```python
import torch

def _softmax(x, axis=-1):
    return torch.softmax(x, dim=axis)
def _gelu(x):
    return torch.nn.functional.gelu(x, approximate="tanh")
def _silu(x):
    return torch.nn.functional.silu(x)
def _sigmoid(x):
    return torch.sigmoid(x)
def _layernorm(x, axis=-1, eps=1e-5):
    m = x.mean(dim=axis, keepdim=True)
    v = x.var(dim=axis, keepdim=True, unbiased=False)
    return (x - m) / torch.sqrt(v + eps)
def _scatter_add(tgt, idx, src, axis=0):
    return tgt.clone().index_add_(axis, idx, src)
def _segment_sum(src, seg, n):
    out = torch.zeros((n,) + src.shape[1:], dtype=src.dtype)
    return out.index_add_(0, seg, src)
def _pad(x, pw):
    flat = tuple(v for pair in reversed(pw) for v in pair)
    return torch.nn.functional.pad(x, flat)

kernel_name = 'concat_heads__gqa_block_cached__gqa_block_cached__near_ridge'

def setup_inputs():

    _w = (lambda a: (lambda t: t.to(torch.bfloat16) if t.is_floating_point() else t)(torch.as_tensor(a)))
    def _A_setup():
        B, Sq, D = 8, 128, 448
        Hq, Hkv, Sk, Dh = 16, 8, 2048, 256
        assert Hq % Hkv == 0, (Hq, Hkv)
        return {
            "x": _w((lambda *s: torch.randn(*s, dtype=torch.bfloat16) * 0.8)(B, Sq, D)),
            "k_cache": _w((lambda *s: torch.randn(*s, dtype=torch.bfloat16) * 0.8)(B, Hkv, Sk, Dh)),
            "v_cache": _w((lambda *s: torch.randn(*s, dtype=torch.bfloat16) * 0.05)(B, Hkv, Sk, Dh)),
            "wq": _w((lambda *s: torch.randn(*s, dtype=torch.bfloat16) * 0.8)(D, Hq * Dh) * (D ** -0.5)),
            "wo": _w((lambda *s: torch.randn(*s, dtype=torch.bfloat16) * 0.05)(Hq * Dh, D) * ((Hq * Dh) ** -0.5)),
        }
    _A_in = _A_setup()

    def _B_setup():
        B, Sq, D = 8, 128, 448
        Hq, Hkv, Sk, Dh = 16, 8, 2048, 256
        assert Hq % Hkv == 0, (Hq, Hkv)
        return {
            "x": _w((lambda *s: torch.randn(*s, dtype=torch.bfloat16) * 0.8)(B, Sq, D)),
            "k_cache": _w((lambda *s: torch.randn(*s, dtype=torch.bfloat16) * 0.8)(B, Hkv, Sk, Dh)),
            "v_cache": _w((lambda *s: torch.randn(*s, dtype=torch.bfloat16) * 0.05)(B, Hkv, Sk, Dh)),
            "wq": _w((lambda *s: torch.randn(*s, dtype=torch.bfloat16) * 0.8)(D, Hq * Dh) * (D ** -0.5)),
            "wo": _w((lambda *s: torch.randn(*s, dtype=torch.bfloat16) * 0.05)(Hq * Dh, D) * ((Hq * Dh) ** -0.5)),
        }
    _B_in = _B_setup()

    return {
        "A_x": _A_in["x"],
        "A_k_cache": _A_in["k_cache"],
        "A_v_cache": _A_in["v_cache"],
        "A_wq": _A_in["wq"],
        "A_wo": _A_in["wo"],
        "B_x": _B_in["x"],
        "B_k_cache": _B_in["k_cache"],
        "B_v_cache": _B_in["v_cache"],
        "B_wq": _B_in["wq"],
        "B_wo": _B_in["wo"],
    }

def reference(A_x, A_k_cache, A_v_cache, A_wq, A_wo, B_x, B_k_cache, B_v_cache, B_wq, B_wo):
    def _A_ref(x, k_cache, v_cache, wq, wo):
        B, Sq, D = x.shape
        Hq, Dh = 16, 256
        Hkv = k_cache.shape[1]
        rep = Hq // Hkv
        q = (lambda x, *d: x.permute(*d))((x @ wq).reshape(B, Sq, Hq, Dh), 0, 2, 1, 3)
        k = (lambda x, n, axis: torch.repeat_interleave(x, n, dim=axis))(k_cache, rep, axis=1)
        v = (lambda x, n, axis: torch.repeat_interleave(x, n, dim=axis))(v_cache, rep, axis=1)
        scores = torch.einsum("bhqd,bhkd->bhqk", q, k) * (Dh ** -0.5)
        p = _softmax(scores, axis=-1)
        o = torch.einsum("bhqk,bhkd->bhqd", p, v)
        return (lambda x, *d: x.permute(*d))(o, 0, 2, 1, 3).reshape(B, Sq, Hq * Dh) @ wo

    def _B_ref(x, k_cache, v_cache, wq, wo):
        B, Sq, D = x.shape
        Hq, Dh = 16, 256
        Hkv = k_cache.shape[1]
        rep = Hq // Hkv
        q = (lambda x, *d: x.permute(*d))((x @ wq).reshape(B, Sq, Hq, Dh), 0, 2, 1, 3)
        k = (lambda x, n, axis: torch.repeat_interleave(x, n, dim=axis))(k_cache, rep, axis=1)
        v = (lambda x, n, axis: torch.repeat_interleave(x, n, dim=axis))(v_cache, rep, axis=1)
        scores = torch.einsum("bhqd,bhkd->bhqk", q, k) * (Dh ** -0.5)
        p = _softmax(scores, axis=-1)
        o = torch.einsum("bhqk,bhkd->bhqd", p, v)
        return (lambda x, *d: x.permute(*d))(o, 0, 2, 1, 3).reshape(B, Sq, Hq * Dh) @ wo

    a = _A_ref(A_x, A_k_cache, A_v_cache, A_wq, A_wo)
    b = _B_ref(B_x, B_k_cache, B_v_cache, B_wq, B_wo)
    return torch.concatenate([a, b], axis=-1)
```

```asm
; @launch grid=(256,1,1) block=(256,1,1) lds=163840
.amdgcn_target "amdgcn-amd-amdhsa--gfx950"
.text
.globl concat_heads__gqa_block_cached__gqa_block_cached__near_ridge_kernel
.p2align 8
.type concat_heads__gqa_block_cached__gqa_block_cached__near_ridge_kernel,@function
concat_heads__gqa_block_cached__gqa_block_cached__near_ridge_kernel:
s_load_dwordx16 s[44:59], s[0:1], 0
s_load_dwordx4 s[60:63], s[0:1], 64
s_load_dwordx2 s[64:65], s[0:1], 96
s_cmp_ge_u32 s2, 256
s_cbranch_scc1 L_exit
v_lshrrev_b32 v1, 6, v0
v_and_b32 v64, 63, v0
v_readfirstlane_b32 s35, v1
s_and_b32 s66, s2, 7
s_lshr_b32 s67, s2, 3
s_lshr_b32 s68, s66, 2
s_and_b32 s69, s67, 1
s_lshr_b32 s70, s67, 1
s_and_b32 s71, s70, 7
s_lshr_b32 s70, s70, 3
s_and_b32 s72, s66, 3
s_lshl_b32 s72, s72, 1
s_add_u32 s72, s72, s70
s_lshl_b32 s73, s72, 1
s_add_u32 s73, s73, s69
s_lshl_b32 s90, s72, 1
s_add_u32 s90, s71, s90
s_and_b32 s90, s90, 3
s_mul_i32 s90, s90, 256
s_min_u32 s90, s90, 768
s_lshl_b32 s28, s35, 12
s_lshl_b32 s34, s35, 16
s_mul_i32 s84, s35, 14336
s_lshl_b32 s85, s35, 11
s_mul_i32 s33, s35, 28672
s_sub_u32 s29, s28, 16384
s_sub_u32 s30, s28, 16384
s_mov_b32 s36, 0x3db8aa3b
s_and_b32 s76, s35, 1
s_lshl_b32 s76, s76, 3
s_getpc_b64 s[20:21]
s_and_b32 s21, s21, 0xffff
s_mov_b32 s22, CODE_BYTES
s_mov_b32 s23, 0x20000
v_lshlrev_b32 v73, 7, v64
s_and_b32 s74, s67, 1
s_lshl_b32 s74, s74, 2
s_add_u32 s74, s74, s35
s_lshl_b32 s74, s74, 13
buffer_load_dword a253, v73, s[20:23], s74 offen
v_lshrrev_b32 v65, 5, v64
v_and_b32 v66, 31, v64
v_lshrrev_b32 v71, 3, v64
v_and_b32 v72, 7, v64
v_mul_u32_u24 v73, 896, v71
v_lshrrev_b32 v74, 1, v71
v_xor_b32 v74, v74, v72
v_lshl_add_u32 v75, v74, 4, v73
v_xor_b32 v74, 4, v74
v_lshl_add_u32 v76, v74, 4, v73
v_add_u32 v24, 0, v75
v_add_u32 v25, 6144, v76
v_lshlrev_b32 v73, 1, v65
v_xor_b32 v73, v73, v66
v_xor_b32 v73, s76, v73
v_lshlrev_b32 v74, 13, v65
v_lshl_add_u32 v75, v73, 4, v74
v_xor_b32 v73, 4, v73
v_lshl_add_u32 v76, v73, 4, v74
v_add_u32 v20, 0, v75
v_add_u32 v21, 15360, v76
v_add_u32 v22, 30720, v75
v_add_u32 v23, 46080, v76
s_waitcnt lgkmcnt(0)
s_cmp_eq_u32 s68, 0
s_cselect_b32 s44, s44, s54
s_cselect_b32 s45, s45, s55
s_cselect_b32 s50, s50, s60
s_cselect_b32 s51, s51, s61
s_cselect_b32 s46, s46, s56
s_cselect_b32 s47, s47, s57
s_cselect_b32 s48, s48, s58
s_cselect_b32 s49, s49, s59
s_cselect_b32 s52, s52, s62
s_cselect_b32 s53, s53, s63
s_lshl_b32 s74, s71, 1
s_add_u32 s74, s74, s69
s_mul_i32 s74, s74, 57344
s_add_u32 s4, s44, s74
s_addc_u32 s5, s45, 0
s_and_b32 s5, s5, 0xffff
s_mov_b32 s6, 57344
s_mov_b32 s7, 0x20000
s_lshl_b32 s74, s72, 10
s_sub_u32 s75, 3670016, s74
s_add_u32 s8, s50, s74
s_addc_u32 s9, s51, 0
s_and_b32 s9, s9, 0xffff
s_mov_b32 s10, s75
s_mov_b32 s11, 0x20000
s_add_u32 m0, s85, 0
s_add_u32 s32, s84, s90
s_lshl_b32 s91, s90, 12
buffer_load_dwordx4 v24, s[4:7], s32 offen lds
buffer_load_dwordx4 v25, s[4:7], s32 offen offset:1024 lds
s_add_u32 m0, s28, 131072
s_add_u32 s32, s34, s91
s_add_u32 s90, s90, 128
buffer_load_dwordx4 v20, s[8:11], s32 offen lds
buffer_load_dwordx4 v21, s[8:11], s32 offen offset:1024 lds
buffer_load_dwordx4 v22, s[8:11], s32 offen offset:2048 lds
buffer_load_dwordx4 v23, s[8:11], s32 offen offset:3072 lds
s_add_u32 m0, s28, 65536
s_add_u32 s32, s32, 512
s_cmp_eq_u32 s90, 896
s_cselect_b32 s90, 0, s90
buffer_load_dwordx4 v20, s[8:11], s32 offen lds
buffer_load_dwordx4 v21, s[8:11], s32 offen offset:1024 lds
buffer_load_dwordx4 v22, s[8:11], s32 offen offset:2048 lds
buffer_load_dwordx4 v23, s[8:11], s32 offen offset:3072 lds
s_lshl_b32 s74, s71, 3
s_add_u32 s74, s74, s72
s_lshl_b32 s74, s74, 20
s_add_u32 s12, s46, s74
s_addc_u32 s13, s47, 0
s_and_b32 s13, s13, 0xffff
s_mov_b32 s14, 1048576
s_mov_b32 s15, 0x20000
s_add_u32 s16, s48, s74
s_addc_u32 s17, s49, 0
s_and_b32 s17, s17, 0xffff
s_mov_b32 s18, 1048576
s_mov_b32 s19, 0x20000
v_xor_b32 v73, v65, v66
v_xor_b32 v73, s76, v73
v_lshlrev_b32 v74, 9, v65
v_xor_b32 v75, 0, v73
v_lshl_add_u32 v12, v75, 4, v74
v_xor_b32 v75, 2, v73
v_lshl_add_u32 v13, v75, 4, v74
v_xor_b32 v75, 4, v73
v_lshl_add_u32 v14, v75, 4, v74
v_xor_b32 v75, 6, v73
v_lshl_add_u32 v15, v75, 4, v74
s_mul_i32 s74, s72, 458752
s_add_u32 s20, s52, s74
s_addc_u32 s21, s53, 0
s_and_b32 s21, s21, 0xffff
s_mov_b32 s22, 458752
s_mov_b32 s23, 0x20000
s_lshl_b32 s70, s68, 3
s_add_u32 s70, s70, s71
s_lshl_b32 s70, s70, 1
s_add_u32 s70, s70, s69
s_mov_b32 s73, s72
s_lshl_b32 s74, s70, 3
s_add_u32 s74, s74, s73
s_mul_i32 s74, s74, 57344
s_add_u32 s24, s64, s74
s_addc_u32 s25, s65, 0
s_and_b32 s25, s25, 0xffff
s_mov_b32 s26, 57344
s_mov_b32 s27, 0x20000
s_lshr_b32 s86, s35, 1
s_and_b32 s87, s35, 1
s_mov_b32 s3, 0
s_load_dwordx2 s[54:55], s[0:1], 80
s_load_dwordx2 s[56:57], s[0:1], 88
s_mov_b32 s74, 0x2400000
s_add_u32 s60, s64, s74
s_addc_u32 s61, s65, 0
s_and_b32 s61, s61, 0xffff
s_mov_b32 s62, 65536
s_mov_b32 s63, 0x20000
s_lshl_b32 s78, s70, 10
s_lshl_b32 s79, s70, 2
s_add_u32 s79, s79, 128
s_or_b32 s74, s73, s35
s_lshl_b32 s74, s74, 27
v_and_b32 v38, 1, v71
v_lshlrev_b32 v38, 15, v38
v_lshl_add_u32 v38, v72, 7, v38
v_add_u32 v38, s74, v38
v_lshlrev_b32 v39, 20, v64
v_add_u32 v39, s74, v39
v_and_b32 v26, 15, v64
v_lshrrev_b32 v67, 4, v64
v_bfe_u32 v68, v64, 2, 2
v_and_b32 v69, 3, v64
v_and_b32 v70, 15, v64
v_lshlrev_b32 v73, 1, v65
v_xor_b32 v73, v73, v66
v_lshlrev_b32 v74, 9, v65
v_xor_b32 v75, 0, v73
v_lshl_add_u32 v16, v75, 4, v74
v_xor_b32 v75, 4, v73
v_lshl_add_u32 v17, v75, 4, v74
v_xor_b32 v75, 8, v73
v_lshl_add_u32 v18, v75, 4, v74
v_xor_b32 v75, 12, v73
v_lshl_add_u32 v19, v75, 4, v74
v_bfe_u32 v76, v64, 2, 3
v_lshl_add_u32 v73, v67, 3, v68
v_lshlrev_b32 v73, 9, v73
v_lshl_add_u32 v73, v69, 3, v73
s_mul_i32 s74, s86, -65536
s_add_u32 s74, s74, 98304
v_add_u32 v73, s74, v73
v_xor_b32 v75, 0, v76
v_lshl_add_u32 v28, v75, 5, v73
v_xor_b32 v75, 1, v76
v_lshl_add_u32 v29, v75, 5, v73
v_xor_b32 v75, 2, v76
v_lshl_add_u32 v30, v75, 5, v73
v_xor_b32 v75, 3, v76
v_lshl_add_u32 v31, v75, 5, v73
v_xor_b32 v75, 4, v76
v_lshl_add_u32 v32, v75, 5, v73
v_xor_b32 v75, 5, v76
v_lshl_add_u32 v33, v75, 5, v73
v_xor_b32 v75, 6, v76
v_lshl_add_u32 v34, v75, 5, v73
v_xor_b32 v75, 7, v76
v_lshl_add_u32 v35, v75, 5, v73
v_lshlrev_b32 v73, 7, v70
s_lshl_b32 s74, s87, 12
v_add_u32 v73, s74, v73
v_lshrrev_b32 v74, 1, v70
v_xor_b32 v74, v74, v67
v_xor_b32 v75, 0, v74
v_lshl_add_u32 v36, v75, 4, v73
v_xor_b32 v75, 4, v74
v_lshl_add_u32 v37, v75, 4, v73
v_lshrrev_b32 v73, 2, v64
v_lshlrev_b32 v73, 9, v73
v_lshl_add_u32 v73, v69, 3, v73
v_add_u32 v73, 32768, v73
v_xor_b32 v75, 0, v76
v_lshl_add_u32 v4, v75, 5, v73
v_xor_b32 v75, 1, v76
v_lshl_add_u32 v5, v75, 5, v73
v_xor_b32 v75, 2, v76
v_lshl_add_u32 v6, v75, 5, v73
v_xor_b32 v75, 3, v76
v_lshl_add_u32 v7, v75, 5, v73
v_xor_b32 v75, 4, v76
v_lshl_add_u32 v8, v75, 5, v73
v_xor_b32 v75, 5, v76
v_lshl_add_u32 v9, v75, 5, v73
v_xor_b32 v75, 6, v76
v_lshl_add_u32 v10, v75, 5, v73
v_xor_b32 v75, 7, v76
v_lshl_add_u32 v11, v75, 5, v73
v_lshlrev_b32 v73, 9, v70
v_add_u32 v73, 98304, v73
v_xor_b32 v74, v67, v70
v_xor_b32 v75, 0, v74
v_lshl_add_u32 v0, v75, 4, v73
v_xor_b32 v75, 4, v74
v_lshl_add_u32 v1, v75, 4, v73
v_xor_b32 v75, 8, v74
v_lshl_add_u32 v2, v75, 4, v73
v_xor_b32 v75, 12, v74
v_lshl_add_u32 v3, v75, 4, v73
v_lshlrev_b32 v73, 4, v64
v_add_u32 v44, s84, v73
v_mul_u32_u24 v74, 896, v71
v_lshlrev_b32 v75, 1, v67
v_xor_b32 v75, v75, v72
v_lshl_add_u32 v74, v75, 4, v74
v_add_u32 v75, 0, v74
v_accvgpr_write_b32 a224, v75
v_add_u32 v75, 6144, v74
v_accvgpr_write_b32 a225, v75
v_add_u32 v75, 12288, v74
v_accvgpr_write_b32 a226, v75
v_add_u32 v75, 18432, v74
v_accvgpr_write_b32 a227, v75
v_lshrrev_b32 v74, 2, v64
v_lshlrev_b32 v74, 7, v74
v_lshl_add_u32 v74, v69, 3, v74
v_and_b32 v77, 3, v71
s_lshl_b32 s74, s86, 1
v_xor_b32 v77, s74, v77
v_xor_b32 v75, 0, v77
v_lshl_add_u32 v75, v75, 5, v74
v_add_u32 v78, 98304, v75
v_accvgpr_write_b32 a228, v78
v_add_u32 v78, 32768, v75
v_accvgpr_write_b32 a230, v78
v_xor_b32 v75, 1, v77
v_lshl_add_u32 v75, v75, 5, v74
v_add_u32 v78, 98304, v75
v_accvgpr_write_b32 a229, v78
v_add_u32 v78, 32768, v75
v_accvgpr_write_b32 a231, v78
s_mul_i32 s74, s87, -81920
s_add_u32 s74, s74, 147456
s_lshl_b32 s75, s87, 14
v_add_u32 v78, s74, v73
v_accvgpr_write_b32 a233, v78
v_add_u32 v78, s75, v73
v_accvgpr_write_b32 a234, v78
s_cmp_eq_u32 s86, 0
s_cselect_b32 s74, s74, s75
v_add_u32 v78, s74, v73
v_accvgpr_write_b32 a232, v78
v_min_u32 v74, 55, v64
v_lshlrev_b32 v74, 7, v74
v_mov_b32 v47, v74
s_and_b32 s77, s70, 15
s_lshl_b32 s77, s77, 2
s_add_u32 s77, s77, s35
s_mul_i32 s77, s77, 7168
buffer_load_dword v27, v38, s[60:63], s78 offen sc1
s_add_u32 m0, s28, 147456
s_add_u32 s32, s32, 261632
buffer_load_dwordx4 v20, s[8:11], s32 offen lds
buffer_load_dwordx4 v21, s[8:11], s32 offen offset:1024 lds
buffer_load_dwordx4 v22, s[8:11], s32 offen offset:2048 lds
buffer_load_dwordx4 v23, s[8:11], s32 offen offset:3072 lds
s_add_u32 m0, s28, 81920
s_add_u32 s32, s32, 512
buffer_load_dwordx4 v20, s[8:11], s32 offen lds
buffer_load_dwordx4 v21, s[8:11], s32 offen offset:1024 lds
buffer_load_dwordx4 v22, s[8:11], s32 offen offset:2048 lds
buffer_load_dwordx4 v23, s[8:11], s32 offen offset:3072 lds
s_add_u32 m0, s85, 8192
s_add_u32 s32, s84, s90
s_lshl_b32 s91, s90, 12
buffer_load_dwordx4 v24, s[4:7], s32 offen lds
buffer_load_dwordx4 v25, s[4:7], s32 offen offset:1024 lds
s_add_u32 m0, s28, 98304
s_add_u32 s32, s34, s91
s_add_u32 s90, s90, 128
buffer_load_dwordx4 v20, s[8:11], s32 offen lds
buffer_load_dwordx4 v21, s[8:11], s32 offen offset:1024 lds
buffer_load_dwordx4 v22, s[8:11], s32 offen offset:2048 lds
buffer_load_dwordx4 v23, s[8:11], s32 offen offset:3072 lds
s_add_u32 m0, s28, 32768
s_add_u32 s32, s32, 512
s_cmp_eq_u32 s90, 896
s_cselect_b32 s90, 0, s90
buffer_load_dwordx4 v20, s[8:11], s32 offen lds
buffer_load_dwordx4 v21, s[8:11], s32 offen offset:1024 lds
buffer_load_dwordx4 v22, s[8:11], s32 offen offset:2048 lds
buffer_load_dwordx4 v23, s[8:11], s32 offen offset:3072 lds
s_waitcnt vmcnt(18) lgkmcnt(0)
s_barrier
ds_read_b128 a[192:195], v36 offset:0
ds_read_b128 a[196:199], v36 offset:2048
ds_read_b64_tr_b16 a[64:65], v28 offset:32768
ds_read_b64_tr_b16 a[66:67], v28 offset:34816
ds_read_b64_tr_b16 a[68:69], v29 offset:32768
ds_read_b64_tr_b16 a[70:71], v29 offset:34816
ds_read_b64_tr_b16 a[72:73], v30 offset:32768
ds_read_b64_tr_b16 a[74:75], v30 offset:34816
ds_read_b64_tr_b16 a[76:77], v31 offset:32768
ds_read_b64_tr_b16 a[78:79], v31 offset:34816
ds_read_b64_tr_b16 a[80:81], v32 offset:32768
ds_read_b64_tr_b16 a[82:83], v32 offset:34816
ds_read_b64_tr_b16 a[84:85], v33 offset:32768
ds_read_b64_tr_b16 a[86:87], v33 offset:34816
ds_read_b64_tr_b16 a[88:89], v34 offset:32768
ds_read_b64_tr_b16 a[90:91], v34 offset:34816
ds_read_b64_tr_b16 a[92:93], v35 offset:32768
ds_read_b64_tr_b16 a[94:95], v35 offset:34816
ds_read_b64_tr_b16 a[96:97], v28 offset:33024
ds_read_b64_tr_b16 a[98:99], v28 offset:35072
ds_read_b64_tr_b16 a[100:101], v29 offset:33024
ds_read_b64_tr_b16 a[102:103], v29 offset:35072
ds_read_b64_tr_b16 a[104:105], v30 offset:33024
ds_read_b64_tr_b16 a[106:107], v30 offset:35072
ds_read_b64_tr_b16 a[108:109], v31 offset:33024
s_waitcnt lgkmcnt(15)
v_mfma_f32_16x16x32_bf16 v[128:131], a[64:67], a[192:195], 0
s_add_u32 m0, s28, 114688
s_add_u32 s32, s32, 261632
buffer_load_dwordx4 v20, s[8:11], s32 offen lds
v_mfma_f32_16x16x32_bf16 v[132:135], a[64:67], a[196:199], 0
buffer_load_dwordx4 v21, s[8:11], s32 offen offset:1024 lds
v_mfma_f32_16x16x32_bf16 v[140:143], a[68:71], a[196:199], 0
ds_read_b64_tr_b16 a[110:111], v31 offset:35072
ds_read_b64_tr_b16 a[112:113], v32 offset:33024
v_mfma_f32_16x16x32_bf16 v[136:139], a[68:71], a[192:195], 0
buffer_load_dwordx4 v22, s[8:11], s32 offen offset:2048 lds
v_mfma_f32_16x16x32_bf16 v[144:147], a[72:75], a[192:195], 0
ds_read_b64_tr_b16 a[114:115], v32 offset:35072
ds_read_b64_tr_b16 a[116:117], v33 offset:33024
v_mfma_f32_16x16x32_bf16 v[148:151], a[72:75], a[196:199], 0
buffer_load_dwordx4 v23, s[8:11], s32 offen offset:3072 lds
v_mfma_f32_16x16x32_bf16 v[156:159], a[76:79], a[196:199], 0
s_add_u32 m0, s28, 49152
s_add_u32 s32, s32, 512
ds_read_b64_tr_b16 a[118:119], v33 offset:35072
ds_read_b64_tr_b16 a[120:121], v34 offset:33024
v_mfma_f32_16x16x32_bf16 v[152:155], a[76:79], a[192:195], 0
s_waitcnt lgkmcnt(6)
buffer_load_dwordx4 v20, s[8:11], s32 offen lds
v_mfma_f32_16x16x32_bf16 v[160:163], a[80:83], a[192:195], 0
ds_read_b64_tr_b16 a[122:123], v34 offset:35072
ds_read_b64_tr_b16 a[124:125], v35 offset:33024
v_mfma_f32_16x16x32_bf16 v[164:167], a[80:83], a[196:199], 0
buffer_load_dwordx4 v21, s[8:11], s32 offen offset:1024 lds
ds_read_b64_tr_b16 a[126:127], v35 offset:35072
v_mfma_f32_16x16x32_bf16 v[172:175], a[84:87], a[196:199], 0
buffer_load_dwordx4 v22, s[8:11], s32 offen offset:2048 lds
v_mfma_f32_16x16x32_bf16 v[168:171], a[84:87], a[192:195], 0
buffer_load_dwordx4 v23, s[8:11], s32 offen offset:3072 lds
v_mfma_f32_16x16x32_bf16 v[176:179], a[88:91], a[192:195], 0
v_mfma_f32_16x16x32_bf16 v[180:183], a[88:91], a[196:199], 0
v_mfma_f32_16x16x32_bf16 v[188:191], a[92:95], a[196:199], 0
v_mfma_f32_16x16x32_bf16 v[184:187], a[92:95], a[192:195], 0
s_waitcnt vmcnt(18) lgkmcnt(0)
s_barrier
ds_read_b128 a[200:203], v37 offset:0
ds_read_b128 a[204:207], v37 offset:2048
v_mfma_f32_16x16x32_bf16 v[192:195], a[96:99], a[192:195], 0
ds_read_b64_tr_b16 a[128:129], v28 offset:49152
v_mfma_f32_16x16x32_bf16 v[196:199], a[96:99], a[196:199], 0
s_add_u32 m0, s85, 16384
s_add_u32 s32, s84, s90
s_lshl_b32 s91, s90, 12
ds_read_b64_tr_b16 a[130:131], v28 offset:51200
v_mfma_f32_16x16x32_bf16 v[204:207], a[100:103], a[196:199], 0
buffer_load_dwordx4 v24, s[4:7], s32 offen lds
v_mfma_f32_16x16x32_bf16 v[200:203], a[100:103], a[192:195], 0
ds_read_b64_tr_b16 a[132:133], v29 offset:49152
ds_read_b64_tr_b16 a[134:135], v29 offset:51200
v_mfma_f32_16x16x32_bf16 v[208:211], a[104:107], a[192:195], 0
ds_read_b64_tr_b16 a[136:137], v30 offset:49152
ds_read_b64_tr_b16 a[138:139], v30 offset:51200
v_mfma_f32_16x16x32_bf16 v[212:215], a[104:107], a[196:199], 0
buffer_load_dwordx4 v25, s[4:7], s32 offen offset:1024 lds
v_mfma_f32_16x16x32_bf16 v[220:223], a[108:111], a[196:199], 0
ds_read_b64_tr_b16 a[140:141], v31 offset:49152
ds_read_b64_tr_b16 a[142:143], v31 offset:51200
v_mfma_f32_16x16x32_bf16 v[216:219], a[108:111], a[192:195], 0
s_add_u32 m0, s28, 131072
s_add_u32 s32, s34, s91
s_add_u32 s90, s90, 128
ds_read_b64_tr_b16 a[144:145], v32 offset:49152
ds_read_b64_tr_b16 a[146:147], v32 offset:51200
v_mfma_f32_16x16x32_bf16 v[224:227], a[112:115], a[192:195], 0
buffer_load_dwordx4 v20, s[8:11], s32 offen lds
v_mfma_f32_16x16x32_bf16 v[228:231], a[112:115], a[196:199], 0
ds_read_b64_tr_b16 a[148:149], v33 offset:49152
ds_read_b64_tr_b16 a[150:151], v33 offset:51200
v_mfma_f32_16x16x32_bf16 v[236:239], a[116:119], a[196:199], 0
ds_read_b64_tr_b16 a[152:153], v34 offset:49152
ds_read_b64_tr_b16 a[154:155], v34 offset:51200
v_mfma_f32_16x16x32_bf16 v[232:235], a[116:119], a[192:195], 0
buffer_load_dwordx4 v21, s[8:11], s32 offen offset:1024 lds
v_mfma_f32_16x16x32_bf16 v[240:243], a[120:123], a[192:195], 0
ds_read_b64_tr_b16 a[156:157], v35 offset:49152
ds_read_b64_tr_b16 a[158:159], v35 offset:51200
v_mfma_f32_16x16x32_bf16 v[244:247], a[120:123], a[196:199], 0
ds_read_b64_tr_b16 a[160:161], v28 offset:49408
ds_read_b64_tr_b16 a[162:163], v28 offset:51456
v_mfma_f32_16x16x32_bf16 v[252:255], a[124:127], a[196:199], 0
buffer_load_dwordx4 v22, s[8:11], s32 offen offset:2048 lds
v_mfma_f32_16x16x32_bf16 v[248:251], a[124:127], a[192:195], 0
s_waitcnt lgkmcnt(6)
ds_read_b64_tr_b16 a[164:165], v29 offset:49408
ds_read_b64_tr_b16 a[166:167], v29 offset:51456
v_mfma_f32_16x16x32_bf16 v[128:131], a[128:131], a[200:203], v[128:131]
ds_read_b64_tr_b16 a[168:169], v30 offset:49408
ds_read_b64_tr_b16 a[170:171], v30 offset:51456
v_mfma_f32_16x16x32_bf16 v[132:135], a[128:131], a[204:207], v[132:135]
buffer_load_dwordx4 v23, s[8:11], s32 offen offset:3072 lds
v_mfma_f32_16x16x32_bf16 v[140:143], a[132:135], a[204:207], v[140:143]
ds_read_b64_tr_b16 a[172:173], v31 offset:49408
ds_read_b64_tr_b16 a[174:175], v31 offset:51456
v_mfma_f32_16x16x32_bf16 v[136:139], a[132:135], a[200:203], v[136:139]
s_add_u32 m0, s28, 65536
s_add_u32 s32, s32, 512
s_cmp_eq_u32 s90, 896
s_cselect_b32 s90, 0, s90
ds_read_b64_tr_b16 a[176:177], v32 offset:49408
ds_read_b64_tr_b16 a[178:179], v32 offset:51456
v_mfma_f32_16x16x32_bf16 v[144:147], a[136:139], a[200:203], v[144:147]
buffer_load_dwordx4 v20, s[8:11], s32 offen lds
v_mfma_f32_16x16x32_bf16 v[148:151], a[136:139], a[204:207], v[148:151]
ds_read_b64_tr_b16 a[180:181], v33 offset:49408
ds_read_b64_tr_b16 a[182:183], v33 offset:51456
v_mfma_f32_16x16x32_bf16 v[156:159], a[140:143], a[204:207], v[156:159]
ds_read_b64_tr_b16 a[184:185], v34 offset:49408
ds_read_b64_tr_b16 a[186:187], v34 offset:51456
v_mfma_f32_16x16x32_bf16 v[152:155], a[140:143], a[200:203], v[152:155]
buffer_load_dwordx4 v21, s[8:11], s32 offen offset:1024 lds
v_mfma_f32_16x16x32_bf16 v[160:163], a[144:147], a[200:203], v[160:163]
ds_read_b64_tr_b16 a[188:189], v35 offset:49408
ds_read_b64_tr_b16 a[190:191], v35 offset:51456
v_mfma_f32_16x16x32_bf16 v[164:167], a[144:147], a[204:207], v[164:167]
buffer_load_dwordx4 v22, s[8:11], s32 offen offset:2048 lds
v_mfma_f32_16x16x32_bf16 v[172:175], a[148:151], a[204:207], v[172:175]
buffer_load_dwordx4 v23, s[8:11], s32 offen offset:3072 lds
v_mfma_f32_16x16x32_bf16 v[168:171], a[148:151], a[200:203], v[168:171]
s_waitcnt lgkmcnt(4)
v_mfma_f32_16x16x32_bf16 v[176:179], a[152:155], a[200:203], v[176:179]
v_mfma_f32_16x16x32_bf16 v[180:183], a[152:155], a[204:207], v[180:183]
v_mfma_f32_16x16x32_bf16 v[188:191], a[156:159], a[204:207], v[188:191]
v_mfma_f32_16x16x32_bf16 v[184:187], a[156:159], a[200:203], v[184:187]
s_waitcnt vmcnt(18) lgkmcnt(0)
s_barrier
ds_read_b128 a[208:211], v36 offset:8192
ds_read_b128 a[212:215], v36 offset:10240
v_mfma_f32_16x16x32_bf16 v[192:195], a[160:163], a[200:203], v[192:195]
ds_read_b64_tr_b16 a[64:65], v28 offset:0
v_mfma_f32_16x16x32_bf16 v[196:199], a[160:163], a[204:207], v[196:199]
s_add_u32 m0, s28, 147456
s_add_u32 s32, s32, 261632
ds_read_b64_tr_b16 a[66:67], v28 offset:2048
v_mfma_f32_16x16x32_bf16 v[204:207], a[164:167], a[204:207], v[204:207]
buffer_load_dwordx4 v20, s[8:11], s32 offen lds
v_mfma_f32_16x16x32_bf16 v[200:203], a[164:167], a[200:203], v[200:203]
ds_read_b64_tr_b16 a[68:69], v29 offset:0
ds_read_b64_tr_b16 a[70:71], v29 offset:2048
v_mfma_f32_16x16x32_bf16 v[208:211], a[168:171], a[200:203], v[208:211]
ds_read_b64_tr_b16 a[72:73], v30 offset:0
ds_read_b64_tr_b16 a[74:75], v30 offset:2048
v_mfma_f32_16x16x32_bf16 v[212:215], a[168:171], a[204:207], v[212:215]
ds_read_b64_tr_b16 a[76:77], v31 offset:0
v_mfma_f32_16x16x32_bf16 v[220:223], a[172:175], a[204:207], v[220:223]
buffer_load_dwordx4 v21, s[8:11], s32 offen offset:1024 lds
v_mfma_f32_16x16x32_bf16 v[216:219], a[172:175], a[200:203], v[216:219]
ds_read_b64_tr_b16 a[78:79], v31 offset:2048
ds_read_b64_tr_b16 a[80:81], v32 offset:0
v_mfma_f32_16x16x32_bf16 v[224:227], a[176:179], a[200:203], v[224:227]
ds_read_b64_tr_b16 a[82:83], v32 offset:2048
ds_read_b64_tr_b16 a[84:85], v33 offset:0
v_mfma_f32_16x16x32_bf16 v[228:231], a[176:179], a[204:207], v[228:231]
buffer_load_dwordx4 v22, s[8:11], s32 offen offset:2048 lds
v_mfma_f32_16x16x32_bf16 v[236:239], a[180:183], a[204:207], v[236:239]
ds_read_b64_tr_b16 a[86:87], v33 offset:2048
ds_read_b64_tr_b16 a[88:89], v34 offset:0
v_mfma_f32_16x16x32_bf16 v[232:235], a[180:183], a[200:203], v[232:235]
ds_read_b64_tr_b16 a[90:91], v34 offset:2048
ds_read_b64_tr_b16 a[92:93], v35 offset:0
v_mfma_f32_16x16x32_bf16 v[240:243], a[184:187], a[200:203], v[240:243]
ds_read_b64_tr_b16 a[94:95], v35 offset:2048
ds_read_b64_tr_b16 a[96:97], v28 offset:256
v_mfma_f32_16x16x32_bf16 v[244:247], a[184:187], a[204:207], v[244:247]
buffer_load_dwordx4 v23, s[8:11], s32 offen offset:3072 lds
v_mfma_f32_16x16x32_bf16 v[252:255], a[188:191], a[204:207], v[252:255]
ds_read_b64_tr_b16 a[98:99], v28 offset:2304
ds_read_b64_tr_b16 a[100:101], v29 offset:256
v_mfma_f32_16x16x32_bf16 v[248:251], a[188:191], a[200:203], v[248:251]
s_add_u32 m0, s28, 81920
s_add_u32 s32, s32, 512
s_waitcnt lgkmcnt(8)
ds_read_b64_tr_b16 a[102:103], v29 offset:2304
ds_read_b64_tr_b16 a[104:105], v30 offset:256
v_mfma_f32_16x16x32_bf16 v[128:131], a[64:67], a[208:211], v[128:131]
buffer_load_dwordx4 v20, s[8:11], s32 offen lds
v_mfma_f32_16x16x32_bf16 v[132:135], a[64:67], a[212:215], v[132:135]
ds_read_b64_tr_b16 a[106:107], v30 offset:2304
ds_read_b64_tr_b16 a[108:109], v31 offset:256
v_mfma_f32_16x16x32_bf16 v[140:143], a[68:71], a[212:215], v[140:143]
ds_read_b64_tr_b16 a[110:111], v31 offset:2304
ds_read_b64_tr_b16 a[112:113], v32 offset:256
v_mfma_f32_16x16x32_bf16 v[136:139], a[68:71], a[208:211], v[136:139]
ds_read_b64_tr_b16 a[114:115], v32 offset:2304
ds_read_b64_tr_b16 a[116:117], v33 offset:256
v_mfma_f32_16x16x32_bf16 v[144:147], a[72:75], a[208:211], v[144:147]
buffer_load_dwordx4 v21, s[8:11], s32 offen offset:1024 lds
v_mfma_f32_16x16x32_bf16 v[148:151], a[72:75], a[212:215], v[148:151]
ds_read_b64_tr_b16 a[118:119], v33 offset:2304
ds_read_b64_tr_b16 a[120:121], v34 offset:256
v_mfma_f32_16x16x32_bf16 v[156:159], a[76:79], a[212:215], v[156:159]
ds_read_b64_tr_b16 a[122:123], v34 offset:2304
ds_read_b64_tr_b16 a[124:125], v35 offset:256
v_mfma_f32_16x16x32_bf16 v[152:155], a[76:79], a[208:211], v[152:155]
buffer_load_dwordx4 v22, s[8:11], s32 offen offset:2048 lds
v_mfma_f32_16x16x32_bf16 v[160:163], a[80:83], a[208:211], v[160:163]
ds_read_b64_tr_b16 a[126:127], v35 offset:2304
v_mfma_f32_16x16x32_bf16 v[164:167], a[80:83], a[212:215], v[164:167]
s_waitcnt lgkmcnt(5)
buffer_load_dwordx4 v23, s[8:11], s32 offen offset:3072 lds
v_mfma_f32_16x16x32_bf16 v[172:175], a[84:87], a[212:215], v[172:175]
v_mfma_f32_16x16x32_bf16 v[168:171], a[84:87], a[208:211], v[168:171]
v_mfma_f32_16x16x32_bf16 v[176:179], a[88:91], a[208:211], v[176:179]
v_mfma_f32_16x16x32_bf16 v[180:183], a[88:91], a[212:215], v[180:183]
v_mfma_f32_16x16x32_bf16 v[188:191], a[92:95], a[212:215], v[188:191]
v_mfma_f32_16x16x32_bf16 v[184:187], a[92:95], a[208:211], v[184:187]
s_waitcnt vmcnt(18) lgkmcnt(0)
s_barrier
ds_read_b128 a[216:219], v37 offset:8192
ds_read_b128 a[220:223], v37 offset:10240
v_mfma_f32_16x16x32_bf16 v[192:195], a[96:99], a[208:211], v[192:195]
ds_read_b64_tr_b16 a[128:129], v28 offset:16384
v_mfma_f32_16x16x32_bf16 v[196:199], a[96:99], a[212:215], v[196:199]
s_add_u32 m0, s85, 0
s_add_u32 s32, s84, s90
s_lshl_b32 s91, s90, 12
ds_read_b64_tr_b16 a[130:131], v28 offset:18432
v_mfma_f32_16x16x32_bf16 v[204:207], a[100:103], a[212:215], v[204:207]
buffer_load_dwordx4 v24, s[4:7], s32 offen lds
v_mfma_f32_16x16x32_bf16 v[200:203], a[100:103], a[208:211], v[200:203]
ds_read_b64_tr_b16 a[132:133], v29 offset:16384
ds_read_b64_tr_b16 a[134:135], v29 offset:18432
v_mfma_f32_16x16x32_bf16 v[208:211], a[104:107], a[208:211], v[208:211]
ds_read_b64_tr_b16 a[136:137], v30 offset:16384
ds_read_b64_tr_b16 a[138:139], v30 offset:18432
v_mfma_f32_16x16x32_bf16 v[212:215], a[104:107], a[212:215], v[212:215]
buffer_load_dwordx4 v25, s[4:7], s32 offen offset:1024 lds
v_mfma_f32_16x16x32_bf16 v[220:223], a[108:111], a[212:215], v[220:223]
ds_read_b64_tr_b16 a[140:141], v31 offset:16384
ds_read_b64_tr_b16 a[142:143], v31 offset:18432
v_mfma_f32_16x16x32_bf16 v[216:219], a[108:111], a[208:211], v[216:219]
s_add_u32 m0, s28, 98304
s_add_u32 s32, s34, s91
s_add_u32 s90, s90, 128
ds_read_b64_tr_b16 a[144:145], v32 offset:16384
ds_read_b64_tr_b16 a[146:147], v32 offset:18432
v_mfma_f32_16x16x32_bf16 v[224:227], a[112:115], a[208:211], v[224:227]
buffer_load_dwordx4 v20, s[8:11], s32 offen lds
v_mfma_f32_16x16x32_bf16 v[228:231], a[112:115], a[212:215], v[228:231]
ds_read_b64_tr_b16 a[148:149], v33 offset:16384
ds_read_b64_tr_b16 a[150:151], v33 offset:18432
v_mfma_f32_16x16x32_bf16 v[236:239], a[116:119], a[212:215], v[236:239]
ds_read_b64_tr_b16 a[152:153], v34 offset:16384
ds_read_b64_tr_b16 a[154:155], v34 offset:18432
v_mfma_f32_16x16x32_bf16 v[232:235], a[116:119], a[208:211], v[232:235]
buffer_load_dwordx4 v21, s[8:11], s32 offen offset:1024 lds
v_mfma_f32_16x16x32_bf16 v[240:243], a[120:123], a[208:211], v[240:243]
ds_read_b64_tr_b16 a[156:157], v35 offset:16384
ds_read_b64_tr_b16 a[158:159], v35 offset:18432
v_mfma_f32_16x16x32_bf16 v[244:247], a[120:123], a[212:215], v[244:247]
ds_read_b64_tr_b16 a[160:161], v28 offset:16640
ds_read_b64_tr_b16 a[162:163], v28 offset:18688
v_mfma_f32_16x16x32_bf16 v[252:255], a[124:127], a[212:215], v[252:255]
buffer_load_dwordx4 v22, s[8:11], s32 offen offset:2048 lds
v_mfma_f32_16x16x32_bf16 v[248:251], a[124:127], a[208:211], v[248:251]
s_waitcnt lgkmcnt(6)
ds_read_b64_tr_b16 a[164:165], v29 offset:16640
ds_read_b64_tr_b16 a[166:167], v29 offset:18688
v_mfma_f32_16x16x32_bf16 v[128:131], a[128:131], a[216:219], v[128:131]
ds_read_b64_tr_b16 a[168:169], v30 offset:16640
ds_read_b64_tr_b16 a[170:171], v30 offset:18688
v_mfma_f32_16x16x32_bf16 v[132:135], a[128:131], a[220:223], v[132:135]
buffer_load_dwordx4 v23, s[8:11], s32 offen offset:3072 lds
v_mfma_f32_16x16x32_bf16 v[140:143], a[132:135], a[220:223], v[140:143]
ds_read_b64_tr_b16 a[172:173], v31 offset:16640
ds_read_b64_tr_b16 a[174:175], v31 offset:18688
v_mfma_f32_16x16x32_bf16 v[136:139], a[132:135], a[216:219], v[136:139]
s_add_u32 m0, s28, 32768
s_add_u32 s32, s32, 512
s_cmp_eq_u32 s90, 896
s_cselect_b32 s90, 0, s90
ds_read_b64_tr_b16 a[176:177], v32 offset:16640
ds_read_b64_tr_b16 a[178:179], v32 offset:18688
v_mfma_f32_16x16x32_bf16 v[144:147], a[136:139], a[216:219], v[144:147]
buffer_load_dwordx4 v20, s[8:11], s32 offen lds
v_mfma_f32_16x16x32_bf16 v[148:151], a[136:139], a[220:223], v[148:151]
ds_read_b64_tr_b16 a[180:181], v33 offset:16640
ds_read_b64_tr_b16 a[182:183], v33 offset:18688
v_mfma_f32_16x16x32_bf16 v[156:159], a[140:143], a[220:223], v[156:159]
ds_read_b64_tr_b16 a[184:185], v34 offset:16640
ds_read_b64_tr_b16 a[186:187], v34 offset:18688
v_mfma_f32_16x16x32_bf16 v[152:155], a[140:143], a[216:219], v[152:155]
buffer_load_dwordx4 v21, s[8:11], s32 offen offset:1024 lds
v_mfma_f32_16x16x32_bf16 v[160:163], a[144:147], a[216:219], v[160:163]
ds_read_b64_tr_b16 a[188:189], v35 offset:16640
ds_read_b64_tr_b16 a[190:191], v35 offset:18688
v_mfma_f32_16x16x32_bf16 v[164:167], a[144:147], a[220:223], v[164:167]
buffer_load_dwordx4 v22, s[8:11], s32 offen offset:2048 lds
v_mfma_f32_16x16x32_bf16 v[172:175], a[148:151], a[220:223], v[172:175]
buffer_load_dwordx4 v23, s[8:11], s32 offen offset:3072 lds
v_mfma_f32_16x16x32_bf16 v[168:171], a[148:151], a[216:219], v[168:171]
s_waitcnt lgkmcnt(4)
v_mfma_f32_16x16x32_bf16 v[176:179], a[152:155], a[216:219], v[176:179]
v_mfma_f32_16x16x32_bf16 v[180:183], a[152:155], a[220:223], v[180:183]
v_mfma_f32_16x16x32_bf16 v[188:191], a[156:159], a[220:223], v[188:191]
v_mfma_f32_16x16x32_bf16 v[184:187], a[156:159], a[216:219], v[184:187]
s_waitcnt vmcnt(18) lgkmcnt(0)
s_barrier
ds_read_b128 a[192:195], v36 offset:16384
ds_read_b128 a[196:199], v36 offset:18432
v_mfma_f32_16x16x32_bf16 v[192:195], a[160:163], a[216:219], v[192:195]
ds_read_b64_tr_b16 a[64:65], v28 offset:32768
v_mfma_f32_16x16x32_bf16 v[196:199], a[160:163], a[220:223], v[196:199]
s_add_u32 m0, s28, 114688
s_add_u32 s32, s32, 261632
ds_read_b64_tr_b16 a[66:67], v28 offset:34816
v_mfma_f32_16x16x32_bf16 v[204:207], a[164:167], a[220:223], v[204:207]
buffer_load_dwordx4 v20, s[8:11], s32 offen lds
v_mfma_f32_16x16x32_bf16 v[200:203], a[164:167], a[216:219], v[200:203]
ds_read_b64_tr_b16 a[68:69], v29 offset:32768
ds_read_b64_tr_b16 a[70:71], v29 offset:34816
v_mfma_f32_16x16x32_bf16 v[208:211], a[168:171], a[216:219], v[208:211]
ds_read_b64_tr_b16 a[72:73], v30 offset:32768
ds_read_b64_tr_b16 a[74:75], v30 offset:34816
v_mfma_f32_16x16x32_bf16 v[212:215], a[168:171], a[220:223], v[212:215]
ds_read_b64_tr_b16 a[76:77], v31 offset:32768
v_mfma_f32_16x16x32_bf16 v[220:223], a[172:175], a[220:223], v[220:223]
buffer_load_dwordx4 v21, s[8:11], s32 offen offset:1024 lds
v_mfma_f32_16x16x32_bf16 v[216:219], a[172:175], a[216:219], v[216:219]
ds_read_b64_tr_b16 a[78:79], v31 offset:34816
ds_read_b64_tr_b16 a[80:81], v32 offset:32768
v_mfma_f32_16x16x32_bf16 v[224:227], a[176:179], a[216:219], v[224:227]
ds_read_b64_tr_b16 a[82:83], v32 offset:34816
ds_read_b64_tr_b16 a[84:85], v33 offset:32768
v_mfma_f32_16x16x32_bf16 v[228:231], a[176:179], a[220:223], v[228:231]
buffer_load_dwordx4 v22, s[8:11], s32 offen offset:2048 lds
v_mfma_f32_16x16x32_bf16 v[236:239], a[180:183], a[220:223], v[236:239]
ds_read_b64_tr_b16 a[86:87], v33 offset:34816
ds_read_b64_tr_b16 a[88:89], v34 offset:32768
v_mfma_f32_16x16x32_bf16 v[232:235], a[180:183], a[216:219], v[232:235]
ds_read_b64_tr_b16 a[90:91], v34 offset:34816
ds_read_b64_tr_b16 a[92:93], v35 offset:32768
v_mfma_f32_16x16x32_bf16 v[240:243], a[184:187], a[216:219], v[240:243]
ds_read_b64_tr_b16 a[94:95], v35 offset:34816
ds_read_b64_tr_b16 a[96:97], v28 offset:33024
v_mfma_f32_16x16x32_bf16 v[244:247], a[184:187], a[220:223], v[244:247]
buffer_load_dwordx4 v23, s[8:11], s32 offen offset:3072 lds
v_mfma_f32_16x16x32_bf16 v[252:255], a[188:191], a[220:223], v[252:255]
ds_read_b64_tr_b16 a[98:99], v28 offset:35072
ds_read_b64_tr_b16 a[100:101], v29 offset:33024
v_mfma_f32_16x16x32_bf16 v[248:251], a[188:191], a[216:219], v[248:251]
s_add_u32 m0, s28, 49152
s_add_u32 s32, s32, 512
s_waitcnt lgkmcnt(8)
ds_read_b64_tr_b16 a[102:103], v29 offset:35072
ds_read_b64_tr_b16 a[104:105], v30 offset:33024
v_mfma_f32_16x16x32_bf16 v[128:131], a[64:67], a[192:195], v[128:131]
buffer_load_dwordx4 v20, s[8:11], s32 offen lds
v_mfma_f32_16x16x32_bf16 v[132:135], a[64:67], a[196:199], v[132:135]
ds_read_b64_tr_b16 a[106:107], v30 offset:35072
ds_read_b64_tr_b16 a[108:109], v31 offset:33024
v_mfma_f32_16x16x32_bf16 v[140:143], a[68:71], a[196:199], v[140:143]
ds_read_b64_tr_b16 a[110:111], v31 offset:35072
ds_read_b64_tr_b16 a[112:113], v32 offset:33024
v_mfma_f32_16x16x32_bf16 v[136:139], a[68:71], a[192:195], v[136:139]
ds_read_b64_tr_b16 a[114:115], v32 offset:35072
ds_read_b64_tr_b16 a[116:117], v33 offset:33024
v_mfma_f32_16x16x32_bf16 v[144:147], a[72:75], a[192:195], v[144:147]
buffer_load_dwordx4 v21, s[8:11], s32 offen offset:1024 lds
v_mfma_f32_16x16x32_bf16 v[148:151], a[72:75], a[196:199], v[148:151]
ds_read_b64_tr_b16 a[118:119], v33 offset:35072
ds_read_b64_tr_b16 a[120:121], v34 offset:33024
v_mfma_f32_16x16x32_bf16 v[156:159], a[76:79], a[196:199], v[156:159]
ds_read_b64_tr_b16 a[122:123], v34 offset:35072
ds_read_b64_tr_b16 a[124:125], v35 offset:33024
v_mfma_f32_16x16x32_bf16 v[152:155], a[76:79], a[192:195], v[152:155]
buffer_load_dwordx4 v22, s[8:11], s32 offen offset:2048 lds
v_mfma_f32_16x16x32_bf16 v[160:163], a[80:83], a[192:195], v[160:163]
ds_read_b64_tr_b16 a[126:127], v35 offset:35072
v_mfma_f32_16x16x32_bf16 v[164:167], a[80:83], a[196:199], v[164:167]
s_waitcnt lgkmcnt(5)
buffer_load_dwordx4 v23, s[8:11], s32 offen offset:3072 lds
v_mfma_f32_16x16x32_bf16 v[172:175], a[84:87], a[196:199], v[172:175]
v_mfma_f32_16x16x32_bf16 v[168:171], a[84:87], a[192:195], v[168:171]
v_mfma_f32_16x16x32_bf16 v[176:179], a[88:91], a[192:195], v[176:179]
v_mfma_f32_16x16x32_bf16 v[180:183], a[88:91], a[196:199], v[180:183]
v_mfma_f32_16x16x32_bf16 v[188:191], a[92:95], a[196:199], v[188:191]
v_mfma_f32_16x16x32_bf16 v[184:187], a[92:95], a[192:195], v[184:187]
s_waitcnt vmcnt(18) lgkmcnt(0)
s_barrier
ds_read_b128 a[200:203], v37 offset:16384
ds_read_b128 a[204:207], v37 offset:18432
v_mfma_f32_16x16x32_bf16 v[192:195], a[96:99], a[192:195], v[192:195]
ds_read_b64_tr_b16 a[128:129], v28 offset:49152
v_mfma_f32_16x16x32_bf16 v[196:199], a[96:99], a[196:199], v[196:199]
s_add_u32 m0, s85, 8192
s_add_u32 s32, s84, s90
s_lshl_b32 s91, s90, 12
ds_read_b64_tr_b16 a[130:131], v28 offset:51200
v_mfma_f32_16x16x32_bf16 v[204:207], a[100:103], a[196:199], v[204:207]
buffer_load_dwordx4 v24, s[4:7], s32 offen lds
v_mfma_f32_16x16x32_bf16 v[200:203], a[100:103], a[192:195], v[200:203]
ds_read_b64_tr_b16 a[132:133], v29 offset:49152
ds_read_b64_tr_b16 a[134:135], v29 offset:51200
v_mfma_f32_16x16x32_bf16 v[208:211], a[104:107], a[192:195], v[208:211]
ds_read_b64_tr_b16 a[136:137], v30 offset:49152
ds_read_b64_tr_b16 a[138:139], v30 offset:51200
v_mfma_f32_16x16x32_bf16 v[212:215], a[104:107], a[196:199], v[212:215]
buffer_load_dwordx4 v25, s[4:7], s32 offen offset:1024 lds
v_mfma_f32_16x16x32_bf16 v[220:223], a[108:111], a[196:199], v[220:223]
ds_read_b64_tr_b16 a[140:141], v31 offset:49152
ds_read_b64_tr_b16 a[142:143], v31 offset:51200
v_mfma_f32_16x16x32_bf16 v[216:219], a[108:111], a[192:195], v[216:219]
s_add_u32 m0, s28, 131072
s_add_u32 s32, s34, s91
s_add_u32 s90, s90, 128
ds_read_b64_tr_b16 a[144:145], v32 offset:49152
ds_read_b64_tr_b16 a[146:147], v32 offset:51200
v_mfma_f32_16x16x32_bf16 v[224:227], a[112:115], a[192:195], v[224:227]
buffer_load_dwordx4 v20, s[8:11], s32 offen lds
v_mfma_f32_16x16x32_bf16 v[228:231], a[112:115], a[196:199], v[228:231]
ds_read_b64_tr_b16 a[148:149], v33 offset:49152
ds_read_b64_tr_b16 a[150:151], v33 offset:51200
v_mfma_f32_16x16x32_bf16 v[236:239], a[116:119], a[196:199], v[236:239]
ds_read_b64_tr_b16 a[152:153], v34 offset:49152
ds_read_b64_tr_b16 a[154:155], v34 offset:51200
v_mfma_f32_16x16x32_bf16 v[232:235], a[116:119], a[192:195], v[232:235]
buffer_load_dwordx4 v21, s[8:11], s32 offen offset:1024 lds
v_mfma_f32_16x16x32_bf16 v[240:243], a[120:123], a[192:195], v[240:243]
ds_read_b64_tr_b16 a[156:157], v35 offset:49152
ds_read_b64_tr_b16 a[158:159], v35 offset:51200
v_mfma_f32_16x16x32_bf16 v[244:247], a[120:123], a[196:199], v[244:247]
ds_read_b64_tr_b16 a[160:161], v28 offset:49408
ds_read_b64_tr_b16 a[162:163], v28 offset:51456
v_mfma_f32_16x16x32_bf16 v[252:255], a[124:127], a[196:199], v[252:255]
buffer_load_dwordx4 v22, s[8:11], s32 offen offset:2048 lds
v_mfma_f32_16x16x32_bf16 v[248:251], a[124:127], a[192:195], v[248:251]
s_waitcnt lgkmcnt(6)
ds_read_b64_tr_b16 a[164:165], v29 offset:49408
ds_read_b64_tr_b16 a[166:167], v29 offset:51456
v_mfma_f32_16x16x32_bf16 v[128:131], a[128:131], a[200:203], v[128:131]
ds_read_b64_tr_b16 a[168:169], v30 offset:49408
ds_read_b64_tr_b16 a[170:171], v30 offset:51456
v_mfma_f32_16x16x32_bf16 v[132:135], a[128:131], a[204:207], v[132:135]
buffer_load_dwordx4 v23, s[8:11], s32 offen offset:3072 lds
v_mfma_f32_16x16x32_bf16 v[140:143], a[132:135], a[204:207], v[140:143]
ds_read_b64_tr_b16 a[172:173], v31 offset:49408
ds_read_b64_tr_b16 a[174:175], v31 offset:51456
v_mfma_f32_16x16x32_bf16 v[136:139], a[132:135], a[200:203], v[136:139]
s_add_u32 m0, s28, 65536
s_add_u32 s32, s32, 512
s_cmp_eq_u32 s90, 896
s_cselect_b32 s90, 0, s90
ds_read_b64_tr_b16 a[176:177], v32 offset:49408
ds_read_b64_tr_b16 a[178:179], v32 offset:51456
v_mfma_f32_16x16x32_bf16 v[144:147], a[136:139], a[200:203], v[144:147]
buffer_load_dwordx4 v20, s[8:11], s32 offen lds
v_mfma_f32_16x16x32_bf16 v[148:151], a[136:139], a[204:207], v[148:151]
ds_read_b64_tr_b16 a[180:181], v33 offset:49408
ds_read_b64_tr_b16 a[182:183], v33 offset:51456
v_mfma_f32_16x16x32_bf16 v[156:159], a[140:143], a[204:207], v[156:159]
ds_read_b64_tr_b16 a[184:185], v34 offset:49408
ds_read_b64_tr_b16 a[186:187], v34 offset:51456
v_mfma_f32_16x16x32_bf16 v[152:155], a[140:143], a[200:203], v[152:155]
buffer_load_dwordx4 v21, s[8:11], s32 offen offset:1024 lds
v_mfma_f32_16x16x32_bf16 v[160:163], a[144:147], a[200:203], v[160:163]
ds_read_b64_tr_b16 a[188:189], v35 offset:49408
ds_read_b64_tr_b16 a[190:191], v35 offset:51456
v_mfma_f32_16x16x32_bf16 v[164:167], a[144:147], a[204:207], v[164:167]
buffer_load_dwordx4 v22, s[8:11], s32 offen offset:2048 lds
v_mfma_f32_16x16x32_bf16 v[172:175], a[148:151], a[204:207], v[172:175]
buffer_load_dwordx4 v23, s[8:11], s32 offen offset:3072 lds
v_mfma_f32_16x16x32_bf16 v[168:171], a[148:151], a[200:203], v[168:171]
s_waitcnt lgkmcnt(4)
v_mfma_f32_16x16x32_bf16 v[176:179], a[152:155], a[200:203], v[176:179]
v_mfma_f32_16x16x32_bf16 v[180:183], a[152:155], a[204:207], v[180:183]
v_mfma_f32_16x16x32_bf16 v[188:191], a[156:159], a[204:207], v[188:191]
v_mfma_f32_16x16x32_bf16 v[184:187], a[156:159], a[200:203], v[184:187]
s_waitcnt vmcnt(18) lgkmcnt(0)
s_barrier
ds_read_b128 a[208:211], v36 offset:0
ds_read_b128 a[212:215], v36 offset:2048
v_mfma_f32_16x16x32_bf16 v[192:195], a[160:163], a[200:203], v[192:195]
ds_read_b64_tr_b16 a[64:65], v28 offset:0
v_mfma_f32_16x16x32_bf16 v[196:199], a[160:163], a[204:207], v[196:199]
s_add_u32 m0, s28, 147456
s_add_u32 s32, s32, 261632
ds_read_b64_tr_b16 a[66:67], v28 offset:2048
v_mfma_f32_16x16x32_bf16 v[204:207], a[164:167], a[204:207], v[204:207]
buffer_load_dwordx4 v20, s[8:11], s32 offen lds
v_mfma_f32_16x16x32_bf16 v[200:203], a[164:167], a[200:203], v[200:203]
ds_read_b64_tr_b16 a[68:69], v29 offset:0
ds_read_b64_tr_b16 a[70:71], v29 offset:2048
v_mfma_f32_16x16x32_bf16 v[208:211], a[168:171], a[200:203], v[208:211]
ds_read_b64_tr_b16 a[72:73], v30 offset:0
ds_read_b64_tr_b16 a[74:75], v30 offset:2048
v_mfma_f32_16x16x32_bf16 v[212:215], a[168:171], a[204:207], v[212:215]
ds_read_b64_tr_b16 a[76:77], v31 offset:0
v_mfma_f32_16x16x32_bf16 v[220:223], a[172:175], a[204:207], v[220:223]
buffer_load_dwordx4 v21, s[8:11], s32 offen offset:1024 lds
v_mfma_f32_16x16x32_bf16 v[216:219], a[172:175], a[200:203], v[216:219]
ds_read_b64_tr_b16 a[78:79], v31 offset:2048
ds_read_b64_tr_b16 a[80:81], v32 offset:0
v_mfma_f32_16x16x32_bf16 v[224:227], a[176:179], a[200:203], v[224:227]
ds_read_b64_tr_b16 a[82:83], v32 offset:2048
ds_read_b64_tr_b16 a[84:85], v33 offset:0
v_mfma_f32_16x16x32_bf16 v[228:231], a[176:179], a[204:207], v[228:231]
buffer_load_dwordx4 v22, s[8:11], s32 offen offset:2048 lds
v_mfma_f32_16x16x32_bf16 v[236:239], a[180:183], a[204:207], v[236:239]
ds_read_b64_tr_b16 a[86:87], v33 offset:2048
ds_read_b64_tr_b16 a[88:89], v34 offset:0
v_mfma_f32_16x16x32_bf16 v[232:235], a[180:183], a[200:203], v[232:235]
ds_read_b64_tr_b16 a[90:91], v34 offset:2048
ds_read_b64_tr_b16 a[92:93], v35 offset:0
v_mfma_f32_16x16x32_bf16 v[240:243], a[184:187], a[200:203], v[240:243]
ds_read_b64_tr_b16 a[94:95], v35 offset:2048
ds_read_b64_tr_b16 a[96:97], v28 offset:256
v_mfma_f32_16x16x32_bf16 v[244:247], a[184:187], a[204:207], v[244:247]
buffer_load_dwordx4 v23, s[8:11], s32 offen offset:3072 lds
v_mfma_f32_16x16x32_bf16 v[252:255], a[188:191], a[204:207], v[252:255]
ds_read_b64_tr_b16 a[98:99], v28 offset:2304
ds_read_b64_tr_b16 a[100:101], v29 offset:256
v_mfma_f32_16x16x32_bf16 v[248:251], a[188:191], a[200:203], v[248:251]
s_add_u32 m0, s28, 81920
s_add_u32 s32, s32, 512
s_waitcnt lgkmcnt(8)
ds_read_b64_tr_b16 a[102:103], v29 offset:2304
ds_read_b64_tr_b16 a[104:105], v30 offset:256
v_mfma_f32_16x16x32_bf16 v[128:131], a[64:67], a[208:211], v[128:131]
buffer_load_dwordx4 v20, s[8:11], s32 offen lds
v_mfma_f32_16x16x32_bf16 v[132:135], a[64:67], a[212:215], v[132:135]
ds_read_b64_tr_b16 a[106:107], v30 offset:2304
ds_read_b64_tr_b16 a[108:109], v31 offset:256
v_mfma_f32_16x16x32_bf16 v[140:143], a[68:71], a[212:215], v[140:143]
ds_read_b64_tr_b16 a[110:111], v31 offset:2304
ds_read_b64_tr_b16 a[112:113], v32 offset:256
v_mfma_f32_16x16x32_bf16 v[136:139], a[68:71], a[208:211], v[136:139]
ds_read_b64_tr_b16 a[114:115], v32 offset:2304
ds_read_b64_tr_b16 a[116:117], v33 offset:256
v_mfma_f32_16x16x32_bf16 v[144:147], a[72:75], a[208:211], v[144:147]
buffer_load_dwordx4 v21, s[8:11], s32 offen offset:1024 lds
v_mfma_f32_16x16x32_bf16 v[148:151], a[72:75], a[212:215], v[148:151]
ds_read_b64_tr_b16 a[118:119], v33 offset:2304
ds_read_b64_tr_b16 a[120:121], v34 offset:256
v_mfma_f32_16x16x32_bf16 v[156:159], a[76:79], a[212:215], v[156:159]
ds_read_b64_tr_b16 a[122:123], v34 offset:2304
ds_read_b64_tr_b16 a[124:125], v35 offset:256
v_mfma_f32_16x16x32_bf16 v[152:155], a[76:79], a[208:211], v[152:155]
buffer_load_dwordx4 v22, s[8:11], s32 offen offset:2048 lds
v_mfma_f32_16x16x32_bf16 v[160:163], a[80:83], a[208:211], v[160:163]
ds_read_b64_tr_b16 a[126:127], v35 offset:2304
v_mfma_f32_16x16x32_bf16 v[164:167], a[80:83], a[212:215], v[164:167]
s_waitcnt lgkmcnt(5)
buffer_load_dwordx4 v23, s[8:11], s32 offen offset:3072 lds
v_mfma_f32_16x16x32_bf16 v[172:175], a[84:87], a[212:215], v[172:175]
v_mfma_f32_16x16x32_bf16 v[168:171], a[84:87], a[208:211], v[168:171]
v_mfma_f32_16x16x32_bf16 v[176:179], a[88:91], a[208:211], v[176:179]
v_mfma_f32_16x16x32_bf16 v[180:183], a[88:91], a[212:215], v[180:183]
v_mfma_f32_16x16x32_bf16 v[188:191], a[92:95], a[212:215], v[188:191]
v_mfma_f32_16x16x32_bf16 v[184:187], a[92:95], a[208:211], v[184:187]
s_waitcnt vmcnt(18) lgkmcnt(0)
s_barrier
ds_read_b128 a[216:219], v37 offset:0
ds_read_b128 a[220:223], v37 offset:2048
v_mfma_f32_16x16x32_bf16 v[192:195], a[96:99], a[208:211], v[192:195]
ds_read_b64_tr_b16 a[128:129], v28 offset:16384
v_mfma_f32_16x16x32_bf16 v[196:199], a[96:99], a[212:215], v[196:199]
s_add_u32 m0, s85, 16384
s_add_u32 s32, s84, s90
s_lshl_b32 s91, s90, 12
ds_read_b64_tr_b16 a[130:131], v28 offset:18432
v_mfma_f32_16x16x32_bf16 v[204:207], a[100:103], a[212:215], v[204:207]
buffer_load_dwordx4 v24, s[4:7], s32 offen lds
v_mfma_f32_16x16x32_bf16 v[200:203], a[100:103], a[208:211], v[200:203]
ds_read_b64_tr_b16 a[132:133], v29 offset:16384
ds_read_b64_tr_b16 a[134:135], v29 offset:18432
v_mfma_f32_16x16x32_bf16 v[208:211], a[104:107], a[208:211], v[208:211]
ds_read_b64_tr_b16 a[136:137], v30 offset:16384
ds_read_b64_tr_b16 a[138:139], v30 offset:18432
v_mfma_f32_16x16x32_bf16 v[212:215], a[104:107], a[212:215], v[212:215]
buffer_load_dwordx4 v25, s[4:7], s32 offen offset:1024 lds
v_mfma_f32_16x16x32_bf16 v[220:223], a[108:111], a[212:215], v[220:223]
ds_read_b64_tr_b16 a[140:141], v31 offset:16384
ds_read_b64_tr_b16 a[142:143], v31 offset:18432
v_mfma_f32_16x16x32_bf16 v[216:219], a[108:111], a[208:211], v[216:219]
s_add_u32 m0, s28, 98304
s_add_u32 s32, s34, s91
s_add_u32 s90, s90, 128
ds_read_b64_tr_b16 a[144:145], v32 offset:16384
ds_read_b64_tr_b16 a[146:147], v32 offset:18432
v_mfma_f32_16x16x32_bf16 v[224:227], a[112:115], a[208:211], v[224:227]
buffer_load_dwordx4 v20, s[8:11], s32 offen lds
v_mfma_f32_16x16x32_bf16 v[228:231], a[112:115], a[212:215], v[228:231]
ds_read_b64_tr_b16 a[148:149], v33 offset:16384
ds_read_b64_tr_b16 a[150:151], v33 offset:18432
v_mfma_f32_16x16x32_bf16 v[236:239], a[116:119], a[212:215], v[236:239]
ds_read_b64_tr_b16 a[152:153], v34 offset:16384
ds_read_b64_tr_b16 a[154:155], v34 offset:18432
v_mfma_f32_16x16x32_bf16 v[232:235], a[116:119], a[208:211], v[232:235]
buffer_load_dwordx4 v21, s[8:11], s32 offen offset:1024 lds
v_mfma_f32_16x16x32_bf16 v[240:243], a[120:123], a[208:211], v[240:243]
ds_read_b64_tr_b16 a[156:157], v35 offset:16384
ds_read_b64_tr_b16 a[158:159], v35 offset:18432
v_mfma_f32_16x16x32_bf16 v[244:247], a[120:123], a[212:215], v[244:247]
ds_read_b64_tr_b16 a[160:161], v28 offset:16640
ds_read_b64_tr_b16 a[162:163], v28 offset:18688
v_mfma_f32_16x16x32_bf16 v[252:255], a[124:127], a[212:215], v[252:255]
buffer_load_dwordx4 v22, s[8:11], s32 offen offset:2048 lds
v_mfma_f32_16x16x32_bf16 v[248:251], a[124:127], a[208:211], v[248:251]
s_waitcnt lgkmcnt(6)
ds_read_b64_tr_b16 a[164:165], v29 offset:16640
ds_read_b64_tr_b16 a[166:167], v29 offset:18688
v_mfma_f32_16x16x32_bf16 v[128:131], a[128:131], a[216:219], v[128:131]
ds_read_b64_tr_b16 a[168:169], v30 offset:16640
ds_read_b64_tr_b16 a[170:171], v30 offset:18688
v_mfma_f32_16x16x32_bf16 v[132:135], a[128:131], a[220:223], v[132:135]
buffer_load_dwordx4 v23, s[8:11], s32 offen offset:3072 lds
v_mfma_f32_16x16x32_bf16 v[140:143], a[132:135], a[220:223], v[140:143]
ds_read_b64_tr_b16 a[172:173], v31 offset:16640
ds_read_b64_tr_b16 a[174:175], v31 offset:18688
v_mfma_f32_16x16x32_bf16 v[136:139], a[132:135], a[216:219], v[136:139]
s_add_u32 m0, s28, 32768
s_add_u32 s32, s32, 512
s_cmp_eq_u32 s90, 896
s_cselect_b32 s90, 0, s90
ds_read_b64_tr_b16 a[176:177], v32 offset:16640
ds_read_b64_tr_b16 a[178:179], v32 offset:18688
v_mfma_f32_16x16x32_bf16 v[144:147], a[136:139], a[216:219], v[144:147]
buffer_load_dwordx4 v20, s[8:11], s32 offen lds
v_mfma_f32_16x16x32_bf16 v[148:151], a[136:139], a[220:223], v[148:151]
ds_read_b64_tr_b16 a[180:181], v33 offset:16640
ds_read_b64_tr_b16 a[182:183], v33 offset:18688
v_mfma_f32_16x16x32_bf16 v[156:159], a[140:143], a[220:223], v[156:159]
ds_read_b64_tr_b16 a[184:185], v34 offset:16640
ds_read_b64_tr_b16 a[186:187], v34 offset:18688
v_mfma_f32_16x16x32_bf16 v[152:155], a[140:143], a[216:219], v[152:155]
buffer_load_dwordx4 v21, s[8:11], s32 offen offset:1024 lds
v_mfma_f32_16x16x32_bf16 v[160:163], a[144:147], a[216:219], v[160:163]
ds_read_b64_tr_b16 a[188:189], v35 offset:16640
ds_read_b64_tr_b16 a[190:191], v35 offset:18688
v_mfma_f32_16x16x32_bf16 v[164:167], a[144:147], a[220:223], v[164:167]
buffer_load_dwordx4 v22, s[8:11], s32 offen offset:2048 lds
v_mfma_f32_16x16x32_bf16 v[172:175], a[148:151], a[220:223], v[172:175]
buffer_load_dwordx4 v23, s[8:11], s32 offen offset:3072 lds
v_mfma_f32_16x16x32_bf16 v[168:171], a[148:151], a[216:219], v[168:171]
s_waitcnt lgkmcnt(4)
v_mfma_f32_16x16x32_bf16 v[176:179], a[152:155], a[216:219], v[176:179]
v_mfma_f32_16x16x32_bf16 v[180:183], a[152:155], a[220:223], v[180:183]
v_mfma_f32_16x16x32_bf16 v[188:191], a[156:159], a[220:223], v[188:191]
v_mfma_f32_16x16x32_bf16 v[184:187], a[156:159], a[216:219], v[184:187]
s_waitcnt vmcnt(18) lgkmcnt(0)
s_barrier
ds_read_b128 a[192:195], v36 offset:8192
ds_read_b128 a[196:199], v36 offset:10240
v_mfma_f32_16x16x32_bf16 v[192:195], a[160:163], a[216:219], v[192:195]
ds_read_b64_tr_b16 a[64:65], v28 offset:32768
v_mfma_f32_16x16x32_bf16 v[196:199], a[160:163], a[220:223], v[196:199]
s_add_u32 m0, s28, 114688
s_add_u32 s32, s32, 261632
ds_read_b64_tr_b16 a[66:67], v28 offset:34816
v_mfma_f32_16x16x32_bf16 v[204:207], a[164:167], a[220:223], v[204:207]
buffer_load_dwordx4 v20, s[8:11], s32 offen lds
v_mfma_f32_16x16x32_bf16 v[200:203], a[164:167], a[216:219], v[200:203]
ds_read_b64_tr_b16 a[68:69], v29 offset:32768
ds_read_b64_tr_b16 a[70:71], v29 offset:34816
v_mfma_f32_16x16x32_bf16 v[208:211], a[168:171], a[216:219], v[208:211]
ds_read_b64_tr_b16 a[72:73], v30 offset:32768
ds_read_b64_tr_b16 a[74:75], v30 offset:34816
v_mfma_f32_16x16x32_bf16 v[212:215], a[168:171], a[220:223], v[212:215]
ds_read_b64_tr_b16 a[76:77], v31 offset:32768
v_mfma_f32_16x16x32_bf16 v[220:223], a[172:175], a[220:223], v[220:223]
buffer_load_dwordx4 v21, s[8:11], s32 offen offset:1024 lds
v_mfma_f32_16x16x32_bf16 v[216:219], a[172:175], a[216:219], v[216:219]
ds_read_b64_tr_b16 a[78:79], v31 offset:34816
ds_read_b64_tr_b16 a[80:81], v32 offset:32768
v_mfma_f32_16x16x32_bf16 v[224:227], a[176:179], a[216:219], v[224:227]
ds_read_b64_tr_b16 a[82:83], v32 offset:34816
ds_read_b64_tr_b16 a[84:85], v33 offset:32768
v_mfma_f32_16x16x32_bf16 v[228:231], a[176:179], a[220:223], v[228:231]
buffer_load_dwordx4 v22, s[8:11], s32 offen offset:2048 lds
v_mfma_f32_16x16x32_bf16 v[236:239], a[180:183], a[220:223], v[236:239]
ds_read_b64_tr_b16 a[86:87], v33 offset:34816
ds_read_b64_tr_b16 a[88:89], v34 offset:32768
v_mfma_f32_16x16x32_bf16 v[232:235], a[180:183], a[216:219], v[232:235]
ds_read_b64_tr_b16 a[90:91], v34 offset:34816
ds_read_b64_tr_b16 a[92:93], v35 offset:32768
v_mfma_f32_16x16x32_bf16 v[240:243], a[184:187], a[216:219], v[240:243]
ds_read_b64_tr_b16 a[94:95], v35 offset:34816
ds_read_b64_tr_b16 a[96:97], v28 offset:33024
v_mfma_f32_16x16x32_bf16 v[244:247], a[184:187], a[220:223], v[244:247]
buffer_load_dwordx4 v23, s[8:11], s32 offen offset:3072 lds
v_mfma_f32_16x16x32_bf16 v[252:255], a[188:191], a[220:223], v[252:255]
ds_read_b64_tr_b16 a[98:99], v28 offset:35072
ds_read_b64_tr_b16 a[100:101], v29 offset:33024
v_mfma_f32_16x16x32_bf16 v[248:251], a[188:191], a[216:219], v[248:251]
s_add_u32 m0, s28, 49152
s_add_u32 s32, s32, 512
s_waitcnt lgkmcnt(8)
ds_read_b64_tr_b16 a[102:103], v29 offset:35072
ds_read_b64_tr_b16 a[104:105], v30 offset:33024
v_mfma_f32_16x16x32_bf16 v[128:131], a[64:67], a[192:195], v[128:131]
buffer_load_dwordx4 v20, s[8:11], s32 offen lds
v_mfma_f32_16x16x32_bf16 v[132:135], a[64:67], a[196:199], v[132:135]
ds_read_b64_tr_b16 a[106:107], v30 offset:35072
ds_read_b64_tr_b16 a[108:109], v31 offset:33024
v_mfma_f32_16x16x32_bf16 v[140:143], a[68:71], a[196:199], v[140:143]
ds_read_b64_tr_b16 a[110:111], v31 offset:35072
ds_read_b64_tr_b16 a[112:113], v32 offset:33024
v_mfma_f32_16x16x32_bf16 v[136:139], a[68:71], a[192:195], v[136:139]
ds_read_b64_tr_b16 a[114:115], v32 offset:35072
ds_read_b64_tr_b16 a[116:117], v33 offset:33024
v_mfma_f32_16x16x32_bf16 v[144:147], a[72:75], a[192:195], v[144:147]
buffer_load_dwordx4 v21, s[8:11], s32 offen offset:1024 lds
v_mfma_f32_16x16x32_bf16 v[148:151], a[72:75], a[196:199], v[148:151]
ds_read_b64_tr_b16 a[118:119], v33 offset:35072
ds_read_b64_tr_b16 a[120:121], v34 offset:33024
v_mfma_f32_16x16x32_bf16 v[156:159], a[76:79], a[196:199], v[156:159]
ds_read_b64_tr_b16 a[122:123], v34 offset:35072
ds_read_b64_tr_b16 a[124:125], v35 offset:33024
v_mfma_f32_16x16x32_bf16 v[152:155], a[76:79], a[192:195], v[152:155]
buffer_load_dwordx4 v22, s[8:11], s32 offen offset:2048 lds
v_mfma_f32_16x16x32_bf16 v[160:163], a[80:83], a[192:195], v[160:163]
ds_read_b64_tr_b16 a[126:127], v35 offset:35072
v_mfma_f32_16x16x32_bf16 v[164:167], a[80:83], a[196:199], v[164:167]
s_waitcnt lgkmcnt(5)
buffer_load_dwordx4 v23, s[8:11], s32 offen offset:3072 lds
v_mfma_f32_16x16x32_bf16 v[172:175], a[84:87], a[196:199], v[172:175]
v_mfma_f32_16x16x32_bf16 v[168:171], a[84:87], a[192:195], v[168:171]
v_mfma_f32_16x16x32_bf16 v[176:179], a[88:91], a[192:195], v[176:179]
s_and_b32 s57, s57, 0xffff
s_mov_b32 s58, 256
s_mov_b32 s59, 0x20000
v_lshrrev_b32 v27, v26, v27
v_and_b32 v27, 1, v27
v_cmp_eq_u32 vcc, 0, v27
s_nop 1
s_and_b32 s74, vcc_lo, 0xffff
s_or_b32 s74, s74, 65536
v_mov_b32 v27, s74
v_mfma_f32_16x16x32_bf16 v[180:183], a[88:91], a[196:199], v[180:183]
buffer_store_dword v27, v39, s[56:59], s79 offen sc1
v_mfma_f32_16x16x32_bf16 v[188:191], a[92:95], a[196:199], v[188:191]
v_mfma_f32_16x16x32_bf16 v[184:187], a[92:95], a[192:195], v[184:187]
s_waitcnt vmcnt(18) lgkmcnt(0)
s_barrier
ds_read_b128 a[200:203], v37 offset:8192
ds_read_b128 a[204:207], v37 offset:10240
v_mfma_f32_16x16x32_bf16 v[192:195], a[96:99], a[192:195], v[192:195]
ds_read_b64_tr_b16 a[128:129], v28 offset:49152
v_mfma_f32_16x16x32_bf16 v[196:199], a[96:99], a[196:199], v[196:199]
s_add_u32 m0, s85, 0
s_add_u32 s32, s84, s90
s_lshl_b32 s91, s90, 12
ds_read_b64_tr_b16 a[130:131], v28 offset:51200
v_mfma_f32_16x16x32_bf16 v[204:207], a[100:103], a[196:199], v[204:207]
buffer_load_dwordx4 v24, s[4:7], s32 offen lds
v_mfma_f32_16x16x32_bf16 v[200:203], a[100:103], a[192:195], v[200:203]
ds_read_b64_tr_b16 a[132:133], v29 offset:49152
ds_read_b64_tr_b16 a[134:135], v29 offset:51200
v_mfma_f32_16x16x32_bf16 v[208:211], a[104:107], a[192:195], v[208:211]
ds_read_b64_tr_b16 a[136:137], v30 offset:49152
ds_read_b64_tr_b16 a[138:139], v30 offset:51200
v_mfma_f32_16x16x32_bf16 v[212:215], a[104:107], a[196:199], v[212:215]
buffer_load_dwordx4 v25, s[4:7], s32 offen offset:1024 lds
v_mfma_f32_16x16x32_bf16 v[220:223], a[108:111], a[196:199], v[220:223]
ds_read_b64_tr_b16 a[140:141], v31 offset:49152
ds_read_b64_tr_b16 a[142:143], v31 offset:51200
v_mfma_f32_16x16x32_bf16 v[216:219], a[108:111], a[192:195], v[216:219]
s_add_u32 m0, s28, 131072
s_add_u32 s32, s34, s91
s_add_u32 s90, s90, 128
ds_read_b64_tr_b16 a[144:145], v32 offset:49152
ds_read_b64_tr_b16 a[146:147], v32 offset:51200
v_mfma_f32_16x16x32_bf16 v[224:227], a[112:115], a[192:195], v[224:227]
buffer_load_dwordx4 v20, s[8:11], s32 offen lds
v_mfma_f32_16x16x32_bf16 v[228:231], a[112:115], a[196:199], v[228:231]
ds_read_b64_tr_b16 a[148:149], v33 offset:49152
ds_read_b64_tr_b16 a[150:151], v33 offset:51200
v_mfma_f32_16x16x32_bf16 v[236:239], a[116:119], a[196:199], v[236:239]
ds_read_b64_tr_b16 a[152:153], v34 offset:49152
ds_read_b64_tr_b16 a[154:155], v34 offset:51200
v_mfma_f32_16x16x32_bf16 v[232:235], a[116:119], a[192:195], v[232:235]
buffer_load_dwordx4 v21, s[8:11], s32 offen offset:1024 lds
v_mfma_f32_16x16x32_bf16 v[240:243], a[120:123], a[192:195], v[240:243]
ds_read_b64_tr_b16 a[156:157], v35 offset:49152
ds_read_b64_tr_b16 a[158:159], v35 offset:51200
v_mfma_f32_16x16x32_bf16 v[244:247], a[120:123], a[196:199], v[244:247]
ds_read_b64_tr_b16 a[160:161], v28 offset:49408
ds_read_b64_tr_b16 a[162:163], v28 offset:51456
v_mfma_f32_16x16x32_bf16 v[252:255], a[124:127], a[196:199], v[252:255]
buffer_load_dwordx4 v22, s[8:11], s32 offen offset:2048 lds
v_mfma_f32_16x16x32_bf16 v[248:251], a[124:127], a[192:195], v[248:251]
s_waitcnt lgkmcnt(6)
ds_read_b64_tr_b16 a[164:165], v29 offset:49408
ds_read_b64_tr_b16 a[166:167], v29 offset:51456
v_mfma_f32_16x16x32_bf16 v[128:131], a[128:131], a[200:203], v[128:131]
ds_read_b64_tr_b16 a[168:169], v30 offset:49408
ds_read_b64_tr_b16 a[170:171], v30 offset:51456
v_mfma_f32_16x16x32_bf16 v[132:135], a[128:131], a[204:207], v[132:135]
buffer_load_dwordx4 v23, s[8:11], s32 offen offset:3072 lds
v_mfma_f32_16x16x32_bf16 v[140:143], a[132:135], a[204:207], v[140:143]
ds_read_b64_tr_b16 a[172:173], v31 offset:49408
ds_read_b64_tr_b16 a[174:175], v31 offset:51456
v_mfma_f32_16x16x32_bf16 v[136:139], a[132:135], a[200:203], v[136:139]
s_add_u32 m0, s28, 65536
s_add_u32 s32, s32, 512
s_cmp_eq_u32 s90, 896
s_cselect_b32 s90, 0, s90
ds_read_b64_tr_b16 a[176:177], v32 offset:49408
ds_read_b64_tr_b16 a[178:179], v32 offset:51456
v_mfma_f32_16x16x32_bf16 v[144:147], a[136:139], a[200:203], v[144:147]
buffer_load_dwordx4 v20, s[8:11], s32 offen lds
v_mfma_f32_16x16x32_bf16 v[148:151], a[136:139], a[204:207], v[148:151]
ds_read_b64_tr_b16 a[180:181], v33 offset:49408
ds_read_b64_tr_b16 a[182:183], v33 offset:51456
v_mfma_f32_16x16x32_bf16 v[156:159], a[140:143], a[204:207], v[156:159]
ds_read_b64_tr_b16 a[184:185], v34 offset:49408
ds_read_b64_tr_b16 a[186:187], v34 offset:51456
v_mfma_f32_16x16x32_bf16 v[152:155], a[140:143], a[200:203], v[152:155]
buffer_load_dwordx4 v21, s[8:11], s32 offen offset:1024 lds
v_mfma_f32_16x16x32_bf16 v[160:163], a[144:147], a[200:203], v[160:163]
ds_read_b64_tr_b16 a[188:189], v35 offset:49408
ds_read_b64_tr_b16 a[190:191], v35 offset:51456
v_mfma_f32_16x16x32_bf16 v[164:167], a[144:147], a[204:207], v[164:167]
buffer_load_dwordx4 v22, s[8:11], s32 offen offset:2048 lds
v_mfma_f32_16x16x32_bf16 v[172:175], a[148:151], a[204:207], v[172:175]
buffer_load_dwordx4 v23, s[8:11], s32 offen offset:3072 lds
v_mfma_f32_16x16x32_bf16 v[168:171], a[148:151], a[200:203], v[168:171]
s_waitcnt lgkmcnt(4)
v_mfma_f32_16x16x32_bf16 v[176:179], a[152:155], a[200:203], v[176:179]
v_mfma_f32_16x16x32_bf16 v[180:183], a[152:155], a[204:207], v[180:183]
v_mfma_f32_16x16x32_bf16 v[188:191], a[156:159], a[204:207], v[188:191]
v_mfma_f32_16x16x32_bf16 v[184:187], a[156:159], a[200:203], v[184:187]
s_waitcnt vmcnt(18) lgkmcnt(0)
s_barrier
ds_read_b128 a[208:211], v36 offset:16384
ds_read_b128 a[212:215], v36 offset:18432
v_mfma_f32_16x16x32_bf16 v[192:195], a[160:163], a[200:203], v[192:195]
ds_read_b64_tr_b16 a[64:65], v28 offset:0
v_mfma_f32_16x16x32_bf16 v[196:199], a[160:163], a[204:207], v[196:199]
s_add_u32 m0, s28, 147456
s_add_u32 s32, s32, 261632
ds_read_b64_tr_b16 a[66:67], v28 offset:2048
v_mfma_f32_16x16x32_bf16 v[204:207], a[164:167], a[204:207], v[204:207]
buffer_load_dwordx4 v20, s[8:11], s32 offen lds
v_mfma_f32_16x16x32_bf16 v[200:203], a[164:167], a[200:203], v[200:203]
ds_read_b64_tr_b16 a[68:69], v29 offset:0
ds_read_b64_tr_b16 a[70:71], v29 offset:2048
v_mfma_f32_16x16x32_bf16 v[208:211], a[168:171], a[200:203], v[208:211]
ds_read_b64_tr_b16 a[72:73], v30 offset:0
ds_read_b64_tr_b16 a[74:75], v30 offset:2048
v_mfma_f32_16x16x32_bf16 v[212:215], a[168:171], a[204:207], v[212:215]
ds_read_b64_tr_b16 a[76:77], v31 offset:0
v_mfma_f32_16x16x32_bf16 v[220:223], a[172:175], a[204:207], v[220:223]
buffer_load_dwordx4 v21, s[8:11], s32 offen offset:1024 lds
v_mfma_f32_16x16x32_bf16 v[216:219], a[172:175], a[200:203], v[216:219]
ds_read_b64_tr_b16 a[78:79], v31 offset:2048
ds_read_b64_tr_b16 a[80:81], v32 offset:0
v_mfma_f32_16x16x32_bf16 v[224:227], a[176:179], a[200:203], v[224:227]
ds_read_b64_tr_b16 a[82:83], v32 offset:2048
ds_read_b64_tr_b16 a[84:85], v33 offset:0
v_mfma_f32_16x16x32_bf16 v[228:231], a[176:179], a[204:207], v[228:231]
buffer_load_dwordx4 v22, s[8:11], s32 offen offset:2048 lds
v_mfma_f32_16x16x32_bf16 v[236:239], a[180:183], a[204:207], v[236:239]
ds_read_b64_tr_b16 a[86:87], v33 offset:2048
ds_read_b64_tr_b16 a[88:89], v34 offset:0
v_mfma_f32_16x16x32_bf16 v[232:235], a[180:183], a[200:203], v[232:235]
ds_read_b64_tr_b16 a[90:91], v34 offset:2048
ds_read_b64_tr_b16 a[92:93], v35 offset:0
v_mfma_f32_16x16x32_bf16 v[240:243], a[184:187], a[200:203], v[240:243]
ds_read_b64_tr_b16 a[94:95], v35 offset:2048
ds_read_b64_tr_b16 a[96:97], v28 offset:256
v_mfma_f32_16x16x32_bf16 v[244:247], a[184:187], a[204:207], v[244:247]
buffer_load_dwordx4 v23, s[8:11], s32 offen offset:3072 lds
v_mfma_f32_16x16x32_bf16 v[252:255], a[188:191], a[204:207], v[252:255]
ds_read_b64_tr_b16 a[98:99], v28 offset:2304
ds_read_b64_tr_b16 a[100:101], v29 offset:256
v_mfma_f32_16x16x32_bf16 v[248:251], a[188:191], a[200:203], v[248:251]
s_add_u32 m0, s28, 81920
s_add_u32 s32, s32, 512
s_waitcnt lgkmcnt(8)
ds_read_b64_tr_b16 a[102:103], v29 offset:2304
ds_read_b64_tr_b16 a[104:105], v30 offset:256
v_mfma_f32_16x16x32_bf16 v[128:131], a[64:67], a[208:211], v[128:131]
buffer_load_dwordx4 v20, s[8:11], s32 offen lds
v_mfma_f32_16x16x32_bf16 v[132:135], a[64:67], a[212:215], v[132:135]
ds_read_b64_tr_b16 a[106:107], v30 offset:2304
ds_read_b64_tr_b16 a[108:109], v31 offset:256
v_mfma_f32_16x16x32_bf16 v[140:143], a[68:71], a[212:215], v[140:143]
ds_read_b64_tr_b16 a[110:111], v31 offset:2304
ds_read_b64_tr_b16 a[112:113], v32 offset:256
v_mfma_f32_16x16x32_bf16 v[136:139], a[68:71], a[208:211], v[136:139]
ds_read_b64_tr_b16 a[114:115], v32 offset:2304
ds_read_b64_tr_b16 a[116:117], v33 offset:256
v_mfma_f32_16x16x32_bf16 v[144:147], a[72:75], a[208:211], v[144:147]
buffer_load_dwordx4 v21, s[8:11], s32 offen offset:1024 lds
v_mfma_f32_16x16x32_bf16 v[148:151], a[72:75], a[212:215], v[148:151]
ds_read_b64_tr_b16 a[118:119], v33 offset:2304
ds_read_b64_tr_b16 a[120:121], v34 offset:256
v_mfma_f32_16x16x32_bf16 v[156:159], a[76:79], a[212:215], v[156:159]
ds_read_b64_tr_b16 a[122:123], v34 offset:2304
ds_read_b64_tr_b16 a[124:125], v35 offset:256
v_mfma_f32_16x16x32_bf16 v[152:155], a[76:79], a[208:211], v[152:155]
buffer_load_dwordx4 v22, s[8:11], s32 offen offset:2048 lds
v_mfma_f32_16x16x32_bf16 v[160:163], a[80:83], a[208:211], v[160:163]
ds_read_b64_tr_b16 a[126:127], v35 offset:2304
v_mfma_f32_16x16x32_bf16 v[164:167], a[80:83], a[212:215], v[164:167]
s_waitcnt lgkmcnt(5)
buffer_load_dwordx4 v23, s[8:11], s32 offen offset:3072 lds
v_mfma_f32_16x16x32_bf16 v[172:175], a[84:87], a[212:215], v[172:175]
v_mfma_f32_16x16x32_bf16 v[168:171], a[84:87], a[208:211], v[168:171]
v_mfma_f32_16x16x32_bf16 v[176:179], a[88:91], a[208:211], v[176:179]
v_mfma_f32_16x16x32_bf16 v[180:183], a[88:91], a[212:215], v[180:183]
v_mfma_f32_16x16x32_bf16 v[188:191], a[92:95], a[212:215], v[188:191]
v_mfma_f32_16x16x32_bf16 v[184:187], a[92:95], a[208:211], v[184:187]
s_waitcnt vmcnt(18) lgkmcnt(0)
s_barrier
ds_read_b128 a[216:219], v37 offset:16384
ds_read_b128 a[220:223], v37 offset:18432
v_mfma_f32_16x16x32_bf16 v[192:195], a[96:99], a[208:211], v[192:195]
ds_read_b64_tr_b16 a[128:129], v28 offset:16384
v_mfma_f32_16x16x32_bf16 v[196:199], a[96:99], a[212:215], v[196:199]
s_add_u32 m0, s28, 98304
s_add_u32 s29, s29, 16384
ds_read_b64_tr_b16 a[130:131], v28 offset:18432
v_mfma_f32_16x16x32_bf16 v[204:207], a[100:103], a[212:215], v[204:207]
buffer_load_dwordx4 v12, s[12:15], s29 offen nt lds
v_mfma_f32_16x16x32_bf16 v[200:203], a[100:103], a[208:211], v[200:203]
ds_read_b64_tr_b16 a[132:133], v29 offset:16384
ds_read_b64_tr_b16 a[134:135], v29 offset:18432
v_mfma_f32_16x16x32_bf16 v[208:211], a[104:107], a[208:211], v[208:211]
ds_read_b64_tr_b16 a[136:137], v30 offset:16384
ds_read_b64_tr_b16 a[138:139], v30 offset:18432
v_mfma_f32_16x16x32_bf16 v[212:215], a[104:107], a[212:215], v[212:215]
ds_read_b64_tr_b16 a[140:141], v31 offset:16384
v_mfma_f32_16x16x32_bf16 v[220:223], a[108:111], a[212:215], v[220:223]
buffer_load_dwordx4 v13, s[12:15], s29 offen offset:1024 nt lds
v_mfma_f32_16x16x32_bf16 v[216:219], a[108:111], a[208:211], v[216:219]
ds_read_b64_tr_b16 a[142:143], v31 offset:18432
ds_read_b64_tr_b16 a[144:145], v32 offset:16384
v_mfma_f32_16x16x32_bf16 v[224:227], a[112:115], a[208:211], v[224:227]
ds_read_b64_tr_b16 a[146:147], v32 offset:18432
ds_read_b64_tr_b16 a[148:149], v33 offset:16384
v_mfma_f32_16x16x32_bf16 v[228:231], a[112:115], a[212:215], v[228:231]
buffer_load_dwordx4 v14, s[12:15], s29 offen offset:2048 nt lds
v_mfma_f32_16x16x32_bf16 v[236:239], a[116:119], a[212:215], v[236:239]
ds_read_b64_tr_b16 a[150:151], v33 offset:18432
ds_read_b64_tr_b16 a[152:153], v34 offset:16384
v_mfma_f32_16x16x32_bf16 v[232:235], a[116:119], a[208:211], v[232:235]
ds_read_b64_tr_b16 a[154:155], v34 offset:18432
ds_read_b64_tr_b16 a[156:157], v35 offset:16384
v_mfma_f32_16x16x32_bf16 v[240:243], a[120:123], a[208:211], v[240:243]
ds_read_b64_tr_b16 a[158:159], v35 offset:18432
ds_read_b64_tr_b16 a[160:161], v28 offset:16640
v_mfma_f32_16x16x32_bf16 v[244:247], a[120:123], a[212:215], v[244:247]
buffer_load_dwordx4 v15, s[12:15], s29 offen offset:3072 nt lds
v_mfma_f32_16x16x32_bf16 v[252:255], a[124:127], a[212:215], v[252:255]
ds_read_b64_tr_b16 a[162:163], v28 offset:18688
ds_read_b64_tr_b16 a[164:165], v29 offset:16640
v_mfma_f32_16x16x32_bf16 v[248:251], a[124:127], a[208:211], v[248:251]
s_add_u32 m0, s28, 32768
s_add_u32 s30, s30, 16384
s_waitcnt lgkmcnt(8)
ds_read_b64_tr_b16 a[166:167], v29 offset:18688
ds_read_b64_tr_b16 a[168:169], v30 offset:16640
v_mfma_f32_16x16x32_bf16 v[128:131], a[128:131], a[216:219], v[128:131]
buffer_load_dwordx4 v16, s[16:19], s30 offen nt lds
v_mfma_f32_16x16x32_bf16 v[132:135], a[128:131], a[220:223], v[132:135]
ds_read_b64_tr_b16 a[170:171], v30 offset:18688
ds_read_b64_tr_b16 a[172:173], v31 offset:16640
v_mfma_f32_16x16x32_bf16 v[140:143], a[132:135], a[220:223], v[140:143]
ds_read_b64_tr_b16 a[174:175], v31 offset:18688
ds_read_b64_tr_b16 a[176:177], v32 offset:16640
v_mfma_f32_16x16x32_bf16 v[136:139], a[132:135], a[216:219], v[136:139]
ds_read_b64_tr_b16 a[178:179], v32 offset:18688
ds_read_b64_tr_b16 a[180:181], v33 offset:16640
v_mfma_f32_16x16x32_bf16 v[144:147], a[136:139], a[216:219], v[144:147]
buffer_load_dwordx4 v17, s[16:19], s30 offen offset:1024 nt lds
v_mfma_f32_16x16x32_bf16 v[148:151], a[136:139], a[220:223], v[148:151]
ds_read_b64_tr_b16 a[182:183], v33 offset:18688
ds_read_b64_tr_b16 a[184:185], v34 offset:16640
v_mfma_f32_16x16x32_bf16 v[156:159], a[140:143], a[220:223], v[156:159]
ds_read_b64_tr_b16 a[186:187], v34 offset:18688
ds_read_b64_tr_b16 a[188:189], v35 offset:16640
v_mfma_f32_16x16x32_bf16 v[152:155], a[140:143], a[216:219], v[152:155]
buffer_load_dwordx4 v18, s[16:19], s30 offen offset:2048 nt lds
v_mfma_f32_16x16x32_bf16 v[160:163], a[144:147], a[216:219], v[160:163]
ds_read_b64_tr_b16 a[190:191], v35 offset:18688
v_mfma_f32_16x16x32_bf16 v[164:167], a[144:147], a[220:223], v[164:167]
s_waitcnt lgkmcnt(5)
buffer_load_dwordx4 v19, s[16:19], s30 offen offset:3072 nt lds
v_mfma_f32_16x16x32_bf16 v[172:175], a[148:151], a[220:223], v[172:175]
v_mfma_f32_16x16x32_bf16 v[168:171], a[148:151], a[216:219], v[168:171]
v_mfma_f32_16x16x32_bf16 v[176:179], a[152:155], a[216:219], v[176:179]
v_mfma_f32_16x16x32_bf16 v[180:183], a[152:155], a[220:223], v[180:183]
v_mfma_f32_16x16x32_bf16 v[188:191], a[156:159], a[220:223], v[188:191]
v_mfma_f32_16x16x32_bf16 v[184:187], a[156:159], a[216:219], v[184:187]
s_waitcnt vmcnt(8) lgkmcnt(0)
s_barrier
ds_read_b128 a[192:195], v36 offset:0
ds_read_b128 a[196:199], v36 offset:2048
v_mfma_f32_16x16x32_bf16 v[192:195], a[160:163], a[216:219], v[192:195]
s_add_u32 m0, s28, 114688
s_add_u32 s29, s29, 16384
ds_read_b128 a[200:203], v37 offset:0
ds_read_b128 a[204:207], v37 offset:2048
v_mfma_f32_16x16x32_bf16 v[196:199], a[160:163], a[220:223], v[196:199]
buffer_load_dwordx4 v12, s[12:15], s29 offen nt lds
v_mfma_f32_16x16x32_bf16 v[204:207], a[164:167], a[220:223], v[204:207]
ds_read_b64_tr_b16 a[64:65], v28 offset:32768
v_mfma_f32_16x16x32_bf16 v[200:203], a[164:167], a[216:219], v[200:203]
ds_read_b64_tr_b16 a[66:67], v28 offset:34816
v_mfma_f32_16x16x32_bf16 v[208:211], a[168:171], a[216:219], v[208:211]
ds_read_b64_tr_b16 a[68:69], v28 offset:49152
v_mfma_f32_16x16x32_bf16 v[212:215], a[168:171], a[220:223], v[212:215]
ds_read_b64_tr_b16 a[70:71], v28 offset:51200
v_mfma_f32_16x16x32_bf16 v[220:223], a[172:175], a[220:223], v[220:223]
ds_read_b64_tr_b16 a[72:73], v29 offset:32768
v_mfma_f32_16x16x32_bf16 v[216:219], a[172:175], a[216:219], v[216:219]
buffer_load_dwordx4 v13, s[12:15], s29 offen offset:1024 nt lds
v_mfma_f32_16x16x32_bf16 v[224:227], a[176:179], a[216:219], v[224:227]
ds_read_b64_tr_b16 a[74:75], v29 offset:34816
ds_read_b64_tr_b16 a[76:77], v29 offset:49152
v_mfma_f32_16x16x32_bf16 v[228:231], a[176:179], a[220:223], v[228:231]
ds_read_b64_tr_b16 a[78:79], v29 offset:51200
ds_read_b64_tr_b16 a[80:81], v30 offset:32768
v_mfma_f32_16x16x32_bf16 v[236:239], a[180:183], a[220:223], v[236:239]
ds_read_b64_tr_b16 a[82:83], v30 offset:34816
v_mfma_f32_16x16x32_bf16 v[232:235], a[180:183], a[216:219], v[232:235]
ds_read_b64_tr_b16 a[84:85], v30 offset:49152
ds_read_b64_tr_b16 a[86:87], v30 offset:51200
v_mfma_f32_16x16x32_bf16 v[240:243], a[184:187], a[216:219], v[240:243]
buffer_load_dwordx4 v14, s[12:15], s29 offen offset:2048 nt lds
v_mfma_f32_16x16x32_bf16 v[244:247], a[184:187], a[220:223], v[244:247]
ds_read_b64_tr_b16 a[88:89], v31 offset:32768
ds_read_b64_tr_b16 a[90:91], v31 offset:34816
v_mfma_f32_16x16x32_bf16 v[252:255], a[188:191], a[220:223], v[252:255]
ds_read_b64_tr_b16 a[92:93], v31 offset:49152
v_mfma_f32_16x16x32_bf16 v[248:251], a[188:191], a[216:219], v[248:251]
s_waitcnt lgkmcnt(6)
ds_read_b64_tr_b16 a[94:95], v31 offset:51200
ds_read_b64_tr_b16 a[96:97], v32 offset:32768
v_mfma_f32_16x16x32_bf16 v[128:131], a[64:67], a[192:195], v[128:131]
ds_read_b64_tr_b16 a[98:99], v32 offset:34816
v_mfma_f32_16x16x32_bf16 v[128:131], a[68:71], a[200:203], v[128:131]
buffer_load_dwordx4 v15, s[12:15], s29 offen offset:3072 nt lds
v_mfma_f32_16x16x32_bf16 v[132:135], a[68:71], a[204:207], v[132:135]
ds_read_b64_tr_b16 a[100:101], v32 offset:49152
ds_read_b64_tr_b16 a[102:103], v32 offset:51200
v_mfma_f32_16x16x32_bf16 v[132:135], a[64:67], a[196:199], v[132:135]
ds_read_b64_tr_b16 a[104:105], v33 offset:32768
ds_read_b64_tr_b16 a[106:107], v33 offset:34816
v_mfma_f32_16x16x32_bf16 v[140:143], a[72:75], a[196:199], v[140:143]
ds_read_b64_tr_b16 a[108:109], v33 offset:49152
v_mfma_f32_16x16x32_bf16 v[140:143], a[76:79], a[204:207], v[140:143]
s_add_u32 m0, s28, 49152
s_add_u32 s30, s30, 16384
ds_read_b64_tr_b16 a[110:111], v33 offset:51200
v_mfma_f32_16x16x32_bf16 v[136:139], a[76:79], a[200:203], v[136:139]
buffer_load_dwordx4 v16, s[16:19], s30 offen nt lds
v_mfma_f32_16x16x32_bf16 v[136:139], a[72:75], a[192:195], v[136:139]
s_waitcnt lgkmcnt(6)
ds_read_b64_tr_b16 a[112:113], v34 offset:32768
ds_read_b64_tr_b16 a[114:115], v34 offset:34816
v_mfma_f32_16x16x32_bf16 v[144:147], a[80:83], a[192:195], v[144:147]
ds_read_b64_tr_b16 a[116:117], v34 offset:49152
ds_read_b64_tr_b16 a[118:119], v34 offset:51200
v_mfma_f32_16x16x32_bf16 v[144:147], a[84:87], a[200:203], v[144:147]
ds_read_b64_tr_b16 a[120:121], v35 offset:32768
v_mfma_f32_16x16x32_bf16 v[148:151], a[84:87], a[204:207], v[148:151]
ds_read_b64_tr_b16 a[122:123], v35 offset:34816
v_mfma_f32_16x16x32_bf16 v[148:151], a[80:83], a[196:199], v[148:151]
ds_read_b64_tr_b16 a[124:125], v35 offset:49152
v_mul_f32 v128, s36, v128
v_mfma_f32_16x16x32_bf16 v[156:159], a[88:91], a[196:199], v[156:159]
ds_read_b64_tr_b16 a[126:127], v35 offset:51200
v_mul_f32 v132, s36, v132
v_mfma_f32_16x16x32_bf16 v[156:159], a[92:95], a[204:207], v[156:159]
ds_read_b64_tr_b16 a[128:129], v28 offset:33024
v_mul_f32 v129, s36, v129
v_mfma_f32_16x16x32_bf16 v[152:155], a[92:95], a[200:203], v[152:155]
buffer_load_dwordx4 v17, s[16:19], s30 offen offset:1024 nt lds
v_mfma_f32_16x16x32_bf16 v[152:155], a[88:91], a[192:195], v[152:155]
ds_read_b64_tr_b16 a[130:131], v28 offset:35072
v_mul_f32 v133, s36, v133
v_mfma_f32_16x16x32_bf16 v[160:163], a[96:99], a[192:195], v[160:163]
s_waitcnt lgkmcnt(4)
ds_read_b64_tr_b16 a[132:133], v28 offset:49408
v_mul_f32 v130, s36, v130
v_mfma_f32_16x16x32_bf16 v[160:163], a[100:103], a[200:203], v[160:163]
ds_read_b64_tr_b16 a[134:135], v28 offset:51456
v_mul_f32 v134, s36, v134
v_mfma_f32_16x16x32_bf16 v[164:167], a[100:103], a[204:207], v[164:167]
ds_read_b64_tr_b16 a[136:137], v29 offset:33024
v_mul_f32 v131, s36, v131
v_mfma_f32_16x16x32_bf16 v[164:167], a[96:99], a[196:199], v[164:167]
ds_read_b64_tr_b16 a[138:139], v29 offset:35072
v_mul_f32 v135, s36, v135
v_mfma_f32_16x16x32_bf16 v[172:175], a[104:107], a[196:199], v[172:175]
buffer_load_dwordx4 v18, s[16:19], s30 offen offset:2048 nt lds
v_mfma_f32_16x16x32_bf16 v[172:175], a[108:111], a[204:207], v[172:175]
ds_read_b64_tr_b16 a[140:141], v29 offset:49408
v_cvt_pk_bf16_f32 v56, v128, v129
v_mfma_f32_16x16x32_bf16 v[168:171], a[108:111], a[200:203], v[168:171]
ds_read_b64_tr_b16 a[142:143], v29 offset:51456
ds_read_b64_tr_b16 a[144:145], v30 offset:33024
v_mfma_f32_16x16x32_bf16 v[168:171], a[104:107], a[192:195], v[168:171]
ds_read_b64_tr_b16 a[146:147], v30 offset:35072
v_cvt_pk_bf16_f32 v60, v132, v133
v_mfma_f32_16x16x32_bf16 v[176:179], a[112:115], a[192:195], v[176:179]
ds_read_b64_tr_b16 a[148:149], v30 offset:49408
v_cvt_pk_bf16_f32 v57, v130, v131
v_mfma_f32_16x16x32_bf16 v[176:179], a[116:119], a[200:203], v[176:179]
buffer_load_dwordx4 v19, s[16:19], s30 offen offset:3072 nt lds
v_mfma_f32_16x16x32_bf16 v[180:183], a[116:119], a[204:207], v[180:183]
ds_read_b64_tr_b16 a[150:151], v30 offset:51456
ds_read_b64_tr_b16 a[152:153], v31 offset:33024
v_mfma_f32_16x16x32_bf16 v[180:183], a[112:115], a[196:199], v[180:183]
ds_read_b64_tr_b16 a[154:155], v31 offset:35072
ds_read_b64_tr_b16 a[156:157], v31 offset:49408
v_cvt_pk_bf16_f32 v61, v134, v135
v_mul_f32 v136, s36, v136
v_mul_f32 v140, s36, v140
v_mul_f32 v137, s36, v137
v_mul_f32 v141, s36, v141
v_mul_f32 v138, s36, v138
v_mul_f32 v142, s36, v142
v_mul_f32 v139, s36, v139
v_mul_f32 v143, s36, v143
v_cvt_pk_bf16_f32 v58, v136, v137
v_cvt_pk_bf16_f32 v62, v140, v141
v_cvt_pk_bf16_f32 v59, v138, v139
v_cvt_pk_bf16_f32 v63, v142, v143
v_permlane32_swap_b32 v56, v58
v_mul_f32 v144, s36, v144
v_permlane32_swap_b32 v60, v62
v_mul_f32 v148, s36, v148
v_mul_f32 v145, s36, v145
v_permlane32_swap_b32 v57, v59
v_mul_f32 v149, s36, v149
v_mul_f32 v146, s36, v146
v_permlane32_swap_b32 v61, v63
v_mul_f32 v150, s36, v150
v_mul_f32 v147, s36, v147
v_permlane16_swap_b32 v56, v58
v_mul_f32 v151, s36, v151
v_cvt_pk_bf16_f32 v48, v144, v145
v_permlane16_swap_b32 v60, v62
v_cvt_pk_bf16_f32 v52, v148, v149
v_cvt_pk_bf16_f32 v49, v146, v147
v_permlane16_swap_b32 v57, v59
v_cvt_pk_bf16_f32 v53, v150, v151
v_mul_f32 v152, s36, v152
v_permlane16_swap_b32 v61, v63
v_mul_f32 v156, s36, v156
v_mul_f32 v153, s36, v153
v_accvgpr_write_b32 a0, v56
v_mul_f32 v157, s36, v157
v_accvgpr_write_b32 a4, v60
v_mul_f32 v154, s36, v154
v_accvgpr_write_b32 a1, v57
v_mul_f32 v158, s36, v158
v_accvgpr_write_b32 a5, v61
v_mul_f32 v155, s36, v155
v_accvgpr_write_b32 a2, v58
v_mul_f32 v159, s36, v159
v_accvgpr_write_b32 a6, v62
v_cvt_pk_bf16_f32 v50, v152, v153
v_accvgpr_write_b32 a3, v59
v_cvt_pk_bf16_f32 v54, v156, v157
v_accvgpr_write_b32 a7, v63
v_mfma_f32_16x16x32_bf16 v[188:191], a[120:123], a[196:199], v[188:191]
s_waitcnt lgkmcnt(6)
ds_read_b64_tr_b16 a[158:159], v31 offset:51456
v_cvt_pk_bf16_f32 v51, v154, v155
v_mfma_f32_16x16x32_bf16 v[188:191], a[124:127], a[204:207], v[188:191]
ds_read_b64_tr_b16 a[160:161], v32 offset:33024
v_cvt_pk_bf16_f32 v55, v158, v159
v_mfma_f32_16x16x32_bf16 v[184:187], a[124:127], a[200:203], v[184:187]
ds_read_b64_tr_b16 a[162:163], v32 offset:35072
ds_read_b64_tr_b16 a[164:165], v32 offset:49408
v_mfma_f32_16x16x32_bf16 v[184:187], a[120:123], a[192:195], v[184:187]
ds_read_b64_tr_b16 a[166:167], v32 offset:51456
ds_read_b64_tr_b16 a[168:169], v33 offset:33024
v_mfma_f32_16x16x32_bf16 v[192:195], a[128:131], a[192:195], v[192:195]
ds_read_b64_tr_b16 a[170:171], v33 offset:35072
ds_read_b64_tr_b16 a[172:173], v33 offset:49408
v_mfma_f32_16x16x32_bf16 v[192:195], a[132:135], a[200:203], v[192:195]
ds_read_b64_tr_b16 a[174:175], v33 offset:51456
ds_read_b64_tr_b16 a[176:177], v34 offset:33024
v_mfma_f32_16x16x32_bf16 v[196:199], a[132:135], a[204:207], v[196:199]
v_permlane32_swap_b32 v48, v50
v_mfma_f32_16x16x32_bf16 v[196:199], a[128:131], a[196:199], v[196:199]
ds_read_b64_tr_b16 a[178:179], v34 offset:35072
v_mul_f32 v160, s36, v160
v_permlane32_swap_b32 v52, v54
v_mul_f32 v164, s36, v164
v_mul_f32 v161, s36, v161
v_permlane32_swap_b32 v49, v51
v_mul_f32 v165, s36, v165
v_mul_f32 v162, s36, v162
v_permlane32_swap_b32 v53, v55
v_mul_f32 v166, s36, v166
v_mul_f32 v163, s36, v163
v_permlane16_swap_b32 v48, v50
v_mul_f32 v167, s36, v167
v_cvt_pk_bf16_f32 v56, v160, v161
v_permlane16_swap_b32 v52, v54
v_cvt_pk_bf16_f32 v60, v164, v165
v_cvt_pk_bf16_f32 v57, v162, v163
v_permlane16_swap_b32 v49, v51
v_cvt_pk_bf16_f32 v61, v166, v167
v_mul_f32 v168, s36, v168
v_permlane16_swap_b32 v53, v55
v_mul_f32 v172, s36, v172
v_mul_f32 v169, s36, v169
v_accvgpr_write_b32 a8, v48
v_mul_f32 v173, s36, v173
v_accvgpr_write_b32 a12, v52
v_mul_f32 v170, s36, v170
v_accvgpr_write_b32 a9, v49
v_mul_f32 v174, s36, v174
v_accvgpr_write_b32 a13, v53
v_mul_f32 v171, s36, v171
v_accvgpr_write_b32 a10, v50
v_mul_f32 v175, s36, v175
v_accvgpr_write_b32 a14, v54
v_cvt_pk_bf16_f32 v58, v168, v169
v_accvgpr_write_b32 a11, v51
v_cvt_pk_bf16_f32 v62, v172, v173
v_accvgpr_write_b32 a15, v55
v_mfma_f32_16x16x32_bf16 v[204:207], a[136:139], a[196:199], v[204:207]
ds_read_b64_tr_b16 a[180:181], v34 offset:49408
v_cvt_pk_bf16_f32 v59, v170, v171
v_mfma_f32_16x16x32_bf16 v[204:207], a[140:143], a[204:207], v[204:207]
ds_read_b64_tr_b16 a[182:183], v34 offset:51456
v_cvt_pk_bf16_f32 v63, v174, v175
v_mfma_f32_16x16x32_bf16 v[200:203], a[140:143], a[200:203], v[200:203]
ds_read_b64_tr_b16 a[184:185], v35 offset:33024
ds_read_b64_tr_b16 a[186:187], v35 offset:35072
v_mfma_f32_16x16x32_bf16 v[200:203], a[136:139], a[192:195], v[200:203]
s_waitcnt lgkmcnt(5)
ds_read_b64_tr_b16 a[188:189], v35 offset:49408
ds_read_b64_tr_b16 a[190:191], v35 offset:51456
v_mfma_f32_16x16x32_bf16 v[208:211], a[144:147], a[192:195], v[208:211]
v_permlane32_swap_b32 v56, v58
v_mfma_f32_16x16x32_bf16 v[208:211], a[148:151], a[200:203], v[208:211]
v_mul_f32 v176, s36, v176
v_mfma_f32_16x16x32_bf16 v[212:215], a[148:151], a[204:207], v[212:215]
v_permlane32_swap_b32 v60, v62
v_mfma_f32_16x16x32_bf16 v[212:215], a[144:147], a[196:199], v[212:215]
v_mul_f32 v180, s36, v180
v_mul_f32 v177, s36, v177
v_permlane32_swap_b32 v57, v59
v_mul_f32 v181, s36, v181
v_mul_f32 v178, s36, v178
v_permlane32_swap_b32 v61, v63
v_mul_f32 v182, s36, v182
v_mul_f32 v179, s36, v179
v_permlane16_swap_b32 v56, v58
v_mul_f32 v183, s36, v183
v_cvt_pk_bf16_f32 v48, v176, v177
v_permlane16_swap_b32 v60, v62
v_cvt_pk_bf16_f32 v52, v180, v181
v_cvt_pk_bf16_f32 v49, v178, v179
v_permlane16_swap_b32 v57, v59
v_cvt_pk_bf16_f32 v53, v182, v183
v_mul_f32 v184, s36, v184
v_permlane16_swap_b32 v61, v63
v_mul_f32 v188, s36, v188
v_mul_f32 v185, s36, v185
v_accvgpr_write_b32 a16, v56
v_mul_f32 v189, s36, v189
v_accvgpr_write_b32 a20, v60
v_mul_f32 v186, s36, v186
v_accvgpr_write_b32 a17, v57
v_mul_f32 v190, s36, v190
v_accvgpr_write_b32 a21, v61
v_mul_f32 v187, s36, v187
v_accvgpr_write_b32 a18, v58
v_mul_f32 v191, s36, v191
v_accvgpr_write_b32 a22, v62
v_cvt_pk_bf16_f32 v50, v184, v185
v_accvgpr_write_b32 a19, v59
v_cvt_pk_bf16_f32 v54, v188, v189
v_accvgpr_write_b32 a23, v63
v_mfma_f32_16x16x32_bf16 v[220:223], a[152:155], a[196:199], v[220:223]
v_cvt_pk_bf16_f32 v51, v186, v187
v_cvt_pk_bf16_f32 v55, v190, v191
v_mfma_f32_16x16x32_bf16 v[220:223], a[156:159], a[204:207], v[220:223]
v_permlane32_swap_b32 v48, v50
v_mfma_f32_16x16x32_bf16 v[216:219], a[156:159], a[200:203], v[216:219]
v_mul_f32 v192, s36, v192
v_mfma_f32_16x16x32_bf16 v[216:219], a[152:155], a[192:195], v[216:219]
s_waitcnt vmcnt(12) lgkmcnt(0)
s_barrier
v_permlane32_swap_b32 v52, v54
v_mfma_f32_16x16x32_bf16 v[224:227], a[160:163], a[192:195], v[224:227]
v_mul_f32 v196, s36, v196
v_mul_f32 v193, s36, v193
v_mfma_f32_16x16x32_bf16 v[224:227], a[164:167], a[200:203], v[224:227]
ds_read_b128 a[64:67], v0 offset:0
ds_read_b128 a[68:71], v1 offset:0
v_mfma_f32_16x16x32_bf16 v[228:231], a[164:167], a[204:207], v[228:231]
v_permlane32_swap_b32 v49, v51
v_mfma_f32_16x16x32_bf16 v[228:231], a[160:163], a[196:199], v[228:231]
v_mul_f32 v197, s36, v197
v_mul_f32 v194, s36, v194
v_permlane32_swap_b32 v53, v55
v_mul_f32 v198, s36, v198
v_mul_f32 v195, s36, v195
v_permlane16_swap_b32 v48, v50
v_mul_f32 v199, s36, v199
v_cvt_pk_bf16_f32 v56, v192, v193
v_permlane16_swap_b32 v52, v54
v_cvt_pk_bf16_f32 v60, v196, v197
v_cvt_pk_bf16_f32 v57, v194, v195
v_permlane16_swap_b32 v49, v51
v_cvt_pk_bf16_f32 v61, v198, v199
v_mul_f32 v200, s36, v200
v_permlane16_swap_b32 v53, v55
v_mul_f32 v204, s36, v204
v_mul_f32 v201, s36, v201
v_accvgpr_write_b32 a24, v48
v_mul_f32 v205, s36, v205
v_accvgpr_write_b32 a28, v52
v_mul_f32 v202, s36, v202
v_accvgpr_write_b32 a25, v49
v_mul_f32 v206, s36, v206
v_accvgpr_write_b32 a29, v53
v_mul_f32 v203, s36, v203
v_accvgpr_write_b32 a26, v50
v_mul_f32 v207, s36, v207
v_accvgpr_write_b32 a30, v54
v_cvt_pk_bf16_f32 v58, v200, v201
v_accvgpr_write_b32 a27, v51
v_cvt_pk_bf16_f32 v62, v204, v205
v_accvgpr_write_b32 a31, v55
v_mfma_f32_16x16x32_bf16 v[236:239], a[168:171], a[196:199], v[236:239]
s_add_u32 m0, s28, 131072
s_add_u32 s29, s29, 16384
ds_read_b128 a[72:75], v0 offset:8192
v_cvt_pk_bf16_f32 v59, v202, v203
v_mfma_f32_16x16x32_bf16 v[236:239], a[172:175], a[204:207], v[236:239]
buffer_load_dwordx4 v12, s[12:15], s29 offen nt lds
v_mfma_f32_16x16x32_bf16 v[232:235], a[172:175], a[200:203], v[232:235]
ds_read_b128 a[76:79], v1 offset:8192
v_cvt_pk_bf16_f32 v63, v206, v207
v_mfma_f32_16x16x32_bf16 v[232:235], a[168:171], a[192:195], v[232:235]
ds_read_b128 a[80:83], v2 offset:0
ds_read_b128 a[84:87], v3 offset:0
v_mfma_f32_16x16x32_bf16 v[240:243], a[176:179], a[192:195], v[240:243]
buffer_load_dwordx4 v13, s[12:15], s29 offen offset:1024 nt lds
v_mfma_f32_16x16x32_bf16 v[240:243], a[180:183], a[200:203], v[240:243]
v_permlane32_swap_b32 v56, v58
v_mfma_f32_16x16x32_bf16 v[244:247], a[180:183], a[204:207], v[244:247]
ds_read_b128 a[88:91], v2 offset:8192
v_mul_f32 v208, s36, v208
v_mfma_f32_16x16x32_bf16 v[244:247], a[176:179], a[196:199], v[244:247]
buffer_load_dwordx4 v14, s[12:15], s29 offen offset:2048 nt lds
v_permlane32_swap_b32 v60, v62
v_mul_f32 v212, s36, v212
v_mul_f32 v209, s36, v209
v_permlane32_swap_b32 v57, v59
v_mul_f32 v213, s36, v213
v_mul_f32 v210, s36, v210
v_permlane32_swap_b32 v61, v63
v_mul_f32 v214, s36, v214
v_mul_f32 v211, s36, v211
v_permlane16_swap_b32 v56, v58
v_mul_f32 v215, s36, v215
v_cvt_pk_bf16_f32 v48, v208, v209
v_permlane16_swap_b32 v60, v62
v_cvt_pk_bf16_f32 v52, v212, v213
v_cvt_pk_bf16_f32 v49, v210, v211
v_permlane16_swap_b32 v57, v59
v_cvt_pk_bf16_f32 v53, v214, v215
v_mul_f32 v216, s36, v216
v_permlane16_swap_b32 v61, v63
v_mul_f32 v220, s36, v220
v_mul_f32 v217, s36, v217
v_accvgpr_write_b32 a32, v56
v_mul_f32 v221, s36, v221
v_accvgpr_write_b32 a36, v60
v_mul_f32 v218, s36, v218
v_accvgpr_write_b32 a33, v57
v_mul_f32 v222, s36, v222
v_accvgpr_write_b32 a37, v61
v_mul_f32 v219, s36, v219
v_accvgpr_write_b32 a34, v58
v_mul_f32 v223, s36, v223
v_accvgpr_write_b32 a38, v62
v_cvt_pk_bf16_f32 v50, v216, v217
v_accvgpr_write_b32 a35, v59
v_cvt_pk_bf16_f32 v54, v220, v221
v_accvgpr_write_b32 a39, v63
v_mfma_f32_16x16x32_bf16 v[252:255], a[184:187], a[196:199], v[252:255]
ds_read_b128 a[92:95], v3 offset:8192
v_cvt_pk_bf16_f32 v51, v218, v219
v_mfma_f32_16x16x32_bf16 v[252:255], a[188:191], a[204:207], v[252:255]
ds_read_b128 a[96:99], v0 offset:256
v_cvt_pk_bf16_f32 v55, v222, v223
v_mfma_f32_16x16x32_bf16 v[248:251], a[188:191], a[200:203], v[248:251]
v_permlane32_swap_b32 v48, v50
v_mfma_f32_16x16x32_bf16 v[248:251], a[184:187], a[192:195], v[248:251]
s_waitcnt lgkmcnt(3)
ds_read_b128 a[100:103], v1 offset:256
v_mul_f32 v224, s36, v224
v_mfma_f32_16x16x32_bf16 v[96:99], a[64:67], a[0:3], 0
buffer_load_dwordx4 v15, s[12:15], s29 offen offset:3072 nt lds
v_mfma_f32_16x16x32_bf16 v[96:99], a[68:71], a[8:11], v[96:99]
s_add_u32 m0, s28, 147456
s_add_u32 s29, s29, 16384
ds_read_b128 a[104:107], v0 offset:8448
ds_read_b128 a[108:111], v1 offset:8448
v_mfma_f32_16x16x32_bf16 v[100:103], a[68:71], a[12:15], 0
buffer_load_dwordx4 v12, s[12:15], s29 offen nt lds
v_mfma_f32_16x16x32_bf16 v[100:103], a[64:67], a[4:7], v[100:103]
ds_read_b128 a[112:115], v2 offset:256
ds_read_b128 a[116:119], v3 offset:256
v_permlane32_swap_b32 v52, v54
v_mul_f32 v228, s36, v228
v_mul_f32 v225, s36, v225
v_permlane32_swap_b32 v49, v51
v_mul_f32 v229, s36, v229
v_mul_f32 v226, s36, v226
v_permlane32_swap_b32 v53, v55
v_mul_f32 v230, s36, v230
v_mul_f32 v227, s36, v227
v_permlane16_swap_b32 v48, v50
v_mul_f32 v231, s36, v231
v_cvt_pk_bf16_f32 v56, v224, v225
v_permlane16_swap_b32 v52, v54
v_cvt_pk_bf16_f32 v60, v228, v229
v_cvt_pk_bf16_f32 v57, v226, v227
v_permlane16_swap_b32 v49, v51
v_cvt_pk_bf16_f32 v61, v230, v231
v_mul_f32 v232, s36, v232
v_permlane16_swap_b32 v53, v55
v_mul_f32 v236, s36, v236
v_mul_f32 v233, s36, v233
v_accvgpr_write_b32 a40, v48
v_mul_f32 v237, s36, v237
v_accvgpr_write_b32 a44, v52
v_mul_f32 v234, s36, v234
v_accvgpr_write_b32 a41, v49
v_mul_f32 v238, s36, v238
v_accvgpr_write_b32 a45, v53
v_mul_f32 v235, s36, v235
v_accvgpr_write_b32 a42, v50
v_mul_f32 v239, s36, v239
v_accvgpr_write_b32 a46, v54
v_cvt_pk_bf16_f32 v58, v232, v233
v_accvgpr_write_b32 a43, v51
v_cvt_pk_bf16_f32 v62, v236, v237
v_accvgpr_write_b32 a47, v55
v_mfma_f32_16x16x32_bf16 v[104:107], a[72:75], a[0:3], 0
v_cvt_pk_bf16_f32 v59, v234, v235
v_cvt_pk_bf16_f32 v63, v238, v239
v_mfma_f32_16x16x32_bf16 v[104:107], a[76:79], a[8:11], v[104:107]
v_permlane32_swap_b32 v56, v58
v_mfma_f32_16x16x32_bf16 v[108:111], a[76:79], a[12:15], 0
buffer_load_dwordx4 v13, s[12:15], s29 offen offset:1024 nt lds
v_mfma_f32_16x16x32_bf16 v[108:111], a[72:75], a[4:7], v[108:111]
ds_read_b128 a[120:123], v2 offset:8448
ds_read_b128 a[124:127], v3 offset:8448
v_mfma_f32_16x16x32_bf16 v[96:99], a[80:83], a[16:19], v[96:99]
buffer_load_dwordx4 v14, s[12:15], s29 offen offset:2048 nt lds
v_mfma_f32_16x16x32_bf16 v[96:99], a[84:87], a[24:27], v[96:99]
v_mul_f32 v240, s36, v240
v_mfma_f32_16x16x32_bf16 v[100:103], a[84:87], a[28:31], v[100:103]
v_permlane32_swap_b32 v60, v62
v_mfma_f32_16x16x32_bf16 v[100:103], a[80:83], a[20:23], v[100:103]
s_waitcnt lgkmcnt(2)
v_mul_f32 v244, s36, v244
v_mul_f32 v241, s36, v241
v_permlane32_swap_b32 v57, v59
v_mul_f32 v245, s36, v245
v_mul_f32 v242, s36, v242
v_permlane32_swap_b32 v61, v63
v_mul_f32 v246, s36, v246
v_mul_f32 v243, s36, v243
v_permlane16_swap_b32 v56, v58
v_mul_f32 v247, s36, v247
v_cvt_pk_bf16_f32 v48, v240, v241
v_permlane16_swap_b32 v60, v62
v_cvt_pk_bf16_f32 v52, v244, v245
v_cvt_pk_bf16_f32 v49, v242, v243
v_permlane16_swap_b32 v57, v59
v_cvt_pk_bf16_f32 v53, v246, v247
v_mul_f32 v248, s36, v248
v_permlane16_swap_b32 v61, v63
v_mul_f32 v252, s36, v252
v_mul_f32 v249, s36, v249
v_accvgpr_write_b32 a48, v56
v_mul_f32 v253, s36, v253
v_accvgpr_write_b32 a52, v60
v_mul_f32 v250, s36, v250
v_accvgpr_write_b32 a49, v57
v_mul_f32 v254, s36, v254
v_accvgpr_write_b32 a53, v61
v_mul_f32 v251, s36, v251
v_accvgpr_write_b32 a50, v58
v_mul_f32 v255, s36, v255
v_accvgpr_write_b32 a54, v62
v_cvt_pk_bf16_f32 v50, v248, v249
v_accvgpr_write_b32 a51, v59
v_cvt_pk_bf16_f32 v54, v252, v253
v_accvgpr_write_b32 a55, v63
v_mfma_f32_16x16x32_bf16 v[104:107], a[88:91], a[16:19], v[104:107]
v_cvt_pk_bf16_f32 v51, v250, v251
v_cvt_pk_bf16_f32 v55, v254, v255
v_mfma_f32_16x16x32_bf16 v[104:107], a[92:95], a[24:27], v[104:107]
buffer_load_dwordx4 v15, s[12:15], s29 offen offset:3072 nt lds
v_mfma_f32_16x16x32_bf16 v[108:111], a[92:95], a[28:31], v[108:111]
v_permlane32_swap_b32 v48, v50
v_mfma_f32_16x16x32_bf16 v[108:111], a[88:91], a[20:23], v[108:111]
s_waitcnt vmcnt(12) lgkmcnt(0)
s_barrier
v_permlane32_swap_b32 v52, v54
v_mfma_f32_16x16x32_bf16 v[96:99], a[96:99], a[32:35], v[96:99]
v_permlane32_swap_b32 v49, v51
v_mfma_f32_16x16x32_bf16 v[96:99], a[100:103], a[40:43], v[96:99]
ds_read_b128 a[128:131], v0 offset:16384
ds_read_b128 a[132:135], v1 offset:16384
v_mfma_f32_16x16x32_bf16 v[100:103], a[100:103], a[44:47], v[100:103]
v_permlane32_swap_b32 v53, v55
v_mfma_f32_16x16x32_bf16 v[100:103], a[96:99], a[36:39], v[100:103]
v_permlane16_swap_b32 v48, v50
v_permlane16_swap_b32 v52, v54
v_permlane16_swap_b32 v49, v51
v_permlane16_swap_b32 v53, v55
v_accvgpr_write_b32 a56, v48
v_accvgpr_write_b32 a60, v52
v_accvgpr_write_b32 a57, v49
v_accvgpr_write_b32 a61, v53
v_accvgpr_write_b32 a58, v50
v_accvgpr_write_b32 a62, v54
v_accvgpr_write_b32 a59, v51
v_accvgpr_write_b32 a63, v55
v_mfma_f32_16x16x32_bf16 v[104:107], a[104:107], a[32:35], v[104:107]
s_add_u32 m0, s28, 98304
s_add_u32 s29, s29, 16384
ds_read_b128 a[136:139], v2 offset:16384
ds_read_b128 a[140:143], v3 offset:16384
v_mfma_f32_16x16x32_bf16 v[104:107], a[108:111], a[40:43], v[104:107]
buffer_load_dwordx4 v12, s[12:15], s29 offen nt lds
v_mfma_f32_16x16x32_bf16 v[108:111], a[108:111], a[44:47], v[108:111]
ds_read_b128 a[144:147], v0 offset:16640
ds_read_b128 a[148:151], v1 offset:16640
v_mfma_f32_16x16x32_bf16 v[108:111], a[104:107], a[36:39], v[108:111]
buffer_load_dwordx4 v13, s[12:15], s29 offen offset:1024 nt lds
v_mfma_f32_16x16x32_bf16 v[96:99], a[112:115], a[48:51], v[96:99]
ds_read_b128 a[152:155], v2 offset:16640
v_accvgpr_read_b32 v20, a224
v_mfma_f32_16x16x32_bf16 v[96:99], a[116:119], a[56:59], v[96:99]
ds_read_b128 a[156:159], v3 offset:16640
v_accvgpr_read_b32 v21, a225
v_mfma_f32_16x16x32_bf16 v[100:103], a[116:119], a[60:63], v[100:103]
buffer_load_dwordx4 v14, s[12:15], s29 offen offset:2048 nt lds
v_mfma_f32_16x16x32_bf16 v[100:103], a[112:115], a[52:55], v[100:103]
v_accvgpr_read_b32 v22, a226
v_accvgpr_read_b32 v23, a227
v_mfma_f32_16x16x32_bf16 v[104:107], a[120:123], a[48:51], v[104:107]
ds_read_b128 a[160:163], v0 offset:24576
v_accvgpr_read_b32 v28, a228
v_mfma_f32_16x16x32_bf16 v[104:107], a[124:127], a[56:59], v[104:107]
ds_read_b128 a[164:167], v1 offset:24576
v_accvgpr_read_b32 v29, a229
v_mfma_f32_16x16x32_bf16 v[108:111], a[124:127], a[60:63], v[108:111]
v_accvgpr_read_b32 v30, a230
v_accvgpr_read_b32 v31, a231
v_mfma_f32_16x16x32_bf16 v[108:111], a[120:123], a[52:55], v[108:111]
s_waitcnt lgkmcnt(2)
buffer_load_dwordx4 v15, s[12:15], s29 offen offset:3072 nt lds
v_mfma_f32_16x16x32_bf16 v[112:115], a[128:131], a[0:3], 0
ds_read_b128 a[168:171], v2 offset:24576
v_accvgpr_read_b32 v32, a232
v_mfma_f32_16x16x32_bf16 v[112:115], a[132:135], a[8:11], v[112:115]
s_add_u32 m0, s28, 65536
s_add_u32 s30, s30, 16384
ds_read_b128 a[172:175], v3 offset:24576
v_accvgpr_read_b32 v33, a233
v_mfma_f32_16x16x32_bf16 v[112:115], a[136:139], a[16:19], v[112:115]
buffer_load_dwordx4 v16, s[16:19], s30 offen nt lds
v_accvgpr_read_b32 v34, a234
v_mfma_f32_16x16x32_bf16 v[112:115], a[140:143], a[24:27], v[112:115]
ds_read_b128 a[176:179], v0 offset:24832
ds_read_b128 a[180:183], v1 offset:24832
v_mfma_f32_16x16x32_bf16 v[116:119], a[140:143], a[28:31], 0
v_max3_f32 v45, v96, v97, v98
v_max3_f32 v42, v100, v101, v102
v_mfma_f32_16x16x32_bf16 v[116:119], a[136:139], a[20:23], v[116:119]
v_max3_f32 v45, v45, v99, v104
v_max3_f32 v42, v42, v103, v108
v_mfma_f32_16x16x32_bf16 v[116:119], a[132:135], a[12:15], v[116:119]
buffer_load_dwordx4 v17, s[16:19], s30 offen offset:1024 nt lds
v_mfma_f32_16x16x32_bf16 v[116:119], a[128:131], a[4:7], v[116:119]
ds_read_b128 a[184:187], v2 offset:24832
ds_read_b128 a[188:191], v3 offset:24832
v_mfma_f32_16x16x32_bf16 v[112:115], a[144:147], a[32:35], v[112:115]
v_max3_f32 v45, v45, v105, v106
v_max3_f32 v42, v42, v109, v110
v_mfma_f32_16x16x32_bf16 v[112:115], a[148:151], a[40:43], v[112:115]
buffer_load_dwordx4 v18, s[16:19], s30 offen offset:2048 nt lds
v_mfma_f32_16x16x32_bf16 v[112:115], a[152:155], a[48:51], v[112:115]
v_max_f32 v45, v45, v107
v_max_f32 v42, v42, v111
v_mfma_f32_16x16x32_bf16 v[112:115], a[156:159], a[56:59], v[112:115]
v_mov_b32 v46, v45
v_mov_b32 v43, v42
v_mfma_f32_16x16x32_bf16 v[116:119], a[156:159], a[60:63], v[116:119]
v_permlane32_swap_b32 v45, v46
v_mfma_f32_16x16x32_bf16 v[116:119], a[152:155], a[52:55], v[116:119]
buffer_load_dwordx4 v19, s[16:19], s30 offen offset:3072 nt lds
v_mfma_f32_16x16x32_bf16 v[116:119], a[148:151], a[44:47], v[116:119]
v_permlane32_swap_b32 v42, v43
v_mfma_f32_16x16x32_bf16 v[116:119], a[144:147], a[36:39], v[116:119]
s_waitcnt vmcnt(12) lgkmcnt(0)
s_barrier
v_max_f32 v45, v45, v46
v_max_f32 v42, v42, v43
v_mfma_f32_16x16x32_bf16 v[120:123], a[160:163], a[0:3], 0
v_mov_b32 v46, v45
v_mov_b32 v43, v42
v_mfma_f32_16x16x32_bf16 v[120:123], a[164:167], a[8:11], v[120:123]
ds_read_b128 a[64:67], v0 offset:32768
ds_read_b64_tr_b16 a[68:69], v4 offset:0
v_mfma_f32_16x16x32_bf16 v[120:123], a[168:171], a[16:19], v[120:123]
v_permlane16_swap_b32 v45, v46
v_mfma_f32_16x16x32_bf16 v[120:123], a[172:175], a[24:27], v[120:123]
v_permlane16_swap_b32 v42, v43
v_mfma_f32_16x16x32_bf16 v[124:127], a[172:175], a[28:31], 0
ds_read_b64_tr_b16 a[70:71], v4 offset:8192
v_max_f32 v45, v45, v46
v_mfma_f32_16x16x32_bf16 v[124:127], a[168:171], a[20:23], v[124:127]
s_add_u32 m0, s28, 114688
s_add_u32 s29, s29, 16384
ds_read_b128 a[72:75], v1 offset:32768
ds_read_b64_tr_b16 a[76:77], v5 offset:0
v_mfma_f32_16x16x32_bf16 v[124:127], a[164:167], a[12:15], v[124:127]
buffer_load_dwordx4 v12, s[12:15], s29 offen nt lds
v_mfma_f32_16x16x32_bf16 v[124:127], a[160:163], a[4:7], v[124:127]
ds_read_b64_tr_b16 a[78:79], v5 offset:8192
v_max_f32 v42, v42, v43
v_mfma_f32_16x16x32_bf16 v[120:123], a[176:179], a[32:35], v[120:123]
ds_read_b128 a[80:83], v2 offset:32768
ds_read_b64_tr_b16 a[84:85], v6 offset:0
v_mfma_f32_16x16x32_bf16 v[120:123], a[180:183], a[40:43], v[120:123]
ds_read_b64_tr_b16 a[86:87], v6 offset:8192
v_sub_f32 v88, 0, v45
v_mfma_f32_16x16x32_bf16 v[120:123], a[184:187], a[48:51], v[120:123]
buffer_load_dwordx4 v13, s[12:15], s29 offen offset:1024 nt lds
v_mfma_f32_16x16x32_bf16 v[120:123], a[188:191], a[56:59], v[120:123]
ds_read_b128 a[88:91], v3 offset:32768
ds_read_b64_tr_b16 a[92:93], v7 offset:0
v_mfma_f32_16x16x32_bf16 v[124:127], a[188:191], a[60:63], v[124:127]
ds_read_b64_tr_b16 a[94:95], v7 offset:8192
v_sub_f32 v89, 0, v45
v_mfma_f32_16x16x32_bf16 v[124:127], a[184:187], a[52:55], v[124:127]
ds_read_b128 a[96:99], v0 offset:33024
v_sub_f32 v90, 0, v45
v_mfma_f32_16x16x32_bf16 v[124:127], a[180:183], a[44:47], v[124:127]
ds_read_b64_tr_b16 a[100:101], v8 offset:0
v_sub_f32 v91, 0, v45
v_mfma_f32_16x16x32_bf16 v[124:127], a[176:179], a[36:39], v[124:127]
s_waitcnt lgkmcnt(5)
buffer_load_dwordx4 v14, s[12:15], s29 offen offset:2048 nt lds
v_sub_f32 v92, 0, v42
v_sub_f32 v93, 0, v42
v_sub_f32 v94, 0, v42
v_sub_f32 v95, 0, v42
v_add_f32 v96, v88, v96
v_add_f32 v97, v88, v97
v_exp_f32 v48, v96
v_exp_f32 v49, v97
v_add_f32 v98, v88, v98
v_add_f32 v99, v88, v99
v_exp_f32 v50, v98
v_add_f32 v40, v48, v49
v_exp_f32 v51, v99
v_cvt_pk_bf16_f32 v72, v48, v49
v_add_f32 v104, v88, v104
v_add_f32 v105, v88, v105
v_exp_f32 v52, v104
v_add_f32 v40, v40, v50
v_exp_f32 v53, v105
v_add_f32 v40, v40, v51
v_cvt_pk_bf16_f32 v73, v50, v51
v_add_f32 v106, v88, v106
v_add_f32 v107, v88, v107
v_exp_f32 v54, v106
v_add_f32 v40, v40, v52
v_exp_f32 v55, v107
v_add_f32 v40, v40, v53
v_cvt_pk_bf16_f32 v74, v52, v53
v_add_f32 v100, v92, v100
v_add_f32 v101, v92, v101
v_exp_f32 v48, v100
v_add_f32 v40, v40, v54
v_exp_f32 v49, v101
v_add_f32 v40, v40, v55
v_cvt_pk_bf16_f32 v75, v54, v55
v_add_f32 v102, v92, v102
v_add_f32 v103, v92, v103
v_exp_f32 v50, v102
v_add_f32 v41, v48, v49
v_exp_f32 v51, v103
v_cvt_pk_bf16_f32 v76, v48, v49
v_add_f32 v108, v92, v108
v_add_f32 v109, v92, v109
v_exp_f32 v52, v108
v_add_f32 v41, v41, v50
v_exp_f32 v53, v109
v_add_f32 v41, v41, v51
v_cvt_pk_bf16_f32 v77, v50, v51
v_add_f32 v110, v92, v110
v_add_f32 v111, v92, v111
v_exp_f32 v54, v110
v_add_f32 v41, v41, v52
v_exp_f32 v55, v111
v_add_f32 v41, v41, v53
v_cvt_pk_bf16_f32 v78, v52, v53
v_add_f32 v41, v41, v54
v_add_f32 v41, v41, v55
v_cvt_pk_bf16_f32 v79, v54, v55
v_mfma_f32_16x16x32_bf16 v[96:99], a[64:67], a[0:3], v[88:91]
ds_read_b64_tr_b16 a[102:103], v8 offset:8192
ds_read_b128 a[104:107], v1 offset:33024
v_mfma_f32_16x16x32_bf16 v[96:99], a[72:75], a[8:11], v[96:99]
ds_read_b64_tr_b16 a[108:109], v9 offset:0
ds_read_b64_tr_b16 a[110:111], v9 offset:8192
v_mfma_f32_16x16x32_bf16 v[96:99], a[80:83], a[16:19], v[96:99]
s_waitcnt lgkmcnt(6)
buffer_load_dwordx4 v15, s[12:15], s29 offen offset:3072 nt lds
v_mfma_f32_16x16x32_bf16 v[96:99], a[88:91], a[24:27], v[96:99]
ds_read_b128 a[112:115], v2 offset:33024
ds_read_b64_tr_b16 a[116:117], v10 offset:0
v_mfma_f32_16x16x32_bf16 v[100:103], a[88:91], a[28:31], v[92:95]
v_mov_b32 v38, v40
v_mov_b32 v39, v41
v_mfma_f32_16x16x32_bf16 v[100:103], a[80:83], a[20:23], v[100:103]
ds_read_b64_tr_b16 a[118:119], v10 offset:8192
v_add_f32 v112, v88, v112
v_mfma_f32_16x16x32_bf16 v[100:103], a[72:75], a[12:15], v[100:103]
ds_read_b128 a[120:123], v3 offset:33024
v_add_f32 v113, v88, v113
v_mfma_f32_16x16x32_bf16 v[100:103], a[64:67], a[4:7], v[100:103]
s_add_u32 m0, s28, 81920
s_add_u32 s30, s30, 16384
v_exp_f32 v48, v112
v_mfma_f32_16x16x32_bf16 v[128:131], a[68:71], v[72:75], 0
buffer_load_dwordx4 v16, s[16:19], s30 offen nt lds
v_mfma_f32_16x16x32_bf16 v[132:135], a[68:71], v[76:79], 0
ds_read_b64_tr_b16 a[124:125], v11 offset:0
ds_read_b64_tr_b16 a[126:127], v11 offset:8192
v_mfma_f32_16x16x32_bf16 v[140:143], a[76:79], v[76:79], 0
ds_read_b128 a[128:131], v0 offset:40960
ds_read_b64_tr_b16 a[132:133], v4 offset:256
v_mfma_f32_16x16x32_bf16 v[136:139], a[76:79], v[72:75], 0
v_exp_f32 v49, v113
v_mfma_f32_16x16x32_bf16 v[144:147], a[84:87], v[72:75], 0
ds_read_b64_tr_b16 a[134:135], v4 offset:8448
v_add_f32 v114, v88, v114
v_mfma_f32_16x16x32_bf16 v[148:151], a[84:87], v[76:79], 0
ds_read_b128 a[136:139], v1 offset:40960
v_add_f32 v115, v88, v115
v_mfma_f32_16x16x32_bf16 v[156:159], a[92:95], v[76:79], 0
buffer_load_dwordx4 v17, s[16:19], s30 offen offset:1024 nt lds
v_mfma_f32_16x16x32_bf16 v[152:155], a[92:95], v[72:75], 0
s_waitcnt lgkmcnt(4)
v_exp_f32 v50, v114
v_mfma_f32_16x16x32_bf16 v[96:99], a[96:99], a[32:35], v[96:99]
ds_read_b64_tr_b16 a[140:141], v5 offset:256
v_add_f32 v40, v48, v49
v_mfma_f32_16x16x32_bf16 v[96:99], a[104:107], a[40:43], v[96:99]
ds_read_b64_tr_b16 a[142:143], v5 offset:8448
ds_read_b128 a[144:147], v2 offset:40960
v_mfma_f32_16x16x32_bf16 v[96:99], a[112:115], a[48:51], v[96:99]
buffer_load_dwordx4 v18, s[16:19], s30 offen offset:2048 nt lds
v_mfma_f32_16x16x32_bf16 v[96:99], a[120:123], a[56:59], v[96:99]
ds_read_b64_tr_b16 a[148:149], v6 offset:256
ds_read_b64_tr_b16 a[150:151], v6 offset:8448
v_mfma_f32_16x16x32_bf16 v[100:103], a[120:123], a[60:63], v[100:103]
ds_read_b128 a[152:155], v3 offset:40960
ds_read_b64_tr_b16 a[156:157], v7 offset:256
v_mfma_f32_16x16x32_bf16 v[100:103], a[112:115], a[52:55], v[100:103]
v_exp_f32 v51, v115
v_mfma_f32_16x16x32_bf16 v[100:103], a[104:107], a[44:47], v[100:103]
ds_read_b64_tr_b16 a[158:159], v7 offset:8448
v_cvt_pk_bf16_f32 v80, v48, v49
v_mfma_f32_16x16x32_bf16 v[100:103], a[96:99], a[36:39], v[100:103]
ds_read_b128 a[160:163], v0 offset:41216
ds_read_b64_tr_b16 a[164:165], v8 offset:256
v_mfma_f32_16x16x32_bf16 v[160:163], a[100:103], v[72:75], 0
buffer_load_dwordx4 v19, s[16:19], s30 offen offset:3072 nt lds
v_mfma_f32_16x16x32_bf16 v[164:167], a[100:103], v[76:79], 0
ds_read_b64_tr_b16 a[166:167], v8 offset:8448
v_add_f32 v120, v88, v120
v_mfma_f32_16x16x32_bf16 v[172:175], a[108:111], v[76:79], 0
ds_read_b128 a[168:171], v1 offset:41216
ds_read_b64_tr_b16 a[172:173], v9 offset:256
v_mfma_f32_16x16x32_bf16 v[168:171], a[108:111], v[72:75], 0
ds_read_b64_tr_b16 a[174:175], v9 offset:8448
v_add_f32 v121, v88, v121
v_mfma_f32_16x16x32_bf16 v[176:179], a[116:119], v[72:75], 0
v_exp_f32 v52, v120
v_mfma_f32_16x16x32_bf16 v[180:183], a[116:119], v[76:79], 0
ds_read_b128 a[176:179], v2 offset:41216
ds_read_b64_tr_b16 a[180:181], v10 offset:256
v_mfma_f32_16x16x32_bf16 v[188:191], a[124:127], v[76:79], 0
ds_read_b64_tr_b16 a[182:183], v10 offset:8448
v_add_f32 v40, v40, v50
v_mfma_f32_16x16x32_bf16 v[184:187], a[124:127], v[72:75], 0
s_waitcnt lgkmcnt(6)
v_exp_f32 v53, v121
v_mfma_f32_16x16x32_bf16 v[104:107], a[128:131], a[0:3], v[88:91]
ds_read_b128 a[184:187], v3 offset:41216
ds_read_b64_tr_b16 a[188:189], v11 offset:256
v_mfma_f32_16x16x32_bf16 v[104:107], a[136:139], a[8:11], v[104:107]
ds_read_b64_tr_b16 a[190:191], v11 offset:8448
v_add_f32 v40, v40, v51
v_mfma_f32_16x16x32_bf16 v[104:107], a[144:147], a[16:19], v[104:107]
v_cvt_pk_bf16_f32 v81, v50, v51
v_add_f32 v122, v88, v122
v_mfma_f32_16x16x32_bf16 v[104:107], a[152:155], a[24:27], v[104:107]
v_add_f32 v123, v88, v123
v_mfma_f32_16x16x32_bf16 v[108:111], a[152:155], a[28:31], v[92:95]
v_exp_f32 v54, v122
v_mfma_f32_16x16x32_bf16 v[108:111], a[144:147], a[20:23], v[108:111]
v_add_f32 v40, v40, v52
v_mfma_f32_16x16x32_bf16 v[108:111], a[136:139], a[12:15], v[108:111]
v_exp_f32 v55, v123
v_mfma_f32_16x16x32_bf16 v[108:111], a[128:131], a[4:7], v[108:111]
v_add_f32 v40, v40, v53
v_cvt_pk_bf16_f32 v82, v52, v53
v_mfma_f32_16x16x32_bf16 v[192:195], a[132:135], v[72:75], 0
v_add_f32 v116, v92, v116
v_add_f32 v117, v92, v117
v_mfma_f32_16x16x32_bf16 v[196:199], a[132:135], v[76:79], 0
v_exp_f32 v48, v116
v_mfma_f32_16x16x32_bf16 v[204:207], a[140:143], v[76:79], 0
v_add_f32 v40, v40, v54
v_mfma_f32_16x16x32_bf16 v[200:203], a[140:143], v[72:75], 0
s_waitcnt vmcnt(16) lgkmcnt(0)
s_barrier
v_exp_f32 v49, v117
v_mfma_f32_16x16x32_bf16 v[208:211], a[148:151], v[72:75], 0
v_add_f32 v40, v40, v55
v_cvt_pk_bf16_f32 v83, v54, v55
v_mfma_f32_16x16x32_bf16 v[212:215], a[148:151], v[76:79], 0
ds_read_b128 a[64:67], v0 offset:49152
v_add_f32 v118, v92, v118
v_mfma_f32_16x16x32_bf16 v[220:223], a[156:159], v[76:79], 0
ds_read_b64_tr_b16 a[68:69], v4 offset:16384
v_add_f32 v119, v92, v119
v_mfma_f32_16x16x32_bf16 v[216:219], a[156:159], v[72:75], 0
v_exp_f32 v50, v118
v_mfma_f32_16x16x32_bf16 v[104:107], a[160:163], a[32:35], v[104:107]
ds_read_b64_tr_b16 a[70:71], v4 offset:24576
v_add_f32 v41, v48, v49
v_mfma_f32_16x16x32_bf16 v[104:107], a[168:171], a[40:43], v[104:107]
s_add_u32 m0, s28, 131072
s_add_u32 s29, s29, 16384
ds_read_b128 a[72:75], v1 offset:49152
ds_read_b64_tr_b16 a[76:77], v5 offset:16384
v_mfma_f32_16x16x32_bf16 v[104:107], a[176:179], a[48:51], v[104:107]
buffer_load_dwordx4 v12, s[12:15], s29 offen nt lds
v_mfma_f32_16x16x32_bf16 v[104:107], a[184:187], a[56:59], v[104:107]
v_exp_f32 v51, v119
v_mfma_f32_16x16x32_bf16 v[108:111], a[184:187], a[60:63], v[108:111]
ds_read_b64_tr_b16 a[78:79], v5 offset:24576
v_cvt_pk_bf16_f32 v84, v48, v49
v_mfma_f32_16x16x32_bf16 v[108:111], a[176:179], a[52:55], v[108:111]
ds_read_b128 a[80:83], v2 offset:49152
ds_read_b64_tr_b16 a[84:85], v6 offset:16384
v_mfma_f32_16x16x32_bf16 v[108:111], a[168:171], a[44:47], v[108:111]
buffer_load_dwordx4 v13, s[12:15], s29 offen offset:1024 nt lds
v_mfma_f32_16x16x32_bf16 v[108:111], a[160:163], a[36:39], v[108:111]
ds_read_b64_tr_b16 a[86:87], v6 offset:24576
v_add_f32 v124, v92, v124
v_mfma_f32_16x16x32_bf16 v[224:227], a[164:167], v[72:75], 0
ds_read_b128 a[88:91], v3 offset:49152
ds_read_b64_tr_b16 a[92:93], v7 offset:16384
v_mfma_f32_16x16x32_bf16 v[228:231], a[164:167], v[76:79], 0
ds_read_b64_tr_b16 a[94:95], v7 offset:24576
v_add_f32 v125, v92, v125
v_mfma_f32_16x16x32_bf16 v[236:239], a[172:175], v[76:79], 0
buffer_load_dwordx4 v14, s[12:15], s29 offen offset:2048 nt lds
v_mfma_f32_16x16x32_bf16 v[232:235], a[172:175], v[72:75], 0
ds_read_b128 a[96:99], v0 offset:49408
ds_read_b64_tr_b16 a[100:101], v8 offset:16384
v_mfma_f32_16x16x32_bf16 v[240:243], a[180:183], v[72:75], 0
v_exp_f32 v52, v124
v_mfma_f32_16x16x32_bf16 v[244:247], a[180:183], v[76:79], 0
ds_read_b64_tr_b16 a[102:103], v8 offset:24576
v_add_f32 v41, v41, v50
v_mfma_f32_16x16x32_bf16 v[252:255], a[188:191], v[76:79], 0
ds_read_b128 a[104:107], v1 offset:49408
ds_read_b64_tr_b16 a[108:109], v9 offset:16384
v_exp_f32 v53, v125
v_add_f32 v41, v41, v51
v_cvt_pk_bf16_f32 v85, v50, v51
v_add_f32 v126, v92, v126
v_add_f32 v127, v92, v127
v_exp_f32 v54, v126
v_add_f32 v41, v41, v52
v_exp_f32 v55, v127
v_add_f32 v41, v41, v53
v_cvt_pk_bf16_f32 v86, v52, v53
v_add_f32 v41, v41, v54
v_add_f32 v41, v41, v55
v_cvt_pk_bf16_f32 v87, v54, v55
v_max_f32 v45, v40, v41
v_cmp_nge_f32 vcc, 0x46800000, v45
v_mfma_f32_16x16x32_bf16 v[248:251], a[188:191], v[72:75], 0
s_waitcnt lgkmcnt(5)
buffer_load_dwordx4 v15, s[12:15], s29 offen offset:3072 nt lds
s_cbranch_vccnz L_t_a0
L_t_a0_back:
v_mfma_f32_16x16x32_bf16 v[112:115], a[64:67], a[0:3], v[88:91]
ds_read_b64_tr_b16 a[110:111], v9 offset:24576
v_add_f32 v38, v38, v40
v_mfma_f32_16x16x32_bf16 v[112:115], a[72:75], a[8:11], v[112:115]
ds_read_b128 a[112:115], v2 offset:49408
ds_read_b64_tr_b16 a[116:117], v10 offset:16384
v_mfma_f32_16x16x32_bf16 v[112:115], a[80:83], a[16:19], v[112:115]
ds_read_b64_tr_b16 a[118:119], v10 offset:24576
v_add_f32 v39, v39, v41
v_mfma_f32_16x16x32_bf16 v[112:115], a[88:91], a[24:27], v[112:115]
s_add_u32 m0, s28, 32768
s_add_u32 s30, s30, 16384
v_exp_f32 v48, v96
v_mfma_f32_16x16x32_bf16 v[116:119], a[88:91], a[28:31], v[92:95]
buffer_load_dwordx4 v16, s[16:19], s30 offen nt lds
v_mfma_f32_16x16x32_bf16 v[116:119], a[80:83], a[20:23], v[116:119]
ds_read_b128 a[120:123], v3 offset:49408
ds_read_b64_tr_b16 a[124:125], v11 offset:16384
v_mfma_f32_16x16x32_bf16 v[116:119], a[72:75], a[12:15], v[116:119]
v_exp_f32 v49, v97
v_mfma_f32_16x16x32_bf16 v[116:119], a[64:67], a[4:7], v[116:119]
v_exp_f32 v50, v98
v_mfma_f32_16x16x32_bf16 v[128:131], a[68:71], v[80:83], v[128:131]
ds_read_b64_tr_b16 a[126:127], v11 offset:24576
v_add_f32 v40, v48, v49
v_mfma_f32_16x16x32_bf16 v[132:135], a[68:71], v[84:87], v[132:135]
ds_read_b128 a[128:131], v0 offset:57344
ds_read_b64_tr_b16 a[132:133], v4 offset:16640
v_mfma_f32_16x16x32_bf16 v[140:143], a[76:79], v[84:87], v[140:143]
buffer_load_dwordx4 v17, s[16:19], s30 offen offset:1024 nt lds
v_mfma_f32_16x16x32_bf16 v[136:139], a[76:79], v[80:83], v[136:139]
v_exp_f32 v51, v99
v_mfma_f32_16x16x32_bf16 v[144:147], a[84:87], v[80:83], v[144:147]
ds_read_b64_tr_b16 a[134:135], v4 offset:24832
v_cvt_pk_bf16_f32 v72, v48, v49
v_mfma_f32_16x16x32_bf16 v[148:151], a[84:87], v[84:87], v[148:151]
ds_read_b128 a[136:139], v1 offset:57344
ds_read_b64_tr_b16 a[140:141], v5 offset:16640
v_mfma_f32_16x16x32_bf16 v[156:159], a[92:95], v[84:87], v[156:159]
buffer_load_dwordx4 v18, s[16:19], s30 offen offset:2048 nt lds
v_mfma_f32_16x16x32_bf16 v[152:155], a[92:95], v[80:83], v[152:155]
s_waitcnt lgkmcnt(3)
ds_read_b64_tr_b16 a[142:143], v5 offset:24832
ds_read_b128 a[144:147], v2 offset:57344
v_mfma_f32_16x16x32_bf16 v[112:115], a[96:99], a[32:35], v[112:115]
v_exp_f32 v52, v104
v_mfma_f32_16x16x32_bf16 v[112:115], a[104:107], a[40:43], v[112:115]
ds_read_b64_tr_b16 a[148:149], v6 offset:16640
v_add_f32 v40, v40, v50
v_mfma_f32_16x16x32_bf16 v[112:115], a[112:115], a[48:51], v[112:115]
v_exp_f32 v53, v105
v_mfma_f32_16x16x32_bf16 v[112:115], a[120:123], a[56:59], v[112:115]
ds_read_b64_tr_b16 a[150:151], v6 offset:24832
v_add_f32 v40, v40, v51
v_mfma_f32_16x16x32_bf16 v[116:119], a[120:123], a[60:63], v[116:119]
ds_read_b128 a[152:155], v3 offset:57344
ds_read_b64_tr_b16 a[156:157], v7 offset:16640
v_mfma_f32_16x16x32_bf16 v[116:119], a[112:115], a[52:55], v[116:119]
buffer_load_dwordx4 v19, s[16:19], s30 offen offset:3072 nt lds
v_mfma_f32_16x16x32_bf16 v[116:119], a[104:107], a[44:47], v[116:119]
ds_read_b64_tr_b16 a[158:159], v7 offset:24832
v_cvt_pk_bf16_f32 v73, v50, v51
v_mfma_f32_16x16x32_bf16 v[116:119], a[96:99], a[36:39], v[116:119]
ds_read_b128 a[160:163], v0 offset:57600
ds_read_b64_tr_b16 a[164:165], v8 offset:16640
v_mfma_f32_16x16x32_bf16 v[160:163], a[100:103], v[80:83], v[160:163]
v_exp_f32 v54, v106
v_mfma_f32_16x16x32_bf16 v[164:167], a[100:103], v[84:87], v[164:167]
ds_read_b64_tr_b16 a[166:167], v8 offset:24832
v_add_f32 v40, v40, v52
v_mfma_f32_16x16x32_bf16 v[172:175], a[108:111], v[84:87], v[172:175]
ds_read_b128 a[168:171], v1 offset:57600
ds_read_b64_tr_b16 a[172:173], v9 offset:16640
v_mfma_f32_16x16x32_bf16 v[168:171], a[108:111], v[80:83], v[168:171]
v_exp_f32 v55, v107
v_mfma_f32_16x16x32_bf16 v[176:179], a[116:119], v[80:83], v[176:179]
ds_read_b64_tr_b16 a[174:175], v9 offset:24832
v_add_f32 v40, v40, v53
v_mfma_f32_16x16x32_bf16 v[180:183], a[116:119], v[84:87], v[180:183]
ds_read_b128 a[176:179], v2 offset:57600
ds_read_b64_tr_b16 a[180:181], v10 offset:16640
v_mfma_f32_16x16x32_bf16 v[188:191], a[124:127], v[84:87], v[188:191]
ds_read_b64_tr_b16 a[182:183], v10 offset:24832
v_cvt_pk_bf16_f32 v74, v52, v53
v_mfma_f32_16x16x32_bf16 v[184:187], a[124:127], v[80:83], v[184:187]
v_exp_f32 v48, v100
v_mfma_f32_16x16x32_bf16 v[120:123], a[128:131], a[0:3], v[88:91]
s_waitcnt lgkmcnt(4)
ds_read_b128 a[184:187], v3 offset:57600
ds_read_b64_tr_b16 a[188:189], v11 offset:16640
v_mfma_f32_16x16x32_bf16 v[120:123], a[136:139], a[8:11], v[120:123]
ds_read_b64_tr_b16 a[190:191], v11 offset:24832
v_add_f32 v40, v40, v54
v_mfma_f32_16x16x32_bf16 v[120:123], a[144:147], a[16:19], v[120:123]
v_exp_f32 v49, v101
v_mfma_f32_16x16x32_bf16 v[120:123], a[152:155], a[24:27], v[120:123]
v_add_f32 v40, v40, v55
v_cvt_pk_bf16_f32 v75, v54, v55
v_mfma_f32_16x16x32_bf16 v[124:127], a[152:155], a[28:31], v[92:95]
v_exp_f32 v50, v102
v_mfma_f32_16x16x32_bf16 v[124:127], a[144:147], a[20:23], v[124:127]
v_add_f32 v41, v48, v49
v_mfma_f32_16x16x32_bf16 v[124:127], a[136:139], a[12:15], v[124:127]
v_exp_f32 v51, v103
v_mfma_f32_16x16x32_bf16 v[124:127], a[128:131], a[4:7], v[124:127]
v_cvt_pk_bf16_f32 v76, v48, v49
v_mfma_f32_16x16x32_bf16 v[192:195], a[132:135], v[80:83], v[192:195]
v_exp_f32 v52, v108
v_mfma_f32_16x16x32_bf16 v[196:199], a[132:135], v[84:87], v[196:199]
v_add_f32 v41, v41, v50
v_mfma_f32_16x16x32_bf16 v[204:207], a[140:143], v[84:87], v[204:207]
v_exp_f32 v53, v109
v_mfma_f32_16x16x32_bf16 v[200:203], a[140:143], v[80:83], v[200:203]
s_waitcnt vmcnt(16) lgkmcnt(0)
s_barrier
ds_read_b128 a[64:67], v0 offset:0
ds_read_b64_tr_b16 a[68:69], v4 offset:32768
v_mfma_f32_16x16x32_bf16 v[208:211], a[148:151], v[80:83], v[208:211]
ds_read_b64_tr_b16 a[70:71], v4 offset:40960
v_add_f32 v41, v41, v51
v_mfma_f32_16x16x32_bf16 v[212:215], a[148:151], v[84:87], v[212:215]
s_add_u32 m0, s28, 147456
s_add_u32 s29, s29, 16384
ds_read_b128 a[72:75], v1 offset:0
v_cvt_pk_bf16_f32 v77, v50, v51
v_mfma_f32_16x16x32_bf16 v[220:223], a[156:159], v[84:87], v[220:223]
buffer_load_dwordx4 v12, s[12:15], s29 offen nt lds
v_mfma_f32_16x16x32_bf16 v[216:219], a[156:159], v[80:83], v[216:219]
v_exp_f32 v54, v110
v_mfma_f32_16x16x32_bf16 v[120:123], a[160:163], a[32:35], v[120:123]
ds_read_b64_tr_b16 a[76:77], v5 offset:32768
v_add_f32 v41, v41, v52
v_mfma_f32_16x16x32_bf16 v[120:123], a[168:171], a[40:43], v[120:123]
ds_read_b64_tr_b16 a[78:79], v5 offset:40960
v_mfma_f32_16x16x32_bf16 v[120:123], a[176:179], a[48:51], v[120:123]
ds_read_b128 a[80:83], v2 offset:0
ds_read_b64_tr_b16 a[84:85], v6 offset:32768
v_mfma_f32_16x16x32_bf16 v[120:123], a[184:187], a[56:59], v[120:123]
v_exp_f32 v55, v111
v_mfma_f32_16x16x32_bf16 v[124:127], a[184:187], a[60:63], v[124:127]
buffer_load_dwordx4 v13, s[12:15], s29 offen offset:1024 nt lds
v_mfma_f32_16x16x32_bf16 v[124:127], a[176:179], a[52:55], v[124:127]
ds_read_b64_tr_b16 a[86:87], v6 offset:40960
v_add_f32 v41, v41, v53
v_mfma_f32_16x16x32_bf16 v[124:127], a[168:171], a[44:47], v[124:127]
ds_read_b128 a[88:91], v3 offset:0
ds_read_b64_tr_b16 a[92:93], v7 offset:32768
v_mfma_f32_16x16x32_bf16 v[124:127], a[160:163], a[36:39], v[124:127]
ds_read_b64_tr_b16 a[94:95], v7 offset:40960
v_cvt_pk_bf16_f32 v78, v52, v53
v_mfma_f32_16x16x32_bf16 v[224:227], a[164:167], v[80:83], v[224:227]
ds_read_b128 a[96:99], v0 offset:256
v_add_f32 v41, v41, v54
v_mfma_f32_16x16x32_bf16 v[228:231], a[164:167], v[84:87], v[228:231]
buffer_load_dwordx4 v14, s[12:15], s29 offen offset:2048 nt lds
v_mfma_f32_16x16x32_bf16 v[236:239], a[172:175], v[84:87], v[236:239]
ds_read_b64_tr_b16 a[100:101], v8 offset:32768
v_add_f32 v41, v41, v55
v_mfma_f32_16x16x32_bf16 v[232:235], a[172:175], v[80:83], v[232:235]
ds_read_b64_tr_b16 a[102:103], v8 offset:40960
v_cvt_pk_bf16_f32 v79, v54, v55
v_mfma_f32_16x16x32_bf16 v[240:243], a[180:183], v[80:83], v[240:243]
ds_read_b128 a[104:107], v1 offset:256
v_max_f32 v45, v40, v41
v_mfma_f32_16x16x32_bf16 v[244:247], a[180:183], v[84:87], v[244:247]
ds_read_b64_tr_b16 a[108:109], v9 offset:32768
v_cmp_nge_f32 vcc, 0x46800000, v45
v_mfma_f32_16x16x32_bf16 v[252:255], a[188:191], v[84:87], v[252:255]
buffer_load_dwordx4 v15, s[12:15], s29 offen offset:3072 nt lds
v_mfma_f32_16x16x32_bf16 v[248:251], a[188:191], v[80:83], v[248:251]
s_waitcnt lgkmcnt(4)
ds_read_b64_tr_b16 a[110:111], v9 offset:40960
s_cbranch_vccnz L_t_a1
L_t_a1_back:
s_mov_b32 s31, 14
.p2align 6
L_loop:
v_mfma_f32_16x16x32_bf16 v[96:99], a[64:67], a[0:3], v[88:91]
ds_read_b128 a[112:115], v2 offset:256
v_add_f32 v38, v38, v40
v_mfma_f32_16x16x32_bf16 v[96:99], a[72:75], a[8:11], v[96:99]
ds_read_b64_tr_b16 a[116:117], v10 offset:32768
v_add_f32 v39, v39, v41
v_mfma_f32_16x16x32_bf16 v[96:99], a[80:83], a[16:19], v[96:99]
s_add_u32 m0, s28, 49152
s_add_u32 s30, s30, 16384
v_exp_f32 v48, v112
v_mfma_f32_16x16x32_bf16 v[96:99], a[88:91], a[24:27], v[96:99]
buffer_load_dwordx4 v16, s[16:19], s30 offen nt lds
v_mfma_f32_16x16x32_bf16 v[100:103], a[88:91], a[28:31], v[92:95]
ds_read_b64_tr_b16 a[118:119], v10 offset:40960
ds_read_b128 a[120:123], v3 offset:256
v_mfma_f32_16x16x32_bf16 v[100:103], a[80:83], a[20:23], v[100:103]
v_exp_f32 v49, v113
v_mfma_f32_16x16x32_bf16 v[100:103], a[72:75], a[12:15], v[100:103]
ds_read_b64_tr_b16 a[124:125], v11 offset:32768
ds_read_b64_tr_b16 a[126:127], v11 offset:40960
v_mfma_f32_16x16x32_bf16 v[100:103], a[64:67], a[4:7], v[100:103]
v_exp_f32 v50, v114
v_mfma_f32_16x16x32_bf16 v[128:131], a[68:71], v[72:75], v[128:131]
ds_read_b128 a[128:131], v0 offset:8192
ds_read_b64_tr_b16 a[132:133], v4 offset:33024
v_mfma_f32_16x16x32_bf16 v[132:135], a[68:71], v[76:79], v[132:135]
buffer_load_dwordx4 v17, s[16:19], s30 offen offset:1024 nt lds
v_mfma_f32_16x16x32_bf16 v[140:143], a[76:79], v[76:79], v[140:143]
ds_read_b64_tr_b16 a[134:135], v4 offset:41216
v_add_f32 v40, v48, v49
v_mfma_f32_16x16x32_bf16 v[136:139], a[76:79], v[72:75], v[136:139]
ds_read_b128 a[136:139], v1 offset:8192
ds_read_b64_tr_b16 a[140:141], v5 offset:33024
v_mfma_f32_16x16x32_bf16 v[144:147], a[84:87], v[72:75], v[144:147]
v_exp_f32 v51, v115
v_mfma_f32_16x16x32_bf16 v[148:151], a[84:87], v[76:79], v[148:151]
ds_read_b64_tr_b16 a[142:143], v5 offset:41216
v_cvt_pk_bf16_f32 v80, v48, v49
v_mfma_f32_16x16x32_bf16 v[156:159], a[92:95], v[76:79], v[156:159]
buffer_load_dwordx4 v18, s[16:19], s30 offen offset:2048 nt lds
v_mfma_f32_16x16x32_bf16 v[152:155], a[92:95], v[72:75], v[152:155]
ds_read_b128 a[144:147], v2 offset:8192
ds_read_b64_tr_b16 a[148:149], v6 offset:33024
v_mfma_f32_16x16x32_bf16 v[96:99], a[96:99], a[32:35], v[96:99]
s_waitcnt lgkmcnt(5)
v_exp_f32 v52, v120
v_mfma_f32_16x16x32_bf16 v[96:99], a[104:107], a[40:43], v[96:99]
ds_read_b64_tr_b16 a[150:151], v6 offset:41216
v_add_f32 v40, v40, v50
v_mfma_f32_16x16x32_bf16 v[96:99], a[112:115], a[48:51], v[96:99]
ds_read_b128 a[152:155], v3 offset:8192
ds_read_b64_tr_b16 a[156:157], v7 offset:33024
v_mfma_f32_16x16x32_bf16 v[96:99], a[120:123], a[56:59], v[96:99]
buffer_load_dwordx4 v19, s[16:19], s30 offen offset:3072 nt lds
v_mfma_f32_16x16x32_bf16 v[100:103], a[120:123], a[60:63], v[100:103]
v_exp_f32 v53, v121
v_mfma_f32_16x16x32_bf16 v[100:103], a[112:115], a[52:55], v[100:103]
ds_read_b64_tr_b16 a[158:159], v7 offset:41216
v_add_f32 v40, v40, v51
v_mfma_f32_16x16x32_bf16 v[100:103], a[104:107], a[44:47], v[100:103]
ds_read_b128 a[160:163], v0 offset:8448
ds_read_b64_tr_b16 a[164:165], v8 offset:33024
v_mfma_f32_16x16x32_bf16 v[100:103], a[96:99], a[36:39], v[100:103]
ds_read_b64_tr_b16 a[166:167], v8 offset:41216
v_cvt_pk_bf16_f32 v81, v50, v51
v_mfma_f32_16x16x32_bf16 v[160:163], a[100:103], v[72:75], v[160:163]
v_exp_f32 v54, v122
v_mfma_f32_16x16x32_bf16 v[164:167], a[100:103], v[76:79], v[164:167]
ds_read_b128 a[168:171], v1 offset:8448
v_add_f32 v40, v40, v52
v_mfma_f32_16x16x32_bf16 v[172:175], a[108:111], v[76:79], v[172:175]
v_exp_f32 v55, v123
v_mfma_f32_16x16x32_bf16 v[168:171], a[108:111], v[72:75], v[168:171]
ds_read_b64_tr_b16 a[172:173], v9 offset:33024
v_add_f32 v40, v40, v53
v_mfma_f32_16x16x32_bf16 v[176:179], a[116:119], v[72:75], v[176:179]
ds_read_b64_tr_b16 a[174:175], v9 offset:41216
v_cvt_pk_bf16_f32 v82, v52, v53
v_mfma_f32_16x16x32_bf16 v[180:183], a[116:119], v[76:79], v[180:183]
ds_read_b128 a[176:179], v2 offset:8448
ds_read_b64_tr_b16 a[180:181], v10 offset:33024
v_mfma_f32_16x16x32_bf16 v[188:191], a[124:127], v[76:79], v[188:191]
v_exp_f32 v48, v116
v_mfma_f32_16x16x32_bf16 v[184:187], a[124:127], v[72:75], v[184:187]
ds_read_b64_tr_b16 a[182:183], v10 offset:41216
v_add_f32 v40, v40, v54
v_mfma_f32_16x16x32_bf16 v[104:107], a[128:131], a[0:3], v[88:91]
s_waitcnt lgkmcnt(5)
ds_read_b128 a[184:187], v3 offset:8448
ds_read_b64_tr_b16 a[188:189], v11 offset:33024
v_mfma_f32_16x16x32_bf16 v[104:107], a[136:139], a[8:11], v[104:107]
v_exp_f32 v49, v117
v_mfma_f32_16x16x32_bf16 v[104:107], a[144:147], a[16:19], v[104:107]
ds_read_b64_tr_b16 a[190:191], v11 offset:41216
v_add_f32 v40, v40, v55
v_mfma_f32_16x16x32_bf16 v[104:107], a[152:155], a[24:27], v[104:107]
v_cvt_pk_bf16_f32 v83, v54, v55
v_mfma_f32_16x16x32_bf16 v[108:111], a[152:155], a[28:31], v[92:95]
v_exp_f32 v50, v118
v_mfma_f32_16x16x32_bf16 v[108:111], a[144:147], a[20:23], v[108:111]
v_add_f32 v41, v48, v49
v_mfma_f32_16x16x32_bf16 v[108:111], a[136:139], a[12:15], v[108:111]
v_exp_f32 v51, v119
v_mfma_f32_16x16x32_bf16 v[108:111], a[128:131], a[4:7], v[108:111]
v_cvt_pk_bf16_f32 v84, v48, v49
v_mfma_f32_16x16x32_bf16 v[192:195], a[132:135], v[72:75], v[192:195]
v_exp_f32 v52, v124
v_mfma_f32_16x16x32_bf16 v[196:199], a[132:135], v[76:79], v[196:199]
v_add_f32 v41, v41, v50
v_mfma_f32_16x16x32_bf16 v[204:207], a[140:143], v[76:79], v[204:207]
v_exp_f32 v53, v125
v_mfma_f32_16x16x32_bf16 v[200:203], a[140:143], v[72:75], v[200:203]
s_waitcnt vmcnt(16) lgkmcnt(0)
s_barrier
ds_read_b128 a[64:67], v0 offset:16384
ds_read_b64_tr_b16 a[68:69], v4 offset:49152
v_mfma_f32_16x16x32_bf16 v[208:211], a[148:151], v[72:75], v[208:211]
ds_read_b64_tr_b16 a[70:71], v4 offset:57344
v_add_f32 v41, v41, v51
v_mfma_f32_16x16x32_bf16 v[212:215], a[148:151], v[76:79], v[212:215]
s_add_u32 m0, s28, 98304
s_add_u32 s29, s29, 16384
ds_read_b128 a[72:75], v1 offset:16384
v_cvt_pk_bf16_f32 v85, v50, v51
v_mfma_f32_16x16x32_bf16 v[220:223], a[156:159], v[76:79], v[220:223]
buffer_load_dwordx4 v12, s[12:15], s29 offen nt lds
v_mfma_f32_16x16x32_bf16 v[216:219], a[156:159], v[72:75], v[216:219]
v_exp_f32 v54, v126
v_mfma_f32_16x16x32_bf16 v[104:107], a[160:163], a[32:35], v[104:107]
ds_read_b64_tr_b16 a[76:77], v5 offset:49152
v_add_f32 v41, v41, v52
v_mfma_f32_16x16x32_bf16 v[104:107], a[168:171], a[40:43], v[104:107]
ds_read_b64_tr_b16 a[78:79], v5 offset:57344
v_mfma_f32_16x16x32_bf16 v[104:107], a[176:179], a[48:51], v[104:107]
ds_read_b128 a[80:83], v2 offset:16384
ds_read_b64_tr_b16 a[84:85], v6 offset:49152
v_mfma_f32_16x16x32_bf16 v[104:107], a[184:187], a[56:59], v[104:107]
v_exp_f32 v55, v127
v_mfma_f32_16x16x32_bf16 v[108:111], a[184:187], a[60:63], v[108:111]
buffer_load_dwordx4 v13, s[12:15], s29 offen offset:1024 nt lds
v_mfma_f32_16x16x32_bf16 v[108:111], a[176:179], a[52:55], v[108:111]
ds_read_b64_tr_b16 a[86:87], v6 offset:57344
v_add_f32 v41, v41, v53
v_mfma_f32_16x16x32_bf16 v[108:111], a[168:171], a[44:47], v[108:111]
ds_read_b128 a[88:91], v3 offset:16384
ds_read_b64_tr_b16 a[92:93], v7 offset:49152
v_mfma_f32_16x16x32_bf16 v[108:111], a[160:163], a[36:39], v[108:111]
ds_read_b64_tr_b16 a[94:95], v7 offset:57344
v_cvt_pk_bf16_f32 v86, v52, v53
v_mfma_f32_16x16x32_bf16 v[224:227], a[164:167], v[72:75], v[224:227]
ds_read_b128 a[96:99], v0 offset:16640
v_add_f32 v41, v41, v54
v_mfma_f32_16x16x32_bf16 v[228:231], a[164:167], v[76:79], v[228:231]
buffer_load_dwordx4 v14, s[12:15], s29 offen offset:2048 nt lds
v_mfma_f32_16x16x32_bf16 v[236:239], a[172:175], v[76:79], v[236:239]
ds_read_b64_tr_b16 a[100:101], v8 offset:49152
v_add_f32 v41, v41, v55
v_mfma_f32_16x16x32_bf16 v[232:235], a[172:175], v[72:75], v[232:235]
ds_read_b64_tr_b16 a[102:103], v8 offset:57344
v_cvt_pk_bf16_f32 v87, v54, v55
v_mfma_f32_16x16x32_bf16 v[240:243], a[180:183], v[72:75], v[240:243]
ds_read_b128 a[104:107], v1 offset:16640
v_max_f32 v45, v40, v41
v_mfma_f32_16x16x32_bf16 v[244:247], a[180:183], v[76:79], v[244:247]
ds_read_b64_tr_b16 a[108:109], v9 offset:49152
v_cmp_nge_f32 vcc, 0x46800000, v45
v_mfma_f32_16x16x32_bf16 v[252:255], a[188:191], v[76:79], v[252:255]
buffer_load_dwordx4 v15, s[12:15], s29 offen offset:3072 nt lds
v_mfma_f32_16x16x32_bf16 v[248:251], a[188:191], v[72:75], v[248:251]
s_waitcnt lgkmcnt(4)
ds_read_b64_tr_b16 a[110:111], v9 offset:57344
s_cbranch_vccnz L_t_a2
L_t_a2_back:
v_mfma_f32_16x16x32_bf16 v[112:115], a[64:67], a[0:3], v[88:91]
ds_read_b128 a[112:115], v2 offset:16640
v_add_f32 v38, v38, v40
v_mfma_f32_16x16x32_bf16 v[112:115], a[72:75], a[8:11], v[112:115]
ds_read_b64_tr_b16 a[116:117], v10 offset:49152
v_add_f32 v39, v39, v41
v_mfma_f32_16x16x32_bf16 v[112:115], a[80:83], a[16:19], v[112:115]
s_add_u32 m0, s28, 65536
s_add_u32 s30, s30, 16384
v_exp_f32 v48, v96
v_mfma_f32_16x16x32_bf16 v[112:115], a[88:91], a[24:27], v[112:115]
buffer_load_dwordx4 v16, s[16:19], s30 offen nt lds
v_mfma_f32_16x16x32_bf16 v[116:119], a[88:91], a[28:31], v[92:95]
ds_read_b64_tr_b16 a[118:119], v10 offset:57344
ds_read_b128 a[120:123], v3 offset:16640
v_mfma_f32_16x16x32_bf16 v[116:119], a[80:83], a[20:23], v[116:119]
v_exp_f32 v49, v97
v_mfma_f32_16x16x32_bf16 v[116:119], a[72:75], a[12:15], v[116:119]
ds_read_b64_tr_b16 a[124:125], v11 offset:49152
ds_read_b64_tr_b16 a[126:127], v11 offset:57344
v_mfma_f32_16x16x32_bf16 v[116:119], a[64:67], a[4:7], v[116:119]
v_exp_f32 v50, v98
v_mfma_f32_16x16x32_bf16 v[128:131], a[68:71], v[80:83], v[128:131]
ds_read_b128 a[128:131], v0 offset:24576
ds_read_b64_tr_b16 a[132:133], v4 offset:49408
v_mfma_f32_16x16x32_bf16 v[132:135], a[68:71], v[84:87], v[132:135]
buffer_load_dwordx4 v17, s[16:19], s30 offen offset:1024 nt lds
v_mfma_f32_16x16x32_bf16 v[140:143], a[76:79], v[84:87], v[140:143]
ds_read_b64_tr_b16 a[134:135], v4 offset:57600
v_add_f32 v40, v48, v49
v_mfma_f32_16x16x32_bf16 v[136:139], a[76:79], v[80:83], v[136:139]
ds_read_b128 a[136:139], v1 offset:24576
ds_read_b64_tr_b16 a[140:141], v5 offset:49408
v_mfma_f32_16x16x32_bf16 v[144:147], a[84:87], v[80:83], v[144:147]
v_exp_f32 v51, v99
v_mfma_f32_16x16x32_bf16 v[148:151], a[84:87], v[84:87], v[148:151]
ds_read_b64_tr_b16 a[142:143], v5 offset:57600
v_cvt_pk_bf16_f32 v72, v48, v49
v_mfma_f32_16x16x32_bf16 v[156:159], a[92:95], v[84:87], v[156:159]
buffer_load_dwordx4 v18, s[16:19], s30 offen offset:2048 nt lds
v_mfma_f32_16x16x32_bf16 v[152:155], a[92:95], v[80:83], v[152:155]
ds_read_b128 a[144:147], v2 offset:24576
ds_read_b64_tr_b16 a[148:149], v6 offset:49408
v_mfma_f32_16x16x32_bf16 v[112:115], a[96:99], a[32:35], v[112:115]
s_waitcnt lgkmcnt(5)
v_exp_f32 v52, v104
v_mfma_f32_16x16x32_bf16 v[112:115], a[104:107], a[40:43], v[112:115]
ds_read_b64_tr_b16 a[150:151], v6 offset:57600
v_add_f32 v40, v40, v50
v_mfma_f32_16x16x32_bf16 v[112:115], a[112:115], a[48:51], v[112:115]
ds_read_b128 a[152:155], v3 offset:24576
ds_read_b64_tr_b16 a[156:157], v7 offset:49408
v_mfma_f32_16x16x32_bf16 v[112:115], a[120:123], a[56:59], v[112:115]
buffer_load_dwordx4 v19, s[16:19], s30 offen offset:3072 nt lds
v_mfma_f32_16x16x32_bf16 v[116:119], a[120:123], a[60:63], v[116:119]
v_exp_f32 v53, v105
v_mfma_f32_16x16x32_bf16 v[116:119], a[112:115], a[52:55], v[116:119]
ds_read_b64_tr_b16 a[158:159], v7 offset:57600
v_add_f32 v40, v40, v51
v_mfma_f32_16x16x32_bf16 v[116:119], a[104:107], a[44:47], v[116:119]
ds_read_b128 a[160:163], v0 offset:24832
ds_read_b64_tr_b16 a[164:165], v8 offset:49408
v_mfma_f32_16x16x32_bf16 v[116:119], a[96:99], a[36:39], v[116:119]
ds_read_b64_tr_b16 a[166:167], v8 offset:57600
v_cvt_pk_bf16_f32 v73, v50, v51
v_mfma_f32_16x16x32_bf16 v[160:163], a[100:103], v[80:83], v[160:163]
v_exp_f32 v54, v106
v_mfma_f32_16x16x32_bf16 v[164:167], a[100:103], v[84:87], v[164:167]
ds_read_b128 a[168:171], v1 offset:24832
v_add_f32 v40, v40, v52
v_mfma_f32_16x16x32_bf16 v[172:175], a[108:111], v[84:87], v[172:175]
v_exp_f32 v55, v107
v_mfma_f32_16x16x32_bf16 v[168:171], a[108:111], v[80:83], v[168:171]
ds_read_b64_tr_b16 a[172:173], v9 offset:49408
v_add_f32 v40, v40, v53
v_mfma_f32_16x16x32_bf16 v[176:179], a[116:119], v[80:83], v[176:179]
ds_read_b64_tr_b16 a[174:175], v9 offset:57600
v_cvt_pk_bf16_f32 v74, v52, v53
v_mfma_f32_16x16x32_bf16 v[180:183], a[116:119], v[84:87], v[180:183]
ds_read_b128 a[176:179], v2 offset:24832
ds_read_b64_tr_b16 a[180:181], v10 offset:49408
v_mfma_f32_16x16x32_bf16 v[188:191], a[124:127], v[84:87], v[188:191]
v_exp_f32 v48, v100
v_mfma_f32_16x16x32_bf16 v[184:187], a[124:127], v[80:83], v[184:187]
ds_read_b64_tr_b16 a[182:183], v10 offset:57600
v_add_f32 v40, v40, v54
v_mfma_f32_16x16x32_bf16 v[120:123], a[128:131], a[0:3], v[88:91]
s_waitcnt lgkmcnt(5)
ds_read_b128 a[184:187], v3 offset:24832
ds_read_b64_tr_b16 a[188:189], v11 offset:49408
v_mfma_f32_16x16x32_bf16 v[120:123], a[136:139], a[8:11], v[120:123]
v_exp_f32 v49, v101
v_mfma_f32_16x16x32_bf16 v[120:123], a[144:147], a[16:19], v[120:123]
ds_read_b64_tr_b16 a[190:191], v11 offset:57600
v_add_f32 v40, v40, v55
v_mfma_f32_16x16x32_bf16 v[120:123], a[152:155], a[24:27], v[120:123]
v_cvt_pk_bf16_f32 v75, v54, v55
v_mfma_f32_16x16x32_bf16 v[124:127], a[152:155], a[28:31], v[92:95]
v_exp_f32 v50, v102
v_mfma_f32_16x16x32_bf16 v[124:127], a[144:147], a[20:23], v[124:127]
v_add_f32 v41, v48, v49
v_mfma_f32_16x16x32_bf16 v[124:127], a[136:139], a[12:15], v[124:127]
v_exp_f32 v51, v103
v_mfma_f32_16x16x32_bf16 v[124:127], a[128:131], a[4:7], v[124:127]
v_cvt_pk_bf16_f32 v76, v48, v49
v_mfma_f32_16x16x32_bf16 v[192:195], a[132:135], v[80:83], v[192:195]
v_exp_f32 v52, v108
v_mfma_f32_16x16x32_bf16 v[196:199], a[132:135], v[84:87], v[196:199]
v_add_f32 v41, v41, v50
v_mfma_f32_16x16x32_bf16 v[204:207], a[140:143], v[84:87], v[204:207]
v_exp_f32 v53, v109
v_mfma_f32_16x16x32_bf16 v[200:203], a[140:143], v[80:83], v[200:203]
s_waitcnt vmcnt(16) lgkmcnt(0)
s_barrier
ds_read_b128 a[64:67], v0 offset:32768
ds_read_b64_tr_b16 a[68:69], v4 offset:0
v_mfma_f32_16x16x32_bf16 v[208:211], a[148:151], v[80:83], v[208:211]
ds_read_b64_tr_b16 a[70:71], v4 offset:8192
v_add_f32 v41, v41, v51
v_mfma_f32_16x16x32_bf16 v[212:215], a[148:151], v[84:87], v[212:215]
s_add_u32 m0, s28, 114688
s_add_u32 s29, s29, 16384
ds_read_b128 a[72:75], v1 offset:32768
v_cvt_pk_bf16_f32 v77, v50, v51
v_mfma_f32_16x16x32_bf16 v[220:223], a[156:159], v[84:87], v[220:223]
buffer_load_dwordx4 v12, s[12:15], s29 offen nt lds
v_mfma_f32_16x16x32_bf16 v[216:219], a[156:159], v[80:83], v[216:219]
v_exp_f32 v54, v110
v_mfma_f32_16x16x32_bf16 v[120:123], a[160:163], a[32:35], v[120:123]
ds_read_b64_tr_b16 a[76:77], v5 offset:0
v_add_f32 v41, v41, v52
v_mfma_f32_16x16x32_bf16 v[120:123], a[168:171], a[40:43], v[120:123]
ds_read_b64_tr_b16 a[78:79], v5 offset:8192
v_mfma_f32_16x16x32_bf16 v[120:123], a[176:179], a[48:51], v[120:123]
ds_read_b128 a[80:83], v2 offset:32768
ds_read_b64_tr_b16 a[84:85], v6 offset:0
v_mfma_f32_16x16x32_bf16 v[120:123], a[184:187], a[56:59], v[120:123]
v_exp_f32 v55, v111
v_mfma_f32_16x16x32_bf16 v[124:127], a[184:187], a[60:63], v[124:127]
buffer_load_dwordx4 v13, s[12:15], s29 offen offset:1024 nt lds
v_mfma_f32_16x16x32_bf16 v[124:127], a[176:179], a[52:55], v[124:127]
ds_read_b64_tr_b16 a[86:87], v6 offset:8192
v_add_f32 v41, v41, v53
v_mfma_f32_16x16x32_bf16 v[124:127], a[168:171], a[44:47], v[124:127]
ds_read_b128 a[88:91], v3 offset:32768
ds_read_b64_tr_b16 a[92:93], v7 offset:0
v_mfma_f32_16x16x32_bf16 v[124:127], a[160:163], a[36:39], v[124:127]
ds_read_b64_tr_b16 a[94:95], v7 offset:8192
v_cvt_pk_bf16_f32 v78, v52, v53
v_mfma_f32_16x16x32_bf16 v[224:227], a[164:167], v[80:83], v[224:227]
ds_read_b128 a[96:99], v0 offset:33024
v_add_f32 v41, v41, v54
v_mfma_f32_16x16x32_bf16 v[228:231], a[164:167], v[84:87], v[228:231]
buffer_load_dwordx4 v14, s[12:15], s29 offen offset:2048 nt lds
v_mfma_f32_16x16x32_bf16 v[236:239], a[172:175], v[84:87], v[236:239]
ds_read_b64_tr_b16 a[100:101], v8 offset:0
v_add_f32 v41, v41, v55
v_mfma_f32_16x16x32_bf16 v[232:235], a[172:175], v[80:83], v[232:235]
ds_read_b64_tr_b16 a[102:103], v8 offset:8192
v_cvt_pk_bf16_f32 v79, v54, v55
v_mfma_f32_16x16x32_bf16 v[240:243], a[180:183], v[80:83], v[240:243]
ds_read_b128 a[104:107], v1 offset:33024
v_max_f32 v45, v40, v41
v_mfma_f32_16x16x32_bf16 v[244:247], a[180:183], v[84:87], v[244:247]
ds_read_b64_tr_b16 a[108:109], v9 offset:0
v_cmp_nge_f32 vcc, 0x46800000, v45
v_mfma_f32_16x16x32_bf16 v[252:255], a[188:191], v[84:87], v[252:255]
buffer_load_dwordx4 v15, s[12:15], s29 offen offset:3072 nt lds
v_mfma_f32_16x16x32_bf16 v[248:251], a[188:191], v[80:83], v[248:251]
s_waitcnt lgkmcnt(4)
ds_read_b64_tr_b16 a[110:111], v9 offset:8192
s_cbranch_vccnz L_t_a3
L_t_a3_back:
v_mfma_f32_16x16x32_bf16 v[96:99], a[64:67], a[0:3], v[88:91]
ds_read_b128 a[112:115], v2 offset:33024
v_add_f32 v38, v38, v40
v_mfma_f32_16x16x32_bf16 v[96:99], a[72:75], a[8:11], v[96:99]
ds_read_b64_tr_b16 a[116:117], v10 offset:0
v_add_f32 v39, v39, v41
v_mfma_f32_16x16x32_bf16 v[96:99], a[80:83], a[16:19], v[96:99]
s_add_u32 m0, s28, 81920
s_add_u32 s30, s30, 16384
v_exp_f32 v48, v112
v_mfma_f32_16x16x32_bf16 v[96:99], a[88:91], a[24:27], v[96:99]
buffer_load_dwordx4 v16, s[16:19], s30 offen nt lds
v_mfma_f32_16x16x32_bf16 v[100:103], a[88:91], a[28:31], v[92:95]
ds_read_b64_tr_b16 a[118:119], v10 offset:8192
ds_read_b128 a[120:123], v3 offset:33024
v_mfma_f32_16x16x32_bf16 v[100:103], a[80:83], a[20:23], v[100:103]
v_exp_f32 v49, v113
v_mfma_f32_16x16x32_bf16 v[100:103], a[72:75], a[12:15], v[100:103]
ds_read_b64_tr_b16 a[124:125], v11 offset:0
ds_read_b64_tr_b16 a[126:127], v11 offset:8192
v_mfma_f32_16x16x32_bf16 v[100:103], a[64:67], a[4:7], v[100:103]
v_exp_f32 v50, v114
v_mfma_f32_16x16x32_bf16 v[128:131], a[68:71], v[72:75], v[128:131]
ds_read_b128 a[128:131], v0 offset:40960
ds_read_b64_tr_b16 a[132:133], v4 offset:256
v_mfma_f32_16x16x32_bf16 v[132:135], a[68:71], v[76:79], v[132:135]
buffer_load_dwordx4 v17, s[16:19], s30 offen offset:1024 nt lds
v_mfma_f32_16x16x32_bf16 v[140:143], a[76:79], v[76:79], v[140:143]
ds_read_b64_tr_b16 a[134:135], v4 offset:8448
v_add_f32 v40, v48, v49
v_mfma_f32_16x16x32_bf16 v[136:139], a[76:79], v[72:75], v[136:139]
ds_read_b128 a[136:139], v1 offset:40960
ds_read_b64_tr_b16 a[140:141], v5 offset:256
v_mfma_f32_16x16x32_bf16 v[144:147], a[84:87], v[72:75], v[144:147]
v_exp_f32 v51, v115
v_mfma_f32_16x16x32_bf16 v[148:151], a[84:87], v[76:79], v[148:151]
ds_read_b64_tr_b16 a[142:143], v5 offset:8448
v_cvt_pk_bf16_f32 v80, v48, v49
v_mfma_f32_16x16x32_bf16 v[156:159], a[92:95], v[76:79], v[156:159]
buffer_load_dwordx4 v18, s[16:19], s30 offen offset:2048 nt lds
v_mfma_f32_16x16x32_bf16 v[152:155], a[92:95], v[72:75], v[152:155]
ds_read_b128 a[144:147], v2 offset:40960
ds_read_b64_tr_b16 a[148:149], v6 offset:256
v_mfma_f32_16x16x32_bf16 v[96:99], a[96:99], a[32:35], v[96:99]
s_waitcnt lgkmcnt(5)
v_exp_f32 v52, v120
v_mfma_f32_16x16x32_bf16 v[96:99], a[104:107], a[40:43], v[96:99]
ds_read_b64_tr_b16 a[150:151], v6 offset:8448
v_add_f32 v40, v40, v50
v_mfma_f32_16x16x32_bf16 v[96:99], a[112:115], a[48:51], v[96:99]
ds_read_b128 a[152:155], v3 offset:40960
ds_read_b64_tr_b16 a[156:157], v7 offset:256
v_mfma_f32_16x16x32_bf16 v[96:99], a[120:123], a[56:59], v[96:99]
buffer_load_dwordx4 v19, s[16:19], s30 offen offset:3072 nt lds
v_mfma_f32_16x16x32_bf16 v[100:103], a[120:123], a[60:63], v[100:103]
v_exp_f32 v53, v121
v_mfma_f32_16x16x32_bf16 v[100:103], a[112:115], a[52:55], v[100:103]
ds_read_b64_tr_b16 a[158:159], v7 offset:8448
v_add_f32 v40, v40, v51
v_mfma_f32_16x16x32_bf16 v[100:103], a[104:107], a[44:47], v[100:103]
ds_read_b128 a[160:163], v0 offset:41216
ds_read_b64_tr_b16 a[164:165], v8 offset:256
v_mfma_f32_16x16x32_bf16 v[100:103], a[96:99], a[36:39], v[100:103]
ds_read_b64_tr_b16 a[166:167], v8 offset:8448
v_cvt_pk_bf16_f32 v81, v50, v51
v_mfma_f32_16x16x32_bf16 v[160:163], a[100:103], v[72:75], v[160:163]
v_exp_f32 v54, v122
v_mfma_f32_16x16x32_bf16 v[164:167], a[100:103], v[76:79], v[164:167]
ds_read_b128 a[168:171], v1 offset:41216
v_add_f32 v40, v40, v52
v_mfma_f32_16x16x32_bf16 v[172:175], a[108:111], v[76:79], v[172:175]
v_exp_f32 v55, v123
v_mfma_f32_16x16x32_bf16 v[168:171], a[108:111], v[72:75], v[168:171]
ds_read_b64_tr_b16 a[172:173], v9 offset:256
v_add_f32 v40, v40, v53
v_mfma_f32_16x16x32_bf16 v[176:179], a[116:119], v[72:75], v[176:179]
ds_read_b64_tr_b16 a[174:175], v9 offset:8448
v_cvt_pk_bf16_f32 v82, v52, v53
v_mfma_f32_16x16x32_bf16 v[180:183], a[116:119], v[76:79], v[180:183]
ds_read_b128 a[176:179], v2 offset:41216
ds_read_b64_tr_b16 a[180:181], v10 offset:256
v_mfma_f32_16x16x32_bf16 v[188:191], a[124:127], v[76:79], v[188:191]
v_exp_f32 v48, v116
v_mfma_f32_16x16x32_bf16 v[184:187], a[124:127], v[72:75], v[184:187]
ds_read_b64_tr_b16 a[182:183], v10 offset:8448
v_add_f32 v40, v40, v54
v_mfma_f32_16x16x32_bf16 v[104:107], a[128:131], a[0:3], v[88:91]
s_waitcnt lgkmcnt(5)
ds_read_b128 a[184:187], v3 offset:41216
ds_read_b64_tr_b16 a[188:189], v11 offset:256
v_mfma_f32_16x16x32_bf16 v[104:107], a[136:139], a[8:11], v[104:107]
v_exp_f32 v49, v117
v_mfma_f32_16x16x32_bf16 v[104:107], a[144:147], a[16:19], v[104:107]
ds_read_b64_tr_b16 a[190:191], v11 offset:8448
v_add_f32 v40, v40, v55
v_mfma_f32_16x16x32_bf16 v[104:107], a[152:155], a[24:27], v[104:107]
v_cvt_pk_bf16_f32 v83, v54, v55
v_mfma_f32_16x16x32_bf16 v[108:111], a[152:155], a[28:31], v[92:95]
v_exp_f32 v50, v118
v_mfma_f32_16x16x32_bf16 v[108:111], a[144:147], a[20:23], v[108:111]
v_add_f32 v41, v48, v49
v_mfma_f32_16x16x32_bf16 v[108:111], a[136:139], a[12:15], v[108:111]
v_exp_f32 v51, v119
v_mfma_f32_16x16x32_bf16 v[108:111], a[128:131], a[4:7], v[108:111]
v_cvt_pk_bf16_f32 v84, v48, v49
v_mfma_f32_16x16x32_bf16 v[192:195], a[132:135], v[72:75], v[192:195]
v_exp_f32 v52, v124
v_mfma_f32_16x16x32_bf16 v[196:199], a[132:135], v[76:79], v[196:199]
v_add_f32 v41, v41, v50
v_mfma_f32_16x16x32_bf16 v[204:207], a[140:143], v[76:79], v[204:207]
v_exp_f32 v53, v125
v_mfma_f32_16x16x32_bf16 v[200:203], a[140:143], v[72:75], v[200:203]
s_waitcnt vmcnt(16) lgkmcnt(0)
s_barrier
ds_read_b128 a[64:67], v0 offset:49152
ds_read_b64_tr_b16 a[68:69], v4 offset:16384
v_mfma_f32_16x16x32_bf16 v[208:211], a[148:151], v[72:75], v[208:211]
ds_read_b64_tr_b16 a[70:71], v4 offset:24576
v_add_f32 v41, v41, v51
v_mfma_f32_16x16x32_bf16 v[212:215], a[148:151], v[76:79], v[212:215]
s_add_u32 m0, s28, 131072
s_add_u32 s29, s29, 16384
ds_read_b128 a[72:75], v1 offset:49152
v_cvt_pk_bf16_f32 v85, v50, v51
v_mfma_f32_16x16x32_bf16 v[220:223], a[156:159], v[76:79], v[220:223]
buffer_load_dwordx4 v12, s[12:15], s29 offen nt lds
v_mfma_f32_16x16x32_bf16 v[216:219], a[156:159], v[72:75], v[216:219]
v_exp_f32 v54, v126
v_mfma_f32_16x16x32_bf16 v[104:107], a[160:163], a[32:35], v[104:107]
ds_read_b64_tr_b16 a[76:77], v5 offset:16384
v_add_f32 v41, v41, v52
v_mfma_f32_16x16x32_bf16 v[104:107], a[168:171], a[40:43], v[104:107]
ds_read_b64_tr_b16 a[78:79], v5 offset:24576
v_mfma_f32_16x16x32_bf16 v[104:107], a[176:179], a[48:51], v[104:107]
ds_read_b128 a[80:83], v2 offset:49152
ds_read_b64_tr_b16 a[84:85], v6 offset:16384
v_mfma_f32_16x16x32_bf16 v[104:107], a[184:187], a[56:59], v[104:107]
v_exp_f32 v55, v127
v_mfma_f32_16x16x32_bf16 v[108:111], a[184:187], a[60:63], v[108:111]
buffer_load_dwordx4 v13, s[12:15], s29 offen offset:1024 nt lds
v_mfma_f32_16x16x32_bf16 v[108:111], a[176:179], a[52:55], v[108:111]
ds_read_b64_tr_b16 a[86:87], v6 offset:24576
v_add_f32 v41, v41, v53
v_mfma_f32_16x16x32_bf16 v[108:111], a[168:171], a[44:47], v[108:111]
ds_read_b128 a[88:91], v3 offset:49152
ds_read_b64_tr_b16 a[92:93], v7 offset:16384
v_mfma_f32_16x16x32_bf16 v[108:111], a[160:163], a[36:39], v[108:111]
ds_read_b64_tr_b16 a[94:95], v7 offset:24576
v_cvt_pk_bf16_f32 v86, v52, v53
v_mfma_f32_16x16x32_bf16 v[224:227], a[164:167], v[72:75], v[224:227]
ds_read_b128 a[96:99], v0 offset:49408
v_add_f32 v41, v41, v54
v_mfma_f32_16x16x32_bf16 v[228:231], a[164:167], v[76:79], v[228:231]
buffer_load_dwordx4 v14, s[12:15], s29 offen offset:2048 nt lds
v_mfma_f32_16x16x32_bf16 v[236:239], a[172:175], v[76:79], v[236:239]
ds_read_b64_tr_b16 a[100:101], v8 offset:16384
v_add_f32 v41, v41, v55
v_mfma_f32_16x16x32_bf16 v[232:235], a[172:175], v[72:75], v[232:235]
ds_read_b64_tr_b16 a[102:103], v8 offset:24576
v_cvt_pk_bf16_f32 v87, v54, v55
v_mfma_f32_16x16x32_bf16 v[240:243], a[180:183], v[72:75], v[240:243]
ds_read_b128 a[104:107], v1 offset:49408
v_max_f32 v45, v40, v41
v_mfma_f32_16x16x32_bf16 v[244:247], a[180:183], v[76:79], v[244:247]
ds_read_b64_tr_b16 a[108:109], v9 offset:16384
v_cmp_nge_f32 vcc, 0x46800000, v45
v_mfma_f32_16x16x32_bf16 v[252:255], a[188:191], v[76:79], v[252:255]
buffer_load_dwordx4 v15, s[12:15], s29 offen offset:3072 nt lds
v_mfma_f32_16x16x32_bf16 v[248:251], a[188:191], v[72:75], v[248:251]
s_waitcnt lgkmcnt(4)
ds_read_b64_tr_b16 a[110:111], v9 offset:24576
s_cbranch_vccnz L_t_a4
L_t_a4_back:
v_mfma_f32_16x16x32_bf16 v[112:115], a[64:67], a[0:3], v[88:91]
s_sub_u32 s31, s31, 1
ds_read_b128 a[112:115], v2 offset:49408
v_add_f32 v38, v38, v40
v_mfma_f32_16x16x32_bf16 v[112:115], a[72:75], a[8:11], v[112:115]
ds_read_b64_tr_b16 a[116:117], v10 offset:16384
v_add_f32 v39, v39, v41
v_mfma_f32_16x16x32_bf16 v[112:115], a[80:83], a[16:19], v[112:115]
s_add_u32 m0, s28, 32768
s_add_u32 s30, s30, 16384
v_exp_f32 v48, v96
v_mfma_f32_16x16x32_bf16 v[112:115], a[88:91], a[24:27], v[112:115]
buffer_load_dwordx4 v16, s[16:19], s30 offen nt lds
v_mfma_f32_16x16x32_bf16 v[116:119], a[88:91], a[28:31], v[92:95]
ds_read_b64_tr_b16 a[118:119], v10 offset:24576
ds_read_b128 a[120:123], v3 offset:49408
v_mfma_f32_16x16x32_bf16 v[116:119], a[80:83], a[20:23], v[116:119]
v_exp_f32 v49, v97
v_mfma_f32_16x16x32_bf16 v[116:119], a[72:75], a[12:15], v[116:119]
ds_read_b64_tr_b16 a[124:125], v11 offset:16384
ds_read_b64_tr_b16 a[126:127], v11 offset:24576
v_mfma_f32_16x16x32_bf16 v[116:119], a[64:67], a[4:7], v[116:119]
v_exp_f32 v50, v98
v_mfma_f32_16x16x32_bf16 v[128:131], a[68:71], v[80:83], v[128:131]
ds_read_b128 a[128:131], v0 offset:57344
ds_read_b64_tr_b16 a[132:133], v4 offset:16640
v_mfma_f32_16x16x32_bf16 v[132:135], a[68:71], v[84:87], v[132:135]
buffer_load_dwordx4 v17, s[16:19], s30 offen offset:1024 nt lds
v_mfma_f32_16x16x32_bf16 v[140:143], a[76:79], v[84:87], v[140:143]
ds_read_b64_tr_b16 a[134:135], v4 offset:24832
v_add_f32 v40, v48, v49
v_mfma_f32_16x16x32_bf16 v[136:139], a[76:79], v[80:83], v[136:139]
ds_read_b128 a[136:139], v1 offset:57344
ds_read_b64_tr_b16 a[140:141], v5 offset:16640
v_mfma_f32_16x16x32_bf16 v[144:147], a[84:87], v[80:83], v[144:147]
v_exp_f32 v51, v99
v_mfma_f32_16x16x32_bf16 v[148:151], a[84:87], v[84:87], v[148:151]
ds_read_b64_tr_b16 a[142:143], v5 offset:24832
v_cvt_pk_bf16_f32 v72, v48, v49
v_mfma_f32_16x16x32_bf16 v[156:159], a[92:95], v[84:87], v[156:159]
buffer_load_dwordx4 v18, s[16:19], s30 offen offset:2048 nt lds
v_mfma_f32_16x16x32_bf16 v[152:155], a[92:95], v[80:83], v[152:155]
ds_read_b128 a[144:147], v2 offset:57344
ds_read_b64_tr_b16 a[148:149], v6 offset:16640
v_mfma_f32_16x16x32_bf16 v[112:115], a[96:99], a[32:35], v[112:115]
s_waitcnt lgkmcnt(5)
v_exp_f32 v52, v104
v_mfma_f32_16x16x32_bf16 v[112:115], a[104:107], a[40:43], v[112:115]
ds_read_b64_tr_b16 a[150:151], v6 offset:24832
v_add_f32 v40, v40, v50
v_mfma_f32_16x16x32_bf16 v[112:115], a[112:115], a[48:51], v[112:115]
ds_read_b128 a[152:155], v3 offset:57344
ds_read_b64_tr_b16 a[156:157], v7 offset:16640
v_mfma_f32_16x16x32_bf16 v[112:115], a[120:123], a[56:59], v[112:115]
buffer_load_dwordx4 v19, s[16:19], s30 offen offset:3072 nt lds
v_mfma_f32_16x16x32_bf16 v[116:119], a[120:123], a[60:63], v[116:119]
v_exp_f32 v53, v105
v_mfma_f32_16x16x32_bf16 v[116:119], a[112:115], a[52:55], v[116:119]
ds_read_b64_tr_b16 a[158:159], v7 offset:24832
v_add_f32 v40, v40, v51
v_mfma_f32_16x16x32_bf16 v[116:119], a[104:107], a[44:47], v[116:119]
ds_read_b128 a[160:163], v0 offset:57600
ds_read_b64_tr_b16 a[164:165], v8 offset:16640
v_mfma_f32_16x16x32_bf16 v[116:119], a[96:99], a[36:39], v[116:119]
ds_read_b64_tr_b16 a[166:167], v8 offset:24832
v_cvt_pk_bf16_f32 v73, v50, v51
v_mfma_f32_16x16x32_bf16 v[160:163], a[100:103], v[80:83], v[160:163]
v_exp_f32 v54, v106
v_mfma_f32_16x16x32_bf16 v[164:167], a[100:103], v[84:87], v[164:167]
ds_read_b128 a[168:171], v1 offset:57600
v_add_f32 v40, v40, v52
v_mfma_f32_16x16x32_bf16 v[172:175], a[108:111], v[84:87], v[172:175]
v_exp_f32 v55, v107
v_mfma_f32_16x16x32_bf16 v[168:171], a[108:111], v[80:83], v[168:171]
ds_read_b64_tr_b16 a[172:173], v9 offset:16640
v_add_f32 v40, v40, v53
v_mfma_f32_16x16x32_bf16 v[176:179], a[116:119], v[80:83], v[176:179]
ds_read_b64_tr_b16 a[174:175], v9 offset:24832
v_cvt_pk_bf16_f32 v74, v52, v53
v_mfma_f32_16x16x32_bf16 v[180:183], a[116:119], v[84:87], v[180:183]
ds_read_b128 a[176:179], v2 offset:57600
ds_read_b64_tr_b16 a[180:181], v10 offset:16640
v_mfma_f32_16x16x32_bf16 v[188:191], a[124:127], v[84:87], v[188:191]
v_exp_f32 v48, v100
v_mfma_f32_16x16x32_bf16 v[184:187], a[124:127], v[80:83], v[184:187]
ds_read_b64_tr_b16 a[182:183], v10 offset:24832
v_add_f32 v40, v40, v54
v_mfma_f32_16x16x32_bf16 v[120:123], a[128:131], a[0:3], v[88:91]
s_waitcnt lgkmcnt(5)
ds_read_b128 a[184:187], v3 offset:57600
ds_read_b64_tr_b16 a[188:189], v11 offset:16640
v_mfma_f32_16x16x32_bf16 v[120:123], a[136:139], a[8:11], v[120:123]
v_exp_f32 v49, v101
v_mfma_f32_16x16x32_bf16 v[120:123], a[144:147], a[16:19], v[120:123]
ds_read_b64_tr_b16 a[190:191], v11 offset:24832
v_add_f32 v40, v40, v55
v_mfma_f32_16x16x32_bf16 v[120:123], a[152:155], a[24:27], v[120:123]
v_cvt_pk_bf16_f32 v75, v54, v55
v_mfma_f32_16x16x32_bf16 v[124:127], a[152:155], a[28:31], v[92:95]
v_exp_f32 v50, v102
v_mfma_f32_16x16x32_bf16 v[124:127], a[144:147], a[20:23], v[124:127]
v_add_f32 v41, v48, v49
v_mfma_f32_16x16x32_bf16 v[124:127], a[136:139], a[12:15], v[124:127]
v_exp_f32 v51, v103
v_mfma_f32_16x16x32_bf16 v[124:127], a[128:131], a[4:7], v[124:127]
v_cvt_pk_bf16_f32 v76, v48, v49
v_mfma_f32_16x16x32_bf16 v[192:195], a[132:135], v[80:83], v[192:195]
v_exp_f32 v52, v108
v_mfma_f32_16x16x32_bf16 v[196:199], a[132:135], v[84:87], v[196:199]
v_add_f32 v41, v41, v50
v_mfma_f32_16x16x32_bf16 v[204:207], a[140:143], v[84:87], v[204:207]
v_exp_f32 v53, v109
v_mfma_f32_16x16x32_bf16 v[200:203], a[140:143], v[80:83], v[200:203]
s_waitcnt vmcnt(16) lgkmcnt(0)
s_barrier
ds_read_b128 a[64:67], v0 offset:0
ds_read_b64_tr_b16 a[68:69], v4 offset:32768
v_mfma_f32_16x16x32_bf16 v[208:211], a[148:151], v[80:83], v[208:211]
ds_read_b64_tr_b16 a[70:71], v4 offset:40960
v_add_f32 v41, v41, v51
v_mfma_f32_16x16x32_bf16 v[212:215], a[148:151], v[84:87], v[212:215]
s_add_u32 m0, s28, 147456
s_add_u32 s29, s29, 16384
ds_read_b128 a[72:75], v1 offset:0
v_cvt_pk_bf16_f32 v77, v50, v51
v_mfma_f32_16x16x32_bf16 v[220:223], a[156:159], v[84:87], v[220:223]
buffer_load_dwordx4 v12, s[12:15], s29 offen nt lds
v_mfma_f32_16x16x32_bf16 v[216:219], a[156:159], v[80:83], v[216:219]
v_exp_f32 v54, v110
v_mfma_f32_16x16x32_bf16 v[120:123], a[160:163], a[32:35], v[120:123]
ds_read_b64_tr_b16 a[76:77], v5 offset:32768
v_add_f32 v41, v41, v52
v_mfma_f32_16x16x32_bf16 v[120:123], a[168:171], a[40:43], v[120:123]
ds_read_b64_tr_b16 a[78:79], v5 offset:40960
v_mfma_f32_16x16x32_bf16 v[120:123], a[176:179], a[48:51], v[120:123]
ds_read_b128 a[80:83], v2 offset:0
ds_read_b64_tr_b16 a[84:85], v6 offset:32768
v_mfma_f32_16x16x32_bf16 v[120:123], a[184:187], a[56:59], v[120:123]
v_exp_f32 v55, v111
v_mfma_f32_16x16x32_bf16 v[124:127], a[184:187], a[60:63], v[124:127]
buffer_load_dwordx4 v13, s[12:15], s29 offen offset:1024 nt lds
v_mfma_f32_16x16x32_bf16 v[124:127], a[176:179], a[52:55], v[124:127]
ds_read_b64_tr_b16 a[86:87], v6 offset:40960
v_add_f32 v41, v41, v53
v_mfma_f32_16x16x32_bf16 v[124:127], a[168:171], a[44:47], v[124:127]
ds_read_b128 a[88:91], v3 offset:0
ds_read_b64_tr_b16 a[92:93], v7 offset:32768
v_mfma_f32_16x16x32_bf16 v[124:127], a[160:163], a[36:39], v[124:127]
ds_read_b64_tr_b16 a[94:95], v7 offset:40960
v_cvt_pk_bf16_f32 v78, v52, v53
v_mfma_f32_16x16x32_bf16 v[224:227], a[164:167], v[80:83], v[224:227]
ds_read_b128 a[96:99], v0 offset:256
v_add_f32 v41, v41, v54
v_mfma_f32_16x16x32_bf16 v[228:231], a[164:167], v[84:87], v[228:231]
buffer_load_dwordx4 v14, s[12:15], s29 offen offset:2048 nt lds
v_mfma_f32_16x16x32_bf16 v[236:239], a[172:175], v[84:87], v[236:239]
ds_read_b64_tr_b16 a[100:101], v8 offset:32768
v_add_f32 v41, v41, v55
v_mfma_f32_16x16x32_bf16 v[232:235], a[172:175], v[80:83], v[232:235]
ds_read_b64_tr_b16 a[102:103], v8 offset:40960
v_cvt_pk_bf16_f32 v79, v54, v55
v_mfma_f32_16x16x32_bf16 v[240:243], a[180:183], v[80:83], v[240:243]
ds_read_b128 a[104:107], v1 offset:256
v_max_f32 v45, v40, v41
v_mfma_f32_16x16x32_bf16 v[244:247], a[180:183], v[84:87], v[244:247]
ds_read_b64_tr_b16 a[108:109], v9 offset:32768
v_cmp_nge_f32 vcc, 0x46800000, v45
v_mfma_f32_16x16x32_bf16 v[252:255], a[188:191], v[84:87], v[252:255]
buffer_load_dwordx4 v15, s[12:15], s29 offen offset:3072 nt lds
v_mfma_f32_16x16x32_bf16 v[248:251], a[188:191], v[80:83], v[248:251]
s_waitcnt lgkmcnt(4)
ds_read_b64_tr_b16 a[110:111], v9 offset:40960
s_cbranch_vccnz L_t_a5
L_t_a5_back:
s_cmp_lg_u32 s31, 0
s_cbranch_scc1 L_loop
v_mfma_f32_16x16x32_bf16 v[96:99], a[64:67], a[0:3], v[88:91]
ds_read_b128 a[112:115], v2 offset:256
v_add_f32 v38, v38, v40
v_mfma_f32_16x16x32_bf16 v[96:99], a[72:75], a[8:11], v[96:99]
ds_read_b64_tr_b16 a[116:117], v10 offset:32768
v_add_f32 v39, v39, v41
v_mfma_f32_16x16x32_bf16 v[96:99], a[80:83], a[16:19], v[96:99]
s_add_u32 m0, s28, 49152
s_add_u32 s30, s30, 16384
v_exp_f32 v48, v112
v_mfma_f32_16x16x32_bf16 v[96:99], a[88:91], a[24:27], v[96:99]
buffer_load_dwordx4 v16, s[16:19], s30 offen nt lds
v_mfma_f32_16x16x32_bf16 v[100:103], a[88:91], a[28:31], v[92:95]
ds_read_b64_tr_b16 a[118:119], v10 offset:40960
ds_read_b128 a[120:123], v3 offset:256
v_mfma_f32_16x16x32_bf16 v[100:103], a[80:83], a[20:23], v[100:103]
v_exp_f32 v49, v113
v_mfma_f32_16x16x32_bf16 v[100:103], a[72:75], a[12:15], v[100:103]
ds_read_b64_tr_b16 a[124:125], v11 offset:32768
ds_read_b64_tr_b16 a[126:127], v11 offset:40960
v_mfma_f32_16x16x32_bf16 v[100:103], a[64:67], a[4:7], v[100:103]
v_exp_f32 v50, v114
v_mfma_f32_16x16x32_bf16 v[128:131], a[68:71], v[72:75], v[128:131]
ds_read_b128 a[128:131], v0 offset:8192
ds_read_b64_tr_b16 a[132:133], v4 offset:33024
v_mfma_f32_16x16x32_bf16 v[132:135], a[68:71], v[76:79], v[132:135]
buffer_load_dwordx4 v17, s[16:19], s30 offen offset:1024 nt lds
v_mfma_f32_16x16x32_bf16 v[140:143], a[76:79], v[76:79], v[140:143]
ds_read_b64_tr_b16 a[134:135], v4 offset:41216
v_add_f32 v40, v48, v49
v_mfma_f32_16x16x32_bf16 v[136:139], a[76:79], v[72:75], v[136:139]
ds_read_b128 a[136:139], v1 offset:8192
ds_read_b64_tr_b16 a[140:141], v5 offset:33024
v_mfma_f32_16x16x32_bf16 v[144:147], a[84:87], v[72:75], v[144:147]
v_exp_f32 v51, v115
v_mfma_f32_16x16x32_bf16 v[148:151], a[84:87], v[76:79], v[148:151]
ds_read_b64_tr_b16 a[142:143], v5 offset:41216
v_cvt_pk_bf16_f32 v80, v48, v49
v_mfma_f32_16x16x32_bf16 v[156:159], a[92:95], v[76:79], v[156:159]
buffer_load_dwordx4 v18, s[16:19], s30 offen offset:2048 nt lds
v_mfma_f32_16x16x32_bf16 v[152:155], a[92:95], v[72:75], v[152:155]
ds_read_b128 a[144:147], v2 offset:8192
ds_read_b64_tr_b16 a[148:149], v6 offset:33024
v_mfma_f32_16x16x32_bf16 v[96:99], a[96:99], a[32:35], v[96:99]
s_waitcnt lgkmcnt(5)
v_exp_f32 v52, v120
v_mfma_f32_16x16x32_bf16 v[96:99], a[104:107], a[40:43], v[96:99]
ds_read_b64_tr_b16 a[150:151], v6 offset:41216
v_add_f32 v40, v40, v50
v_mfma_f32_16x16x32_bf16 v[96:99], a[112:115], a[48:51], v[96:99]
ds_read_b128 a[152:155], v3 offset:8192
ds_read_b64_tr_b16 a[156:157], v7 offset:33024
v_mfma_f32_16x16x32_bf16 v[96:99], a[120:123], a[56:59], v[96:99]
buffer_load_dwordx4 v19, s[16:19], s30 offen offset:3072 nt lds
v_mfma_f32_16x16x32_bf16 v[100:103], a[120:123], a[60:63], v[100:103]
v_exp_f32 v53, v121
v_mfma_f32_16x16x32_bf16 v[100:103], a[112:115], a[52:55], v[100:103]
ds_read_b64_tr_b16 a[158:159], v7 offset:41216
v_add_f32 v40, v40, v51
v_mfma_f32_16x16x32_bf16 v[100:103], a[104:107], a[44:47], v[100:103]
ds_read_b128 a[160:163], v0 offset:8448
ds_read_b64_tr_b16 a[164:165], v8 offset:33024
v_mfma_f32_16x16x32_bf16 v[100:103], a[96:99], a[36:39], v[100:103]
ds_read_b64_tr_b16 a[166:167], v8 offset:41216
v_cvt_pk_bf16_f32 v81, v50, v51
v_mfma_f32_16x16x32_bf16 v[160:163], a[100:103], v[72:75], v[160:163]
v_exp_f32 v54, v122
v_mfma_f32_16x16x32_bf16 v[164:167], a[100:103], v[76:79], v[164:167]
ds_read_b128 a[168:171], v1 offset:8448
v_add_f32 v40, v40, v52
v_mfma_f32_16x16x32_bf16 v[172:175], a[108:111], v[76:79], v[172:175]
v_exp_f32 v55, v123
v_mfma_f32_16x16x32_bf16 v[168:171], a[108:111], v[72:75], v[168:171]
ds_read_b64_tr_b16 a[172:173], v9 offset:33024
v_add_f32 v40, v40, v53
v_mfma_f32_16x16x32_bf16 v[176:179], a[116:119], v[72:75], v[176:179]
ds_read_b64_tr_b16 a[174:175], v9 offset:41216
v_cvt_pk_bf16_f32 v82, v52, v53
v_mfma_f32_16x16x32_bf16 v[180:183], a[116:119], v[76:79], v[180:183]
ds_read_b128 a[176:179], v2 offset:8448
ds_read_b64_tr_b16 a[180:181], v10 offset:33024
v_mfma_f32_16x16x32_bf16 v[188:191], a[124:127], v[76:79], v[188:191]
v_exp_f32 v48, v116
v_mfma_f32_16x16x32_bf16 v[184:187], a[124:127], v[72:75], v[184:187]
ds_read_b64_tr_b16 a[182:183], v10 offset:41216
v_add_f32 v40, v40, v54
v_mfma_f32_16x16x32_bf16 v[104:107], a[128:131], a[0:3], v[88:91]
s_waitcnt lgkmcnt(5)
ds_read_b128 a[184:187], v3 offset:8448
ds_read_b64_tr_b16 a[188:189], v11 offset:33024
v_mfma_f32_16x16x32_bf16 v[104:107], a[136:139], a[8:11], v[104:107]
v_exp_f32 v49, v117
v_mfma_f32_16x16x32_bf16 v[104:107], a[144:147], a[16:19], v[104:107]
ds_read_b64_tr_b16 a[190:191], v11 offset:41216
v_add_f32 v40, v40, v55
v_mfma_f32_16x16x32_bf16 v[104:107], a[152:155], a[24:27], v[104:107]
v_cvt_pk_bf16_f32 v83, v54, v55
v_mfma_f32_16x16x32_bf16 v[108:111], a[152:155], a[28:31], v[92:95]
v_exp_f32 v50, v118
v_mfma_f32_16x16x32_bf16 v[108:111], a[144:147], a[20:23], v[108:111]
v_add_f32 v41, v48, v49
v_mfma_f32_16x16x32_bf16 v[108:111], a[136:139], a[12:15], v[108:111]
v_exp_f32 v51, v119
v_mfma_f32_16x16x32_bf16 v[108:111], a[128:131], a[4:7], v[108:111]
v_cvt_pk_bf16_f32 v84, v48, v49
v_mfma_f32_16x16x32_bf16 v[192:195], a[132:135], v[72:75], v[192:195]
v_exp_f32 v52, v124
v_mfma_f32_16x16x32_bf16 v[196:199], a[132:135], v[76:79], v[196:199]
v_add_f32 v41, v41, v50
v_mfma_f32_16x16x32_bf16 v[204:207], a[140:143], v[76:79], v[204:207]
v_exp_f32 v53, v125
v_mfma_f32_16x16x32_bf16 v[200:203], a[140:143], v[72:75], v[200:203]
s_waitcnt vmcnt(16) lgkmcnt(0)
s_barrier
ds_read_b128 a[64:67], v0 offset:16384
ds_read_b64_tr_b16 a[68:69], v4 offset:49152
v_mfma_f32_16x16x32_bf16 v[208:211], a[148:151], v[72:75], v[208:211]
ds_read_b64_tr_b16 a[70:71], v4 offset:57344
v_add_f32 v41, v41, v51
v_mfma_f32_16x16x32_bf16 v[212:215], a[148:151], v[76:79], v[212:215]
s_add_u32 m0, s28, 98304
s_add_u32 s76, s33, 0
ds_read_b128 a[72:75], v1 offset:16384
v_cvt_pk_bf16_f32 v85, v50, v51
v_mfma_f32_16x16x32_bf16 v[220:223], a[156:159], v[76:79], v[220:223]
buffer_load_dwordx4 v20, s[20:23], s76 offen lds
v_mfma_f32_16x16x32_bf16 v[216:219], a[156:159], v[72:75], v[216:219]
v_exp_f32 v54, v126
v_mfma_f32_16x16x32_bf16 v[104:107], a[160:163], a[32:35], v[104:107]
ds_read_b64_tr_b16 a[76:77], v5 offset:49152
v_add_f32 v41, v41, v52
v_mfma_f32_16x16x32_bf16 v[104:107], a[168:171], a[40:43], v[104:107]
ds_read_b64_tr_b16 a[78:79], v5 offset:57344
v_mfma_f32_16x16x32_bf16 v[104:107], a[176:179], a[48:51], v[104:107]
ds_read_b128 a[80:83], v2 offset:16384
ds_read_b64_tr_b16 a[84:85], v6 offset:49152
v_mfma_f32_16x16x32_bf16 v[104:107], a[184:187], a[56:59], v[104:107]
v_exp_f32 v55, v127
v_mfma_f32_16x16x32_bf16 v[108:111], a[184:187], a[60:63], v[108:111]
buffer_load_dwordx4 v21, s[20:23], s76 offen offset:1024 lds
v_mfma_f32_16x16x32_bf16 v[108:111], a[176:179], a[52:55], v[108:111]
ds_read_b64_tr_b16 a[86:87], v6 offset:57344
v_add_f32 v41, v41, v53
v_mfma_f32_16x16x32_bf16 v[108:111], a[168:171], a[44:47], v[108:111]
ds_read_b128 a[88:91], v3 offset:16384
ds_read_b64_tr_b16 a[92:93], v7 offset:49152
v_mfma_f32_16x16x32_bf16 v[108:111], a[160:163], a[36:39], v[108:111]
ds_read_b64_tr_b16 a[94:95], v7 offset:57344
v_cvt_pk_bf16_f32 v86, v52, v53
v_mfma_f32_16x16x32_bf16 v[224:227], a[164:167], v[72:75], v[224:227]
ds_read_b128 a[96:99], v0 offset:16640
v_add_f32 v41, v41, v54
v_mfma_f32_16x16x32_bf16 v[228:231], a[164:167], v[76:79], v[228:231]
buffer_load_dwordx4 v22, s[20:23], s76 offen offset:2048 lds
v_mfma_f32_16x16x32_bf16 v[236:239], a[172:175], v[76:79], v[236:239]
ds_read_b64_tr_b16 a[100:101], v8 offset:49152
v_add_f32 v41, v41, v55
v_mfma_f32_16x16x32_bf16 v[232:235], a[172:175], v[72:75], v[232:235]
ds_read_b64_tr_b16 a[102:103], v8 offset:57344
v_cvt_pk_bf16_f32 v87, v54, v55
v_mfma_f32_16x16x32_bf16 v[240:243], a[180:183], v[72:75], v[240:243]
ds_read_b128 a[104:107], v1 offset:16640
v_max_f32 v45, v40, v41
v_mfma_f32_16x16x32_bf16 v[244:247], a[180:183], v[76:79], v[244:247]
ds_read_b64_tr_b16 a[108:109], v9 offset:49152
v_cmp_nge_f32 vcc, 0x46800000, v45
v_mfma_f32_16x16x32_bf16 v[252:255], a[188:191], v[76:79], v[252:255]
buffer_load_dwordx4 v23, s[20:23], s76 offen offset:3072 lds
v_mfma_f32_16x16x32_bf16 v[248:251], a[188:191], v[72:75], v[248:251]
s_waitcnt lgkmcnt(4)
ds_read_b64_tr_b16 a[110:111], v9 offset:57344
s_cbranch_vccnz L_t_a58
L_t_a58_back:
v_mfma_f32_16x16x32_bf16 v[112:115], a[64:67], a[0:3], v[88:91]
ds_read_b128 a[112:115], v2 offset:16640
v_add_f32 v38, v38, v40
v_mfma_f32_16x16x32_bf16 v[112:115], a[72:75], a[8:11], v[112:115]
ds_read_b64_tr_b16 a[116:117], v10 offset:49152
v_add_f32 v39, v39, v41
v_mfma_f32_16x16x32_bf16 v[112:115], a[80:83], a[16:19], v[112:115]
s_add_u32 m0, s28, 65536
s_add_u32 s30, s30, 16384
v_exp_f32 v48, v96
v_mfma_f32_16x16x32_bf16 v[112:115], a[88:91], a[24:27], v[112:115]
buffer_load_dwordx4 v16, s[16:19], s30 offen nt lds
v_mfma_f32_16x16x32_bf16 v[116:119], a[88:91], a[28:31], v[92:95]
ds_read_b64_tr_b16 a[118:119], v10 offset:57344
ds_read_b128 a[120:123], v3 offset:16640
v_mfma_f32_16x16x32_bf16 v[116:119], a[80:83], a[20:23], v[116:119]
v_exp_f32 v49, v97
v_mfma_f32_16x16x32_bf16 v[116:119], a[72:75], a[12:15], v[116:119]
ds_read_b64_tr_b16 a[124:125], v11 offset:49152
ds_read_b64_tr_b16 a[126:127], v11 offset:57344
v_mfma_f32_16x16x32_bf16 v[116:119], a[64:67], a[4:7], v[116:119]
v_exp_f32 v50, v98
v_mfma_f32_16x16x32_bf16 v[128:131], a[68:71], v[80:83], v[128:131]
ds_read_b128 a[128:131], v0 offset:24576
ds_read_b64_tr_b16 a[132:133], v4 offset:49408
v_mfma_f32_16x16x32_bf16 v[132:135], a[68:71], v[84:87], v[132:135]
buffer_load_dwordx4 v17, s[16:19], s30 offen offset:1024 nt lds
v_mfma_f32_16x16x32_bf16 v[140:143], a[76:79], v[84:87], v[140:143]
ds_read_b64_tr_b16 a[134:135], v4 offset:57600
v_add_f32 v40, v48, v49
v_mfma_f32_16x16x32_bf16 v[136:139], a[76:79], v[80:83], v[136:139]
ds_read_b128 a[136:139], v1 offset:24576
ds_read_b64_tr_b16 a[140:141], v5 offset:49408
v_mfma_f32_16x16x32_bf16 v[144:147], a[84:87], v[80:83], v[144:147]
v_exp_f32 v51, v99
v_mfma_f32_16x16x32_bf16 v[148:151], a[84:87], v[84:87], v[148:151]
ds_read_b64_tr_b16 a[142:143], v5 offset:57600
v_cvt_pk_bf16_f32 v72, v48, v49
v_mfma_f32_16x16x32_bf16 v[156:159], a[92:95], v[84:87], v[156:159]
buffer_load_dwordx4 v18, s[16:19], s30 offen offset:2048 nt lds
v_mfma_f32_16x16x32_bf16 v[152:155], a[92:95], v[80:83], v[152:155]
ds_read_b128 a[144:147], v2 offset:24576
ds_read_b64_tr_b16 a[148:149], v6 offset:49408
v_mfma_f32_16x16x32_bf16 v[112:115], a[96:99], a[32:35], v[112:115]
s_waitcnt lgkmcnt(5)
v_exp_f32 v52, v104
v_mfma_f32_16x16x32_bf16 v[112:115], a[104:107], a[40:43], v[112:115]
ds_read_b64_tr_b16 a[150:151], v6 offset:57600
v_add_f32 v40, v40, v50
v_mfma_f32_16x16x32_bf16 v[112:115], a[112:115], a[48:51], v[112:115]
ds_read_b128 a[152:155], v3 offset:24576
ds_read_b64_tr_b16 a[156:157], v7 offset:49408
v_mfma_f32_16x16x32_bf16 v[112:115], a[120:123], a[56:59], v[112:115]
buffer_load_dwordx4 v19, s[16:19], s30 offen offset:3072 nt lds
v_mfma_f32_16x16x32_bf16 v[116:119], a[120:123], a[60:63], v[116:119]
v_exp_f32 v53, v105
v_mfma_f32_16x16x32_bf16 v[116:119], a[112:115], a[52:55], v[116:119]
ds_read_b64_tr_b16 a[158:159], v7 offset:57600
v_add_f32 v40, v40, v51
v_mfma_f32_16x16x32_bf16 v[116:119], a[104:107], a[44:47], v[116:119]
ds_read_b128 a[160:163], v0 offset:24832
ds_read_b64_tr_b16 a[164:165], v8 offset:49408
v_mfma_f32_16x16x32_bf16 v[116:119], a[96:99], a[36:39], v[116:119]
ds_read_b64_tr_b16 a[166:167], v8 offset:57600
v_cvt_pk_bf16_f32 v73, v50, v51
v_mfma_f32_16x16x32_bf16 v[160:163], a[100:103], v[80:83], v[160:163]
v_exp_f32 v54, v106
v_mfma_f32_16x16x32_bf16 v[164:167], a[100:103], v[84:87], v[164:167]
ds_read_b128 a[168:171], v1 offset:24832
v_add_f32 v40, v40, v52
v_mfma_f32_16x16x32_bf16 v[172:175], a[108:111], v[84:87], v[172:175]
v_exp_f32 v55, v107
v_mfma_f32_16x16x32_bf16 v[168:171], a[108:111], v[80:83], v[168:171]
ds_read_b64_tr_b16 a[172:173], v9 offset:49408
v_add_f32 v40, v40, v53
v_mfma_f32_16x16x32_bf16 v[176:179], a[116:119], v[80:83], v[176:179]
ds_read_b64_tr_b16 a[174:175], v9 offset:57600
v_cvt_pk_bf16_f32 v74, v52, v53
v_mfma_f32_16x16x32_bf16 v[180:183], a[116:119], v[84:87], v[180:183]
ds_read_b128 a[176:179], v2 offset:24832
ds_read_b64_tr_b16 a[180:181], v10 offset:49408
v_mfma_f32_16x16x32_bf16 v[188:191], a[124:127], v[84:87], v[188:191]
v_exp_f32 v48, v100
v_mfma_f32_16x16x32_bf16 v[184:187], a[124:127], v[80:83], v[184:187]
ds_read_b64_tr_b16 a[182:183], v10 offset:57600
v_add_f32 v40, v40, v54
v_mfma_f32_16x16x32_bf16 v[120:123], a[128:131], a[0:3], v[88:91]
s_waitcnt lgkmcnt(5)
ds_read_b128 a[184:187], v3 offset:24832
ds_read_b64_tr_b16 a[188:189], v11 offset:49408
v_mfma_f32_16x16x32_bf16 v[120:123], a[136:139], a[8:11], v[120:123]
v_exp_f32 v49, v101
v_mfma_f32_16x16x32_bf16 v[120:123], a[144:147], a[16:19], v[120:123]
ds_read_b64_tr_b16 a[190:191], v11 offset:57600
v_add_f32 v40, v40, v55
v_mfma_f32_16x16x32_bf16 v[120:123], a[152:155], a[24:27], v[120:123]
v_cvt_pk_bf16_f32 v75, v54, v55
v_mfma_f32_16x16x32_bf16 v[124:127], a[152:155], a[28:31], v[92:95]
v_exp_f32 v50, v102
v_mfma_f32_16x16x32_bf16 v[124:127], a[144:147], a[20:23], v[124:127]
v_add_f32 v41, v48, v49
v_mfma_f32_16x16x32_bf16 v[124:127], a[136:139], a[12:15], v[124:127]
v_exp_f32 v51, v103
v_mfma_f32_16x16x32_bf16 v[124:127], a[128:131], a[4:7], v[124:127]
v_cvt_pk_bf16_f32 v76, v48, v49
v_mfma_f32_16x16x32_bf16 v[192:195], a[132:135], v[80:83], v[192:195]
v_exp_f32 v52, v108
v_mfma_f32_16x16x32_bf16 v[196:199], a[132:135], v[84:87], v[196:199]
v_add_f32 v41, v41, v50
v_mfma_f32_16x16x32_bf16 v[204:207], a[140:143], v[84:87], v[204:207]
v_exp_f32 v53, v109
v_mfma_f32_16x16x32_bf16 v[200:203], a[140:143], v[80:83], v[200:203]
s_waitcnt vmcnt(16) lgkmcnt(0)
s_barrier
ds_read_b128 a[64:67], v0 offset:32768
ds_read_b64_tr_b16 a[68:69], v4 offset:0
v_mfma_f32_16x16x32_bf16 v[208:211], a[148:151], v[80:83], v[208:211]
ds_read_b64_tr_b16 a[70:71], v4 offset:8192
v_add_f32 v41, v41, v51
v_mfma_f32_16x16x32_bf16 v[212:215], a[148:151], v[84:87], v[212:215]
ds_read_b128 a[72:75], v1 offset:32768
v_cvt_pk_bf16_f32 v77, v50, v51
v_mfma_f32_16x16x32_bf16 v[220:223], a[156:159], v[84:87], v[220:223]
buffer_load_dword v61, off, s[56:59], s79 sc1
v_mfma_f32_16x16x32_bf16 v[216:219], a[156:159], v[80:83], v[216:219]
v_exp_f32 v54, v110
v_mfma_f32_16x16x32_bf16 v[120:123], a[160:163], a[32:35], v[120:123]
ds_read_b64_tr_b16 a[76:77], v5 offset:0
v_add_f32 v41, v41, v52
v_mfma_f32_16x16x32_bf16 v[120:123], a[168:171], a[40:43], v[120:123]
ds_read_b64_tr_b16 a[78:79], v5 offset:8192
v_mfma_f32_16x16x32_bf16 v[120:123], a[176:179], a[48:51], v[120:123]
s_add_u32 m0, s28, 114688
s_add_u32 s76, s33, 229376
ds_read_b128 a[80:83], v2 offset:32768
ds_read_b64_tr_b16 a[84:85], v6 offset:0
v_mfma_f32_16x16x32_bf16 v[120:123], a[184:187], a[56:59], v[120:123]
buffer_load_dwordx4 v20, s[20:23], s76 offen lds
v_mfma_f32_16x16x32_bf16 v[124:127], a[184:187], a[60:63], v[124:127]
v_exp_f32 v55, v111
v_mfma_f32_16x16x32_bf16 v[124:127], a[176:179], a[52:55], v[124:127]
ds_read_b64_tr_b16 a[86:87], v6 offset:8192
v_add_f32 v41, v41, v53
v_mfma_f32_16x16x32_bf16 v[124:127], a[168:171], a[44:47], v[124:127]
ds_read_b128 a[88:91], v3 offset:32768
ds_read_b64_tr_b16 a[92:93], v7 offset:0
v_mfma_f32_16x16x32_bf16 v[124:127], a[160:163], a[36:39], v[124:127]
ds_read_b64_tr_b16 a[94:95], v7 offset:8192
v_cvt_pk_bf16_f32 v78, v52, v53
v_mfma_f32_16x16x32_bf16 v[224:227], a[164:167], v[80:83], v[224:227]
buffer_load_dwordx4 v21, s[20:23], s76 offen offset:1024 lds
v_mfma_f32_16x16x32_bf16 v[228:231], a[164:167], v[84:87], v[228:231]
ds_read_b128 a[96:99], v0 offset:33024
v_add_f32 v41, v41, v54
v_mfma_f32_16x16x32_bf16 v[236:239], a[172:175], v[84:87], v[236:239]
ds_read_b64_tr_b16 a[100:101], v8 offset:0
v_add_f32 v41, v41, v55
v_mfma_f32_16x16x32_bf16 v[232:235], a[172:175], v[80:83], v[232:235]
ds_read_b64_tr_b16 a[102:103], v8 offset:8192
v_cvt_pk_bf16_f32 v79, v54, v55
v_mfma_f32_16x16x32_bf16 v[240:243], a[180:183], v[80:83], v[240:243]
ds_read_b128 a[104:107], v1 offset:33024
v_max_f32 v45, v40, v41
v_mfma_f32_16x16x32_bf16 v[244:247], a[180:183], v[84:87], v[244:247]
buffer_load_dwordx4 v22, s[20:23], s76 offen offset:2048 lds
v_mfma_f32_16x16x32_bf16 v[252:255], a[188:191], v[84:87], v[252:255]
ds_read_b64_tr_b16 a[108:109], v9 offset:0
v_cmp_nge_f32 vcc, 0x46800000, v45
v_mfma_f32_16x16x32_bf16 v[248:251], a[188:191], v[80:83], v[248:251]
s_waitcnt lgkmcnt(4)
ds_read_b64_tr_b16 a[110:111], v9 offset:8192
s_cbranch_vccnz L_t_a59
L_t_a59_back:
v_mfma_f32_16x16x32_bf16 v[96:99], a[64:67], a[0:3], v[88:91]
ds_read_b128 a[112:115], v2 offset:33024
v_add_f32 v38, v38, v40
v_mfma_f32_16x16x32_bf16 v[96:99], a[72:75], a[8:11], v[96:99]
ds_read_b64_tr_b16 a[116:117], v10 offset:0
v_add_f32 v39, v39, v41
v_mfma_f32_16x16x32_bf16 v[96:99], a[80:83], a[16:19], v[96:99]
buffer_load_dwordx4 v23, s[20:23], s76 offen offset:3072 lds
v_mfma_f32_16x16x32_bf16 v[96:99], a[88:91], a[24:27], v[96:99]
v_exp_f32 v48, v112
v_mfma_f32_16x16x32_bf16 v[100:103], a[88:91], a[28:31], v[92:95]
ds_read_b64_tr_b16 a[118:119], v10 offset:8192
ds_read_b128 a[120:123], v3 offset:33024
v_mfma_f32_16x16x32_bf16 v[100:103], a[80:83], a[20:23], v[100:103]
s_add_u32 m0, s28, 81920
s_add_u32 s30, s30, 16384
v_exp_f32 v49, v113
v_mfma_f32_16x16x32_bf16 v[100:103], a[72:75], a[12:15], v[100:103]
buffer_load_dwordx4 v16, s[16:19], s30 offen nt lds
v_mfma_f32_16x16x32_bf16 v[100:103], a[64:67], a[4:7], v[100:103]
ds_read_b64_tr_b16 a[124:125], v11 offset:0
ds_read_b64_tr_b16 a[126:127], v11 offset:8192
v_mfma_f32_16x16x32_bf16 v[128:131], a[68:71], v[72:75], v[128:131]
ds_read_b128 a[128:131], v0 offset:40960
ds_read_b64_tr_b16 a[132:133], v4 offset:256
v_mfma_f32_16x16x32_bf16 v[132:135], a[68:71], v[76:79], v[132:135]
v_exp_f32 v50, v114
v_mfma_f32_16x16x32_bf16 v[140:143], a[76:79], v[76:79], v[140:143]
ds_read_b64_tr_b16 a[134:135], v4 offset:8448
v_add_f32 v40, v48, v49
v_mfma_f32_16x16x32_bf16 v[136:139], a[76:79], v[72:75], v[136:139]
buffer_load_dwordx4 v17, s[16:19], s30 offen offset:1024 nt lds
v_mfma_f32_16x16x32_bf16 v[144:147], a[84:87], v[72:75], v[144:147]
ds_read_b128 a[136:139], v1 offset:40960
ds_read_b64_tr_b16 a[140:141], v5 offset:256
v_mfma_f32_16x16x32_bf16 v[148:151], a[84:87], v[76:79], v[148:151]
v_exp_f32 v51, v115
v_mfma_f32_16x16x32_bf16 v[156:159], a[92:95], v[76:79], v[156:159]
ds_read_b64_tr_b16 a[142:143], v5 offset:8448
v_cvt_pk_bf16_f32 v80, v48, v49
v_mfma_f32_16x16x32_bf16 v[152:155], a[92:95], v[72:75], v[152:155]
ds_read_b128 a[144:147], v2 offset:40960
ds_read_b64_tr_b16 a[148:149], v6 offset:256
v_mfma_f32_16x16x32_bf16 v[96:99], a[96:99], a[32:35], v[96:99]
s_waitcnt lgkmcnt(5)
buffer_load_dwordx4 v18, s[16:19], s30 offen offset:2048 nt lds
v_mfma_f32_16x16x32_bf16 v[96:99], a[104:107], a[40:43], v[96:99]
v_exp_f32 v52, v120
v_mfma_f32_16x16x32_bf16 v[96:99], a[112:115], a[48:51], v[96:99]
ds_read_b64_tr_b16 a[150:151], v6 offset:8448
v_add_f32 v40, v40, v50
v_mfma_f32_16x16x32_bf16 v[96:99], a[120:123], a[56:59], v[96:99]
ds_read_b128 a[152:155], v3 offset:40960
ds_read_b64_tr_b16 a[156:157], v7 offset:256
v_mfma_f32_16x16x32_bf16 v[100:103], a[120:123], a[60:63], v[100:103]
buffer_load_dwordx4 v19, s[16:19], s30 offen offset:3072 nt lds
v_mfma_f32_16x16x32_bf16 v[100:103], a[112:115], a[52:55], v[100:103]
v_exp_f32 v53, v121
v_mfma_f32_16x16x32_bf16 v[100:103], a[104:107], a[44:47], v[100:103]
ds_read_b64_tr_b16 a[158:159], v7 offset:8448
v_add_f32 v40, v40, v51
v_mfma_f32_16x16x32_bf16 v[100:103], a[96:99], a[36:39], v[100:103]
ds_read_b128 a[160:163], v0 offset:41216
ds_read_b64_tr_b16 a[164:165], v8 offset:256
v_mfma_f32_16x16x32_bf16 v[160:163], a[100:103], v[72:75], v[160:163]
ds_read_b64_tr_b16 a[166:167], v8 offset:8448
v_cvt_pk_bf16_f32 v81, v50, v51
v_mfma_f32_16x16x32_bf16 v[164:167], a[100:103], v[76:79], v[164:167]
ds_read_b128 a[168:171], v1 offset:41216
ds_read_b64_tr_b16 a[172:173], v9 offset:256
v_mfma_f32_16x16x32_bf16 v[172:175], a[108:111], v[76:79], v[172:175]
v_exp_f32 v54, v122
v_mfma_f32_16x16x32_bf16 v[168:171], a[108:111], v[72:75], v[168:171]
ds_read_b64_tr_b16 a[174:175], v9 offset:8448
v_add_f32 v40, v40, v52
v_mfma_f32_16x16x32_bf16 v[176:179], a[116:119], v[72:75], v[176:179]
ds_read_b128 a[176:179], v2 offset:41216
ds_read_b64_tr_b16 a[180:181], v10 offset:256
v_mfma_f32_16x16x32_bf16 v[180:183], a[116:119], v[76:79], v[180:183]
v_exp_f32 v55, v123
v_mfma_f32_16x16x32_bf16 v[188:191], a[124:127], v[76:79], v[188:191]
ds_read_b64_tr_b16 a[182:183], v10 offset:8448
v_add_f32 v40, v40, v53
v_mfma_f32_16x16x32_bf16 v[184:187], a[124:127], v[72:75], v[184:187]
ds_read_b128 a[184:187], v3 offset:41216
v_cvt_pk_bf16_f32 v82, v52, v53
v_mfma_f32_16x16x32_bf16 v[104:107], a[128:131], a[0:3], v[88:91]
s_waitcnt lgkmcnt(5)
v_exp_f32 v48, v116
v_mfma_f32_16x16x32_bf16 v[104:107], a[136:139], a[8:11], v[104:107]
ds_read_b64_tr_b16 a[188:189], v11 offset:256
v_add_f32 v40, v40, v54
v_mfma_f32_16x16x32_bf16 v[104:107], a[144:147], a[16:19], v[104:107]
v_exp_f32 v49, v117
v_mfma_f32_16x16x32_bf16 v[104:107], a[152:155], a[24:27], v[104:107]
ds_read_b64_tr_b16 a[190:191], v11 offset:8448
v_add_f32 v40, v40, v55
v_mfma_f32_16x16x32_bf16 v[108:111], a[152:155], a[28:31], v[92:95]
v_cvt_pk_bf16_f32 v83, v54, v55
v_mfma_f32_16x16x32_bf16 v[108:111], a[144:147], a[20:23], v[108:111]
v_exp_f32 v50, v118
v_mfma_f32_16x16x32_bf16 v[108:111], a[136:139], a[12:15], v[108:111]
v_add_f32 v41, v48, v49
v_mfma_f32_16x16x32_bf16 v[108:111], a[128:131], a[4:7], v[108:111]
v_exp_f32 v51, v119
v_mfma_f32_16x16x32_bf16 v[192:195], a[132:135], v[72:75], v[192:195]
v_cvt_pk_bf16_f32 v84, v48, v49
v_mfma_f32_16x16x32_bf16 v[196:199], a[132:135], v[76:79], v[196:199]
v_exp_f32 v52, v124
v_mfma_f32_16x16x32_bf16 v[204:207], a[140:143], v[76:79], v[204:207]
v_add_f32 v41, v41, v50
v_mfma_f32_16x16x32_bf16 v[200:203], a[140:143], v[72:75], v[200:203]
s_waitcnt vmcnt(16) lgkmcnt(0)
s_barrier
ds_read_b128 a[64:67], v0 offset:49152
ds_read_b64_tr_b16 a[68:69], v4 offset:16384
v_mfma_f32_16x16x32_bf16 v[208:211], a[148:151], v[72:75], v[208:211]
v_exp_f32 v53, v125
v_mfma_f32_16x16x32_bf16 v[212:215], a[148:151], v[76:79], v[212:215]
ds_read_b64_tr_b16 a[70:71], v4 offset:24576
v_add_f32 v41, v41, v51
v_mfma_f32_16x16x32_bf16 v[220:223], a[156:159], v[76:79], v[220:223]
s_add_u32 m0, s28, 131072
s_add_u32 s76, s33, 128
ds_read_b128 a[72:75], v1 offset:49152
v_cvt_pk_bf16_f32 v85, v50, v51
v_mfma_f32_16x16x32_bf16 v[216:219], a[156:159], v[72:75], v[216:219]
buffer_load_dwordx4 v20, s[20:23], s76 offen lds
v_mfma_f32_16x16x32_bf16 v[104:107], a[160:163], a[32:35], v[104:107]
v_exp_f32 v54, v126
v_mfma_f32_16x16x32_bf16 v[104:107], a[168:171], a[40:43], v[104:107]
ds_read_b64_tr_b16 a[76:77], v5 offset:16384
v_add_f32 v41, v41, v52
v_mfma_f32_16x16x32_bf16 v[104:107], a[176:179], a[48:51], v[104:107]
ds_read_b64_tr_b16 a[78:79], v5 offset:24576
ds_read_b128 a[80:83], v2 offset:49152
v_mfma_f32_16x16x32_bf16 v[104:107], a[184:187], a[56:59], v[104:107]
v_exp_f32 v55, v127
v_mfma_f32_16x16x32_bf16 v[108:111], a[184:187], a[60:63], v[108:111]
buffer_load_dwordx4 v21, s[20:23], s76 offen offset:1024 lds
v_mfma_f32_16x16x32_bf16 v[108:111], a[176:179], a[52:55], v[108:111]
ds_read_b64_tr_b16 a[84:85], v6 offset:16384
v_add_f32 v41, v41, v53
v_mfma_f32_16x16x32_bf16 v[108:111], a[168:171], a[44:47], v[108:111]
ds_read_b64_tr_b16 a[86:87], v6 offset:24576
v_cvt_pk_bf16_f32 v86, v52, v53
v_mfma_f32_16x16x32_bf16 v[108:111], a[160:163], a[36:39], v[108:111]
ds_read_b128 a[88:91], v3 offset:49152
ds_read_b64_tr_b16 a[92:93], v7 offset:16384
v_mfma_f32_16x16x32_bf16 v[224:227], a[164:167], v[72:75], v[224:227]
ds_read_b64_tr_b16 a[94:95], v7 offset:24576
v_add_f32 v41, v41, v54
v_mfma_f32_16x16x32_bf16 v[228:231], a[164:167], v[76:79], v[228:231]
ds_read_b128 a[96:99], v0 offset:49408
v_add_f32 v41, v41, v55
v_mfma_f32_16x16x32_bf16 v[236:239], a[172:175], v[76:79], v[236:239]
buffer_load_dwordx4 v22, s[20:23], s76 offen offset:2048 lds
v_mfma_f32_16x16x32_bf16 v[232:235], a[172:175], v[72:75], v[232:235]
ds_read_b64_tr_b16 a[100:101], v8 offset:16384
v_cvt_pk_bf16_f32 v87, v54, v55
v_mfma_f32_16x16x32_bf16 v[240:243], a[180:183], v[72:75], v[240:243]
ds_read_b64_tr_b16 a[102:103], v8 offset:24576
v_max_f32 v45, v40, v41
v_mfma_f32_16x16x32_bf16 v[244:247], a[180:183], v[76:79], v[244:247]
ds_read_b128 a[104:107], v1 offset:49408
v_cmp_nge_f32 vcc, 0x46800000, v45
v_mfma_f32_16x16x32_bf16 v[252:255], a[188:191], v[76:79], v[252:255]
buffer_load_dwordx4 v23, s[20:23], s76 offen offset:3072 lds
v_mfma_f32_16x16x32_bf16 v[248:251], a[188:191], v[72:75], v[248:251]
s_waitcnt lgkmcnt(3)
ds_read_b64_tr_b16 a[108:109], v9 offset:16384
ds_read_b64_tr_b16 a[110:111], v9 offset:24576
s_cbranch_vccnz L_t_a60
L_t_a60_back:
v_mfma_f32_16x16x32_bf16 v[112:115], a[64:67], a[0:3], v[88:91]
ds_read_b128 a[112:115], v2 offset:49408
v_add_f32 v38, v38, v40
v_mfma_f32_16x16x32_bf16 v[112:115], a[72:75], a[8:11], v[112:115]
ds_read_b64_tr_b16 a[116:117], v10 offset:16384
v_add_f32 v39, v39, v41
v_mfma_f32_16x16x32_bf16 v[112:115], a[80:83], a[16:19], v[112:115]
s_add_u32 m0, s28, 32768
s_add_u32 s76, s33, 114688
v_exp_f32 v48, v96
v_mfma_f32_16x16x32_bf16 v[112:115], a[88:91], a[24:27], v[112:115]
buffer_load_dwordx4 v20, s[20:23], s76 offen lds
v_mfma_f32_16x16x32_bf16 v[116:119], a[88:91], a[28:31], v[92:95]
ds_read_b64_tr_b16 a[118:119], v10 offset:24576
ds_read_b128 a[120:123], v3 offset:49408
v_mfma_f32_16x16x32_bf16 v[116:119], a[80:83], a[20:23], v[116:119]
v_exp_f32 v49, v97
v_mfma_f32_16x16x32_bf16 v[116:119], a[72:75], a[12:15], v[116:119]
ds_read_b64_tr_b16 a[124:125], v11 offset:16384
ds_read_b64_tr_b16 a[126:127], v11 offset:24576
v_mfma_f32_16x16x32_bf16 v[116:119], a[64:67], a[4:7], v[116:119]
v_exp_f32 v50, v98
v_mfma_f32_16x16x32_bf16 v[128:131], a[68:71], v[80:83], v[128:131]
ds_read_b128 a[128:131], v0 offset:57344
ds_read_b64_tr_b16 a[132:133], v4 offset:16640
v_mfma_f32_16x16x32_bf16 v[132:135], a[68:71], v[84:87], v[132:135]
buffer_load_dwordx4 v21, s[20:23], s76 offen offset:1024 lds
v_mfma_f32_16x16x32_bf16 v[140:143], a[76:79], v[84:87], v[140:143]
ds_read_b64_tr_b16 a[134:135], v4 offset:24832
v_add_f32 v40, v48, v49
v_mfma_f32_16x16x32_bf16 v[136:139], a[76:79], v[80:83], v[136:139]
ds_read_b128 a[136:139], v1 offset:57344
ds_read_b64_tr_b16 a[140:141], v5 offset:16640
v_mfma_f32_16x16x32_bf16 v[144:147], a[84:87], v[80:83], v[144:147]
v_exp_f32 v51, v99
v_mfma_f32_16x16x32_bf16 v[148:151], a[84:87], v[84:87], v[148:151]
ds_read_b64_tr_b16 a[142:143], v5 offset:24832
v_cvt_pk_bf16_f32 v72, v48, v49
v_mfma_f32_16x16x32_bf16 v[156:159], a[92:95], v[84:87], v[156:159]
buffer_load_dwordx4 v22, s[20:23], s76 offen offset:2048 lds
v_mfma_f32_16x16x32_bf16 v[152:155], a[92:95], v[80:83], v[152:155]
ds_read_b128 a[144:147], v2 offset:57344
ds_read_b64_tr_b16 a[148:149], v6 offset:16640
v_mfma_f32_16x16x32_bf16 v[112:115], a[96:99], a[32:35], v[112:115]
s_waitcnt lgkmcnt(5)
v_exp_f32 v52, v104
v_mfma_f32_16x16x32_bf16 v[112:115], a[104:107], a[40:43], v[112:115]
ds_read_b64_tr_b16 a[150:151], v6 offset:24832
v_add_f32 v40, v40, v50
v_mfma_f32_16x16x32_bf16 v[112:115], a[112:115], a[48:51], v[112:115]
ds_read_b128 a[152:155], v3 offset:57344
ds_read_b64_tr_b16 a[156:157], v7 offset:16640
v_mfma_f32_16x16x32_bf16 v[112:115], a[120:123], a[56:59], v[112:115]
buffer_load_dwordx4 v23, s[20:23], s76 offen offset:3072 lds
v_mfma_f32_16x16x32_bf16 v[116:119], a[120:123], a[60:63], v[116:119]
v_exp_f32 v53, v105
v_mfma_f32_16x16x32_bf16 v[116:119], a[112:115], a[52:55], v[116:119]
ds_read_b64_tr_b16 a[158:159], v7 offset:24832
v_add_f32 v40, v40, v51
v_mfma_f32_16x16x32_bf16 v[116:119], a[104:107], a[44:47], v[116:119]
ds_read_b128 a[160:163], v0 offset:57600
ds_read_b64_tr_b16 a[164:165], v8 offset:16640
v_mfma_f32_16x16x32_bf16 v[116:119], a[96:99], a[36:39], v[116:119]
ds_read_b64_tr_b16 a[166:167], v8 offset:24832
v_cvt_pk_bf16_f32 v73, v50, v51
v_mfma_f32_16x16x32_bf16 v[160:163], a[100:103], v[80:83], v[160:163]
v_exp_f32 v54, v106
v_mfma_f32_16x16x32_bf16 v[164:167], a[100:103], v[84:87], v[164:167]
ds_read_b128 a[168:171], v1 offset:57600
v_add_f32 v40, v40, v52
v_mfma_f32_16x16x32_bf16 v[172:175], a[108:111], v[84:87], v[172:175]
v_exp_f32 v55, v107
v_mfma_f32_16x16x32_bf16 v[168:171], a[108:111], v[80:83], v[168:171]
ds_read_b64_tr_b16 a[172:173], v9 offset:16640
v_add_f32 v40, v40, v53
v_mfma_f32_16x16x32_bf16 v[176:179], a[116:119], v[80:83], v[176:179]
ds_read_b64_tr_b16 a[174:175], v9 offset:24832
v_cvt_pk_bf16_f32 v74, v52, v53
v_mfma_f32_16x16x32_bf16 v[180:183], a[116:119], v[84:87], v[180:183]
ds_read_b128 a[176:179], v2 offset:57600
ds_read_b64_tr_b16 a[180:181], v10 offset:16640
v_mfma_f32_16x16x32_bf16 v[188:191], a[124:127], v[84:87], v[188:191]
v_exp_f32 v48, v100
v_mfma_f32_16x16x32_bf16 v[184:187], a[124:127], v[80:83], v[184:187]
ds_read_b64_tr_b16 a[182:183], v10 offset:24832
v_add_f32 v40, v40, v54
v_mfma_f32_16x16x32_bf16 v[120:123], a[128:131], a[0:3], v[88:91]
s_waitcnt lgkmcnt(5)
ds_read_b128 a[184:187], v3 offset:57600
ds_read_b64_tr_b16 a[188:189], v11 offset:16640
v_mfma_f32_16x16x32_bf16 v[120:123], a[136:139], a[8:11], v[120:123]
v_exp_f32 v49, v101
v_mfma_f32_16x16x32_bf16 v[120:123], a[144:147], a[16:19], v[120:123]
ds_read_b64_tr_b16 a[190:191], v11 offset:24832
v_add_f32 v40, v40, v55
v_mfma_f32_16x16x32_bf16 v[120:123], a[152:155], a[24:27], v[120:123]
v_cvt_pk_bf16_f32 v75, v54, v55
v_mfma_f32_16x16x32_bf16 v[124:127], a[152:155], a[28:31], v[92:95]
v_exp_f32 v50, v102
v_mfma_f32_16x16x32_bf16 v[124:127], a[144:147], a[20:23], v[124:127]
v_add_f32 v41, v48, v49
v_mfma_f32_16x16x32_bf16 v[124:127], a[136:139], a[12:15], v[124:127]
v_exp_f32 v51, v103
v_mfma_f32_16x16x32_bf16 v[124:127], a[128:131], a[4:7], v[124:127]
v_cvt_pk_bf16_f32 v76, v48, v49
v_mfma_f32_16x16x32_bf16 v[192:195], a[132:135], v[80:83], v[192:195]
v_exp_f32 v52, v108
v_mfma_f32_16x16x32_bf16 v[196:199], a[132:135], v[84:87], v[196:199]
v_add_f32 v41, v41, v50
v_mfma_f32_16x16x32_bf16 v[204:207], a[140:143], v[84:87], v[204:207]
v_exp_f32 v53, v109
v_mfma_f32_16x16x32_bf16 v[200:203], a[140:143], v[80:83], v[200:203]
s_waitcnt vmcnt(16) lgkmcnt(0)
s_barrier
ds_read_b64_tr_b16 a[64:65], v4 offset:32768
v_mfma_f32_16x16x32_bf16 v[208:211], a[148:151], v[80:83], v[208:211]
ds_read_b64_tr_b16 a[66:67], v4 offset:40960
v_add_f32 v41, v41, v51
v_mfma_f32_16x16x32_bf16 v[212:215], a[148:151], v[84:87], v[212:215]
s_add_u32 m0, s28, 49152
s_add_u32 s76, s33, 344064
ds_read_b64_tr_b16 a[68:69], v5 offset:32768
v_cvt_pk_bf16_f32 v77, v50, v51
v_mfma_f32_16x16x32_bf16 v[220:223], a[156:159], v[84:87], v[220:223]
buffer_load_dwordx4 v20, s[20:23], s76 offen lds
v_mfma_f32_16x16x32_bf16 v[216:219], a[156:159], v[80:83], v[216:219]
ds_read_b64_tr_b16 a[70:71], v5 offset:40960
ds_read_b64_tr_b16 a[72:73], v6 offset:32768
v_mfma_f32_16x16x32_bf16 v[120:123], a[160:163], a[32:35], v[120:123]
v_exp_f32 v54, v110
v_mfma_f32_16x16x32_bf16 v[120:123], a[168:171], a[40:43], v[120:123]
ds_read_b64_tr_b16 a[74:75], v6 offset:40960
v_add_f32 v41, v41, v52
v_mfma_f32_16x16x32_bf16 v[120:123], a[176:179], a[48:51], v[120:123]
ds_read_b64_tr_b16 a[76:77], v7 offset:32768
ds_read_b64_tr_b16 a[78:79], v7 offset:40960
v_mfma_f32_16x16x32_bf16 v[120:123], a[184:187], a[56:59], v[120:123]
v_exp_f32 v55, v111
v_mfma_f32_16x16x32_bf16 v[124:127], a[184:187], a[60:63], v[124:127]
ds_read_b64_tr_b16 a[80:81], v8 offset:32768
v_add_f32 v41, v41, v53
v_mfma_f32_16x16x32_bf16 v[124:127], a[176:179], a[52:55], v[124:127]
ds_read_b64_tr_b16 a[82:83], v8 offset:40960
v_cvt_pk_bf16_f32 v78, v52, v53
v_mfma_f32_16x16x32_bf16 v[124:127], a[168:171], a[44:47], v[124:127]
ds_read_b64_tr_b16 a[84:85], v9 offset:32768
ds_read_b64_tr_b16 a[86:87], v9 offset:40960
v_mfma_f32_16x16x32_bf16 v[124:127], a[160:163], a[36:39], v[124:127]
ds_read_b64_tr_b16 a[88:89], v10 offset:32768
v_add_f32 v41, v41, v54
v_mfma_f32_16x16x32_bf16 v[224:227], a[164:167], v[80:83], v[224:227]
buffer_load_dwordx4 v21, s[20:23], s76 offen offset:1024 lds
v_mfma_f32_16x16x32_bf16 v[228:231], a[164:167], v[84:87], v[228:231]
ds_read_b64_tr_b16 a[90:91], v10 offset:40960
v_add_f32 v41, v41, v55
v_mfma_f32_16x16x32_bf16 v[236:239], a[172:175], v[84:87], v[236:239]
ds_read_b64_tr_b16 a[92:93], v11 offset:32768
v_cvt_pk_bf16_f32 v79, v54, v55
v_mfma_f32_16x16x32_bf16 v[232:235], a[172:175], v[80:83], v[232:235]
ds_read_b64_tr_b16 a[94:95], v11 offset:40960
v_max_f32 v45, v40, v41
v_mfma_f32_16x16x32_bf16 v[240:243], a[180:183], v[80:83], v[240:243]
ds_read_b64_tr_b16 a[96:97], v4 offset:33024
v_cmp_nge_f32 vcc, 0x46800000, v45
v_mfma_f32_16x16x32_bf16 v[244:247], a[180:183], v[84:87], v[244:247]
ds_read_b64_tr_b16 a[98:99], v4 offset:41216
ds_read_b64_tr_b16 a[100:101], v5 offset:33024
v_mfma_f32_16x16x32_bf16 v[252:255], a[188:191], v[84:87], v[252:255]
ds_read_b64_tr_b16 a[102:103], v5 offset:41216
ds_read_b64_tr_b16 a[104:105], v6 offset:33024
v_mfma_f32_16x16x32_bf16 v[248:251], a[188:191], v[80:83], v[248:251]
s_waitcnt lgkmcnt(7)
buffer_load_dwordx4 v22, s[20:23], s76 offen offset:2048 lds
s_cbranch_vccnz L_t_a61
L_t_a61_back:
v_mfma_f32_16x16x32_bf16 v[128:131], a[64:67], v[72:75], v[128:131]
ds_read_b64_tr_b16 a[106:107], v6 offset:41216
v_add_f32 v38, v38, v40
v_mfma_f32_16x16x32_bf16 v[132:135], a[64:67], v[76:79], v[132:135]
ds_read_b64_tr_b16 a[108:109], v7 offset:33024
v_add_f32 v39, v39, v41
v_mfma_f32_16x16x32_bf16 v[140:143], a[68:71], v[76:79], v[140:143]
v_exp_f32 v48, v112
v_mfma_f32_16x16x32_bf16 v[136:139], a[68:71], v[72:75], v[136:139]
ds_read_b64_tr_b16 a[110:111], v7 offset:41216
ds_read_b64_tr_b16 a[112:113], v8 offset:33024
v_mfma_f32_16x16x32_bf16 v[144:147], a[72:75], v[72:75], v[144:147]
ds_read_b64_tr_b16 a[114:115], v8 offset:41216
ds_read_b64_tr_b16 a[116:117], v9 offset:33024
v_mfma_f32_16x16x32_bf16 v[148:151], a[72:75], v[76:79], v[148:151]
v_exp_f32 v49, v113
v_mfma_f32_16x16x32_bf16 v[156:159], a[76:79], v[76:79], v[156:159]
ds_read_b64_tr_b16 a[118:119], v9 offset:41216
ds_read_b64_tr_b16 a[120:121], v10 offset:33024
v_mfma_f32_16x16x32_bf16 v[152:155], a[76:79], v[72:75], v[152:155]
v_exp_f32 v50, v114
v_mfma_f32_16x16x32_bf16 v[160:163], a[80:83], v[72:75], v[160:163]
ds_read_b64_tr_b16 a[122:123], v10 offset:41216
v_add_f32 v40, v48, v49
v_mfma_f32_16x16x32_bf16 v[164:167], a[80:83], v[76:79], v[164:167]
buffer_load_dwordx4 v23, s[20:23], s76 offen offset:3072 lds
ds_read_b64_tr_b16 a[124:125], v11 offset:33024
ds_read_b64_tr_b16 a[126:127], v11 offset:41216
v_mfma_f32_16x16x32_bf16 v[172:175], a[84:87], v[76:79], v[172:175]
v_exp_f32 v51, v115
v_mfma_f32_16x16x32_bf16 v[168:171], a[84:87], v[72:75], v[168:171]
v_cvt_pk_bf16_f32 v80, v48, v49
v_mfma_f32_16x16x32_bf16 v[176:179], a[88:91], v[72:75], v[176:179]
v_exp_f32 v52, v120
v_mfma_f32_16x16x32_bf16 v[180:183], a[88:91], v[76:79], v[180:183]
s_waitcnt lgkmcnt(3)
v_add_f32 v40, v40, v50
v_mfma_f32_16x16x32_bf16 v[188:191], a[92:95], v[76:79], v[188:191]
v_exp_f32 v53, v121
v_mfma_f32_16x16x32_bf16 v[184:187], a[92:95], v[72:75], v[184:187]
s_waitcnt vmcnt(4) lgkmcnt(0)
s_barrier
v_add_f32 v40, v40, v51
v_cvt_pk_bf16_f32 v81, v50, v51
v_mfma_f32_16x16x32_bf16 v[192:195], a[96:99], v[72:75], v[192:195]
v_exp_f32 v54, v122
v_mfma_f32_16x16x32_bf16 v[196:199], a[96:99], v[76:79], v[196:199]
ds_read_b64_tr_b16 a[128:129], v4 offset:49152
v_add_f32 v40, v40, v52
v_mfma_f32_16x16x32_bf16 v[204:207], a[100:103], v[76:79], v[204:207]
v_exp_f32 v55, v123
v_mfma_f32_16x16x32_bf16 v[200:203], a[100:103], v[72:75], v[200:203]
ds_read_b64_tr_b16 a[130:131], v4 offset:57344
v_add_f32 v40, v40, v53
v_mfma_f32_16x16x32_bf16 v[208:211], a[104:107], v[72:75], v[208:211]
ds_read_b64_tr_b16 a[132:133], v5 offset:49152
v_cvt_pk_bf16_f32 v82, v52, v53
v_mfma_f32_16x16x32_bf16 v[212:215], a[104:107], v[76:79], v[212:215]
ds_read_b64_tr_b16 a[134:135], v5 offset:57344
ds_read_b64_tr_b16 a[136:137], v6 offset:49152
v_mfma_f32_16x16x32_bf16 v[220:223], a[108:111], v[76:79], v[220:223]
buffer_load_dword v62, v47, s[20:23], s77 offen
v_mfma_f32_16x16x32_bf16 v[216:219], a[108:111], v[72:75], v[216:219]
ds_read_b64_tr_b16 a[138:139], v6 offset:57344
ds_read_b64_tr_b16 a[140:141], v7 offset:49152
v_mfma_f32_16x16x32_bf16 v[224:227], a[112:115], v[72:75], v[224:227]
ds_read_b64_tr_b16 a[142:143], v7 offset:57344
ds_read_b64_tr_b16 a[144:145], v8 offset:49152
v_mfma_f32_16x16x32_bf16 v[228:231], a[112:115], v[76:79], v[228:231]
ds_read_b64_tr_b16 a[146:147], v8 offset:57344
ds_read_b64_tr_b16 a[148:149], v9 offset:49152
v_mfma_f32_16x16x32_bf16 v[236:239], a[116:119], v[76:79], v[236:239]
ds_read_b64_tr_b16 a[150:151], v9 offset:57344
ds_read_b64_tr_b16 a[152:153], v10 offset:49152
v_mfma_f32_16x16x32_bf16 v[232:235], a[116:119], v[72:75], v[232:235]
ds_read_b64_tr_b16 a[154:155], v10 offset:57344
ds_read_b64_tr_b16 a[156:157], v11 offset:49152
v_mfma_f32_16x16x32_bf16 v[240:243], a[120:123], v[72:75], v[240:243]
ds_read_b64_tr_b16 a[158:159], v11 offset:57344
ds_read_b64_tr_b16 a[160:161], v4 offset:49408
v_mfma_f32_16x16x32_bf16 v[244:247], a[120:123], v[76:79], v[244:247]
ds_read_b64_tr_b16 a[162:163], v4 offset:57600
ds_read_b64_tr_b16 a[164:165], v5 offset:49408
v_mfma_f32_16x16x32_bf16 v[252:255], a[124:127], v[76:79], v[252:255]
ds_read_b64_tr_b16 a[166:167], v5 offset:57600
ds_read_b64_tr_b16 a[168:169], v6 offset:49408
v_exp_f32 v48, v116
v_add_f32 v40, v40, v54
v_exp_f32 v49, v117
v_add_f32 v40, v40, v55
v_cvt_pk_bf16_f32 v83, v54, v55
v_exp_f32 v50, v118
v_add_f32 v41, v48, v49
v_exp_f32 v51, v119
v_cvt_pk_bf16_f32 v84, v48, v49
v_exp_f32 v52, v124
v_add_f32 v41, v41, v50
v_exp_f32 v53, v125
v_add_f32 v41, v41, v51
v_cvt_pk_bf16_f32 v85, v50, v51
v_exp_f32 v54, v126
v_add_f32 v41, v41, v52
v_exp_f32 v55, v127
v_add_f32 v41, v41, v53
v_cvt_pk_bf16_f32 v86, v52, v53
v_add_f32 v41, v41, v54
v_add_f32 v41, v41, v55
v_cvt_pk_bf16_f32 v87, v54, v55
v_max_f32 v45, v40, v41
v_cmp_nge_f32 vcc, 0x46800000, v45
v_mfma_f32_16x16x32_bf16 v[248:251], a[124:127], v[72:75], v[248:251]
s_waitcnt lgkmcnt(10)
ds_read_b64_tr_b16 a[170:171], v6 offset:57600
ds_read_b64_tr_b16 a[172:173], v7 offset:49408
s_cbranch_vccnz L_t_a62
L_t_a62_back:
v_mfma_f32_16x16x32_bf16 v[128:131], a[128:131], v[80:83], v[128:131]
ds_read_b64_tr_b16 a[174:175], v7 offset:57600
ds_read_b64_tr_b16 a[176:177], v8 offset:49408
v_mfma_f32_16x16x32_bf16 v[132:135], a[128:131], v[84:87], v[132:135]
ds_read_b64_tr_b16 a[178:179], v8 offset:57600
ds_read_b64_tr_b16 a[180:181], v9 offset:49408
v_mfma_f32_16x16x32_bf16 v[140:143], a[132:135], v[84:87], v[140:143]
ds_read_b64_tr_b16 a[182:183], v9 offset:57600
ds_read_b64_tr_b16 a[184:185], v10 offset:49408
v_mfma_f32_16x16x32_bf16 v[136:139], a[132:135], v[80:83], v[136:139]
ds_read_b64_tr_b16 a[186:187], v10 offset:57600
ds_read_b64_tr_b16 a[188:189], v11 offset:49408
v_mfma_f32_16x16x32_bf16 v[144:147], a[136:139], v[80:83], v[144:147]
ds_read_b64_tr_b16 a[190:191], v11 offset:57600
ds_read_b64_tr_b16 a[64:65], v28 offset:0
v_mfma_f32_16x16x32_bf16 v[148:151], a[136:139], v[84:87], v[148:151]
ds_read_b64_tr_b16 a[66:67], v28 offset:2048
ds_read_b64_tr_b16 a[68:69], v28 offset:4096
v_mfma_f32_16x16x32_bf16 v[156:159], a[140:143], v[84:87], v[156:159]
ds_read_b64_tr_b16 a[70:71], v28 offset:6144
ds_read_b64_tr_b16 a[72:73], v28 offset:8192
v_mfma_f32_16x16x32_bf16 v[152:155], a[140:143], v[80:83], v[152:155]
ds_read_b64_tr_b16 a[74:75], v28 offset:10240
ds_read_b64_tr_b16 a[76:77], v28 offset:12288
v_mfma_f32_16x16x32_bf16 v[160:163], a[144:147], v[80:83], v[160:163]
ds_read_b64_tr_b16 a[78:79], v28 offset:14336
ds_read_b64_tr_b16 a[80:81], v29 offset:0
ds_read_b64_tr_b16 a[82:83], v29 offset:2048
ds_read_b64_tr_b16 a[84:85], v29 offset:4096
ds_read_b64_tr_b16 a[86:87], v29 offset:6144
ds_read_b64_tr_b16 a[88:89], v29 offset:8192
ds_read_b64_tr_b16 a[90:91], v29 offset:10240
ds_read_b64_tr_b16 a[92:93], v29 offset:12288
ds_read_b64_tr_b16 a[94:95], v29 offset:14336
v_add_f32 v38, v38, v40
v_add_f32 v39, v39, v41
v_mov_b32 v45, v38
v_mov_b32 v46, v39
s_nop 0
v_permlane32_swap_b32 v38, v45
v_permlane32_swap_b32 v39, v46
v_add_f32 v38, v38, v45
v_add_f32 v39, v39, v46
v_mov_b32 v45, v38
v_mov_b32 v46, v39
s_nop 0
v_permlane16_swap_b32 v38, v45
v_permlane16_swap_b32 v39, v46
v_add_f32 v38, v38, v45
v_add_f32 v39, v39, v46
v_rcp_f32 v42, v38
v_rcp_f32 v43, v39
v_mfma_f32_16x16x32_bf16 v[164:167], a[144:147], v[84:87], v[164:167]
s_waitcnt lgkmcnt(15)
v_mul_f32 v128, v42, v128
v_mul_f32 v129, v42, v129
v_mul_f32 v130, v42, v130
v_mul_f32 v131, v42, v131
v_cvt_pk_bf16_f32 v96, v128, v129
v_cvt_pk_bf16_f32 v97, v130, v131
v_mfma_f32_16x16x32_bf16 v[172:175], a[148:151], v[84:87], v[172:175]
v_mul_f32 v136, v42, v136
v_mul_f32 v137, v42, v137
v_mul_f32 v138, v42, v138
v_mul_f32 v139, v42, v139
v_cvt_pk_bf16_f32 v98, v136, v137
v_cvt_pk_bf16_f32 v99, v138, v139
v_mfma_f32_16x16x32_bf16 v[168:171], a[148:151], v[80:83], v[168:171]
ds_write_b128 v32, v[96:99] offset:0
v_mul_f32 v132, v43, v132
v_mul_f32 v133, v43, v133
v_mul_f32 v134, v43, v134
v_mul_f32 v135, v43, v135
v_cvt_pk_bf16_f32 v100, v132, v133
v_cvt_pk_bf16_f32 v101, v134, v135
v_mfma_f32_16x16x32_bf16 v[176:179], a[152:155], v[80:83], v[176:179]
v_mul_f32 v140, v43, v140
v_mul_f32 v141, v43, v141
v_mul_f32 v142, v43, v142
v_mul_f32 v143, v43, v143
v_cvt_pk_bf16_f32 v102, v140, v141
v_cvt_pk_bf16_f32 v103, v142, v143
v_mfma_f32_16x16x32_bf16 v[180:183], a[152:155], v[84:87], v[180:183]
ds_write_b128 v32, v[100:103] offset:1024
v_mul_f32 v144, v42, v144
v_mul_f32 v145, v42, v145
v_mul_f32 v146, v42, v146
v_mul_f32 v147, v42, v147
v_cvt_pk_bf16_f32 v104, v144, v145
v_cvt_pk_bf16_f32 v105, v146, v147
v_mfma_f32_16x16x32_bf16 v[188:191], a[156:159], v[84:87], v[188:191]
v_mul_f32 v152, v42, v152
v_mul_f32 v153, v42, v153
v_mul_f32 v154, v42, v154
v_mul_f32 v155, v42, v155
v_cvt_pk_bf16_f32 v106, v152, v153
v_cvt_pk_bf16_f32 v107, v154, v155
v_mfma_f32_16x16x32_bf16 v[184:187], a[156:159], v[80:83], v[184:187]
s_waitcnt vmcnt(4) lgkmcnt(0)
s_barrier
ds_write_b128 v32, v[104:107] offset:2048
v_mul_f32 v148, v43, v148
v_mul_f32 v149, v43, v149
v_mul_f32 v150, v43, v150
v_mul_f32 v151, v43, v151
v_cvt_pk_bf16_f32 v108, v148, v149
v_cvt_pk_bf16_f32 v109, v150, v151
v_mfma_f32_16x16x32_bf16 v[192:195], a[160:163], v[80:83], v[192:195]
v_mul_f32 v156, v43, v156
v_mul_f32 v157, v43, v157
v_mul_f32 v158, v43, v158
v_mul_f32 v159, v43, v159
v_cvt_pk_bf16_f32 v110, v156, v157
v_cvt_pk_bf16_f32 v111, v158, v159
v_mfma_f32_16x16x32_bf16 v[196:199], a[160:163], v[84:87], v[196:199]
ds_write_b128 v32, v[108:111] offset:3072
v_mul_f32 v160, v42, v160
v_mul_f32 v161, v42, v161
v_mul_f32 v162, v42, v162
v_mul_f32 v163, v42, v163
v_cvt_pk_bf16_f32 v112, v160, v161
v_cvt_pk_bf16_f32 v113, v162, v163
v_mfma_f32_16x16x32_bf16 v[204:207], a[164:167], v[84:87], v[204:207]
v_mul_f32 v168, v42, v168
v_mul_f32 v169, v42, v169
v_mul_f32 v170, v42, v170
v_mul_f32 v171, v42, v171
v_cvt_pk_bf16_f32 v114, v168, v169
v_cvt_pk_bf16_f32 v115, v170, v171
v_mfma_f32_16x16x32_bf16 v[200:203], a[164:167], v[80:83], v[200:203]
ds_write_b128 v32, v[112:115] offset:4096
v_mul_f32 v164, v43, v164
v_mul_f32 v165, v43, v165
v_mul_f32 v166, v43, v166
v_mul_f32 v167, v43, v167
v_cvt_pk_bf16_f32 v116, v164, v165
v_cvt_pk_bf16_f32 v117, v166, v167
v_mfma_f32_16x16x32_bf16 v[208:211], a[168:171], v[80:83], v[208:211]
v_mul_f32 v172, v43, v172
v_mul_f32 v173, v43, v173
v_mul_f32 v174, v43, v174
v_mul_f32 v175, v43, v175
v_cvt_pk_bf16_f32 v118, v172, v173
v_cvt_pk_bf16_f32 v119, v174, v175
v_mfma_f32_16x16x32_bf16 v[212:215], a[168:171], v[84:87], v[212:215]
ds_write_b128 v32, v[116:119] offset:5120
v_mul_f32 v176, v42, v176
v_mul_f32 v177, v42, v177
v_mul_f32 v178, v42, v178
v_mul_f32 v179, v42, v179
v_cvt_pk_bf16_f32 v120, v176, v177
v_cvt_pk_bf16_f32 v121, v178, v179
v_mfma_f32_16x16x32_bf16 v[220:223], a[172:175], v[84:87], v[220:223]
v_mul_f32 v184, v42, v184
v_mul_f32 v185, v42, v185
v_mul_f32 v186, v42, v186
v_mul_f32 v187, v42, v187
v_cvt_pk_bf16_f32 v122, v184, v185
v_cvt_pk_bf16_f32 v123, v186, v187
v_mfma_f32_16x16x32_bf16 v[216:219], a[172:175], v[80:83], v[216:219]
ds_write_b128 v32, v[120:123] offset:6144
v_mul_f32 v180, v43, v180
v_mul_f32 v181, v43, v181
v_mul_f32 v182, v43, v182
v_mul_f32 v183, v43, v183
v_cvt_pk_bf16_f32 v124, v180, v181
v_cvt_pk_bf16_f32 v125, v182, v183
v_mfma_f32_16x16x32_bf16 v[224:227], a[176:179], v[80:83], v[224:227]
v_mul_f32 v188, v43, v188
v_mul_f32 v189, v43, v189
v_mul_f32 v190, v43, v190
v_mul_f32 v191, v43, v191
v_cvt_pk_bf16_f32 v126, v188, v189
v_cvt_pk_bf16_f32 v127, v190, v191
v_mfma_f32_16x16x32_bf16 v[228:231], a[176:179], v[84:87], v[228:231]
ds_write_b128 v32, v[124:127] offset:7168
v_mul_f32 v192, v42, v192
v_mul_f32 v193, v42, v193
v_mul_f32 v194, v42, v194
v_mul_f32 v195, v42, v195
v_cvt_pk_bf16_f32 v88, v192, v193
v_cvt_pk_bf16_f32 v89, v194, v195
v_mfma_f32_16x16x32_bf16 v[236:239], a[180:183], v[84:87], v[236:239]
v_mul_f32 v200, v42, v200
v_mul_f32 v201, v42, v201
v_mul_f32 v202, v42, v202
v_mul_f32 v203, v42, v203
v_cvt_pk_bf16_f32 v90, v200, v201
v_cvt_pk_bf16_f32 v91, v202, v203
v_mfma_f32_16x16x32_bf16 v[232:235], a[180:183], v[80:83], v[232:235]
ds_write_b128 v32, v[88:91] offset:8192
v_mul_f32 v196, v43, v196
v_mul_f32 v197, v43, v197
v_mul_f32 v198, v43, v198
v_mul_f32 v199, v43, v199
v_cvt_pk_bf16_f32 v92, v196, v197
v_cvt_pk_bf16_f32 v93, v198, v199
v_mfma_f32_16x16x32_bf16 v[240:243], a[184:187], v[80:83], v[240:243]
v_mul_f32 v204, v43, v204
v_mul_f32 v205, v43, v205
v_mul_f32 v206, v43, v206
v_mul_f32 v207, v43, v207
v_cvt_pk_bf16_f32 v94, v204, v205
v_cvt_pk_bf16_f32 v95, v206, v207
v_mfma_f32_16x16x32_bf16 v[244:247], a[184:187], v[84:87], v[244:247]
ds_write_b128 v32, v[92:95] offset:9216
v_mul_f32 v208, v42, v208
v_mul_f32 v209, v42, v209
v_mul_f32 v210, v42, v210
v_mul_f32 v211, v42, v211
v_cvt_pk_bf16_f32 v64, v208, v209
v_cvt_pk_bf16_f32 v65, v210, v211
v_mfma_f32_16x16x32_bf16 v[252:255], a[188:191], v[84:87], v[252:255]
s_add_u32 m0, s28, 81920
s_add_u32 s76, s33, 114816
v_mul_f32 v216, v42, v216
v_mul_f32 v217, v42, v217
v_mul_f32 v218, v42, v218
v_mul_f32 v219, v42, v219
v_cvt_pk_bf16_f32 v66, v216, v217
v_cvt_pk_bf16_f32 v67, v218, v219
v_mfma_f32_16x16x32_bf16 v[248:251], a[188:191], v[80:83], v[248:251]
buffer_load_dwordx4 v20, s[20:23], s76 offen lds
ds_write_b128 v32, v[64:67] offset:10240
v_mul_f32 v212, v43, v212
v_mul_f32 v213, v43, v213
v_mul_f32 v214, v43, v214
v_mul_f32 v215, v43, v215
v_cvt_pk_bf16_f32 v68, v212, v213
v_cvt_pk_bf16_f32 v69, v214, v215
v_mul_f32 v220, v43, v220
v_mul_f32 v221, v43, v221
v_mul_f32 v222, v43, v222
v_mul_f32 v223, v43, v223
v_cvt_pk_bf16_f32 v70, v220, v221
v_cvt_pk_bf16_f32 v71, v222, v223
ds_write_b128 v32, v[68:71] offset:11264
v_mul_f32 v224, v42, v224
v_mul_f32 v225, v42, v225
v_mul_f32 v226, v42, v226
v_mul_f32 v227, v42, v227
v_cvt_pk_bf16_f32 v72, v224, v225
v_cvt_pk_bf16_f32 v73, v226, v227
v_mul_f32 v232, v42, v232
v_mul_f32 v233, v42, v233
v_mul_f32 v234, v42, v234
v_mul_f32 v235, v42, v235
v_cvt_pk_bf16_f32 v74, v232, v233
v_cvt_pk_bf16_f32 v75, v234, v235
ds_write_b128 v32, v[72:75] offset:12288
v_mul_f32 v228, v43, v228
v_mul_f32 v229, v43, v229
v_mul_f32 v230, v43, v230
v_mul_f32 v231, v43, v231
v_cvt_pk_bf16_f32 v76, v228, v229
v_cvt_pk_bf16_f32 v77, v230, v231
v_mul_f32 v236, v43, v236
v_mul_f32 v237, v43, v237
v_mul_f32 v238, v43, v238
v_mul_f32 v239, v43, v239
v_cvt_pk_bf16_f32 v78, v236, v237
v_cvt_pk_bf16_f32 v79, v238, v239
ds_write_b128 v32, v[76:79] offset:13312
v_mul_f32 v240, v42, v240
v_mul_f32 v241, v42, v241
v_mul_f32 v242, v42, v242
v_mul_f32 v243, v42, v243
v_cvt_pk_bf16_f32 v80, v240, v241
v_cvt_pk_bf16_f32 v81, v242, v243
v_mul_f32 v248, v42, v248
v_mul_f32 v249, v42, v249
v_mul_f32 v250, v42, v250
v_mul_f32 v251, v42, v251
v_cvt_pk_bf16_f32 v82, v248, v249
v_cvt_pk_bf16_f32 v83, v250, v251
ds_write_b128 v32, v[80:83] offset:14336
v_mul_f32 v244, v43, v244
v_mul_f32 v245, v43, v245
v_mul_f32 v246, v43, v246
v_mul_f32 v247, v43, v247
v_cvt_pk_bf16_f32 v84, v244, v245
v_cvt_pk_bf16_f32 v85, v246, v247
v_mul_f32 v252, v43, v252
v_mul_f32 v253, v43, v253
v_mul_f32 v254, v43, v254
v_mul_f32 v255, v43, v255
v_cvt_pk_bf16_f32 v86, v252, v253
v_cvt_pk_bf16_f32 v87, v254, v255
ds_write_b128 v32, v[84:87] offset:15360
s_waitcnt lgkmcnt(0)
s_barrier
ds_read_b128 a[0:3], v33 offset:0
ds_read_b128 a[8:11], v33 offset:2048
ds_read_b128 a[16:19], v33 offset:4096
ds_read_b128 a[24:27], v33 offset:6144
ds_read_b128 a[28:31], v33 offset:7168
ds_read_b128 a[20:23], v33 offset:5120
ds_read_b128 a[12:15], v33 offset:3072
ds_read_b128 a[4:7], v33 offset:1024
s_waitcnt lgkmcnt(7)
v_mfma_f32_16x16x32_bf16 v[128:131], a[64:67], a[0:3], 0
s_waitcnt lgkmcnt(6)
buffer_load_dwordx4 v21, s[20:23], s76 offen offset:1024 lds
v_mfma_f32_16x16x32_bf16 v[128:131], a[68:71], a[8:11], v[128:131]
s_waitcnt lgkmcnt(5)
buffer_load_dwordx4 v22, s[20:23], s76 offen offset:2048 lds
v_mfma_f32_16x16x32_bf16 v[128:131], a[72:75], a[16:19], v[128:131]
s_waitcnt lgkmcnt(4)
ds_read_b64_tr_b16 a[96:97], v30 offset:0
ds_read_b64_tr_b16 a[98:99], v30 offset:2048
v_mfma_f32_16x16x32_bf16 v[128:131], a[76:79], a[24:27], v[128:131]
s_waitcnt lgkmcnt(5)
ds_read_b64_tr_b16 a[100:101], v30 offset:4096
ds_read_b64_tr_b16 a[102:103], v30 offset:6144
v_mfma_f32_16x16x32_bf16 v[132:135], a[76:79], a[28:31], 0
s_waitcnt lgkmcnt(6)
ds_read_b64_tr_b16 a[104:105], v30 offset:8192
ds_read_b64_tr_b16 a[106:107], v30 offset:10240
v_mfma_f32_16x16x32_bf16 v[132:135], a[72:75], a[20:23], v[132:135]
s_waitcnt lgkmcnt(6)
ds_read_b64_tr_b16 a[108:109], v30 offset:12288
ds_read_b64_tr_b16 a[110:111], v30 offset:14336
v_mfma_f32_16x16x32_bf16 v[132:135], a[68:71], a[12:15], v[132:135]
ds_read_b64_tr_b16 a[112:113], v31 offset:0
ds_read_b64_tr_b16 a[114:115], v31 offset:2048
v_mfma_f32_16x16x32_bf16 v[132:135], a[64:67], a[4:7], v[132:135]
ds_read_b64_tr_b16 a[116:117], v31 offset:4096
ds_read_b64_tr_b16 a[118:119], v31 offset:6144
v_mfma_f32_16x16x32_bf16 v[140:143], a[80:83], a[4:7], 0
ds_read_b64_tr_b16 a[120:121], v31 offset:8192
ds_read_b64_tr_b16 a[122:123], v31 offset:10240
ds_read_b128 a[32:35], v33 offset:8192
ds_read_b128 a[40:43], v33 offset:10240
ds_read_b128 a[48:51], v33 offset:12288
ds_read_b128 a[56:59], v33 offset:14336
ds_read_b128 a[60:63], v33 offset:15360
ds_read_b128 a[52:55], v33 offset:13312
ds_read_b128 a[44:47], v33 offset:11264
ds_read_b128 a[36:39], v33 offset:9216
v_mfma_f32_16x16x32_bf16 v[140:143], a[84:87], a[12:15], v[140:143]
ds_read_b64_tr_b16 a[124:125], v31 offset:12288
ds_read_b64_tr_b16 a[126:127], v31 offset:14336
v_mfma_f32_16x16x32_bf16 v[140:143], a[88:91], a[20:23], v[140:143]
buffer_load_dwordx4 v23, s[20:23], s76 offen offset:3072 lds
v_mfma_f32_16x16x32_bf16 v[140:143], a[92:95], a[28:31], v[140:143]
ds_read_b128 a[192:195], v34 offset:0
v_mfma_f32_16x16x32_bf16 v[136:139], a[92:95], a[24:27], 0
ds_read_b128 a[196:199], v34 offset:1024
v_mfma_f32_16x16x32_bf16 v[136:139], a[88:91], a[16:19], v[136:139]
ds_read_b128 a[200:203], v34 offset:2048
v_mfma_f32_16x16x32_bf16 v[136:139], a[84:87], a[8:11], v[136:139]
ds_read_b128 a[204:207], v34 offset:3072
v_mfma_f32_16x16x32_bf16 v[136:139], a[80:83], a[0:3], v[136:139]
s_waitcnt vmcnt(4) lgkmcnt(0)
s_barrier
ds_read_b128 a[208:211], v34 offset:4096
v_mfma_f32_16x16x32_bf16 v[128:131], a[96:99], a[32:35], v[128:131]
ds_read_b64_tr_b16 a[128:129], v28 offset:16384
ds_read_b64_tr_b16 a[130:131], v28 offset:18432
v_mfma_f32_16x16x32_bf16 v[128:131], a[100:103], a[40:43], v[128:131]
ds_read_b128 a[212:215], v34 offset:5120
v_mfma_f32_16x16x32_bf16 v[128:131], a[104:107], a[48:51], v[128:131]
s_add_u32 m0, s28, 147456
s_add_u32 s76, s33, 229504
ds_read_b64_tr_b16 a[132:133], v28 offset:20480
ds_read_b64_tr_b16 a[134:135], v28 offset:22528
v_mfma_f32_16x16x32_bf16 v[128:131], a[108:111], a[56:59], v[128:131]
buffer_load_dwordx4 v20, s[20:23], s76 offen lds
v_mfma_f32_16x16x32_bf16 v[132:135], a[108:111], a[60:63], v[132:135]
ds_read_b64_tr_b16 a[136:137], v28 offset:24576
ds_read_b64_tr_b16 a[138:139], v28 offset:26624
v_mfma_f32_16x16x32_bf16 v[132:135], a[104:107], a[52:55], v[132:135]
buffer_load_dwordx4 v21, s[20:23], s76 offen offset:1024 lds
v_mfma_f32_16x16x32_bf16 v[132:135], a[100:103], a[44:47], v[132:135]
ds_read_b64_tr_b16 a[140:141], v28 offset:28672
ds_read_b64_tr_b16 a[142:143], v28 offset:30720
v_mfma_f32_16x16x32_bf16 v[132:135], a[96:99], a[36:39], v[132:135]
buffer_load_dwordx4 v22, s[20:23], s76 offen offset:2048 lds
v_mfma_f32_16x16x32_bf16 v[140:143], a[112:115], a[36:39], v[140:143]
ds_read_b64_tr_b16 a[144:145], v29 offset:16384
ds_read_b64_tr_b16 a[146:147], v29 offset:18432
v_mfma_f32_16x16x32_bf16 v[140:143], a[116:119], a[44:47], v[140:143]
buffer_load_dwordx4 v23, s[20:23], s76 offen offset:3072 lds
v_mfma_f32_16x16x32_bf16 v[140:143], a[120:123], a[52:55], v[140:143]
ds_read_b64_tr_b16 a[148:149], v29 offset:20480
ds_read_b64_tr_b16 a[150:151], v29 offset:22528
ds_read_b128 a[216:219], v34 offset:6144
ds_read_b128 a[220:223], v34 offset:7168
ds_read_b128 a[224:227], v34 offset:8192
ds_read_b128 a[228:231], v34 offset:9216
ds_read_b128 a[232:235], v34 offset:10240
ds_read_b128 a[236:239], v34 offset:11264
ds_read_b128 a[240:243], v34 offset:12288
ds_read_b128 a[244:247], v34 offset:13312
ds_read_b128 a[248:251], v34 offset:14336
ds_read_b128 a[252:255], v34 offset:15360
v_mfma_f32_16x16x32_bf16 v[140:143], a[124:127], a[60:63], v[140:143]
s_add_u32 m0, s28, 65536
s_add_u32 s76, s33, 344192
ds_read_b64_tr_b16 a[152:153], v29 offset:24576
ds_read_b64_tr_b16 a[154:155], v29 offset:26624
v_mfma_f32_16x16x32_bf16 v[136:139], a[124:127], a[56:59], v[136:139]
buffer_load_dwordx4 v20, s[20:23], s76 offen lds
v_mfma_f32_16x16x32_bf16 v[136:139], a[120:123], a[48:51], v[136:139]
ds_read_b64_tr_b16 a[156:157], v29 offset:28672
ds_read_b64_tr_b16 a[158:159], v29 offset:30720
v_mfma_f32_16x16x32_bf16 v[136:139], a[116:119], a[40:43], v[136:139]
buffer_load_dwordx4 v21, s[20:23], s76 offen offset:1024 lds
v_mfma_f32_16x16x32_bf16 v[136:139], a[112:115], a[32:35], v[136:139]
s_waitcnt lgkmcnt(15)
ds_read_b64_tr_b16 a[160:161], v30 offset:16384
ds_read_b64_tr_b16 a[162:163], v30 offset:18432
v_mfma_f32_16x16x32_bf16 v[128:131], a[128:131], a[192:195], v[128:131]
buffer_load_dwordx4 v22, s[20:23], s76 offen offset:2048 lds
v_mfma_f32_16x16x32_bf16 v[128:131], a[132:135], a[200:203], v[128:131]
ds_read_b64_tr_b16 a[164:165], v30 offset:20480
ds_read_b64_tr_b16 a[166:167], v30 offset:22528
v_mfma_f32_16x16x32_bf16 v[128:131], a[136:139], a[208:211], v[128:131]
s_mul_i32 s74, s70, 458752
s_add_u32 s4, s64, s74
s_addc_u32 s5, s65, 0
s_waitcnt lgkmcnt(6)
buffer_load_dwordx4 v23, s[20:23], s76 offen offset:3072 lds
v_mfma_f32_16x16x32_bf16 v[128:131], a[140:143], a[216:219], v[128:131]
s_and_b32 s5, s5, 0xffff
s_mov_b32 s6, 458752
s_add_u32 m0, s28, 98304
s_add_u32 s76, s33, 256
ds_read_b64_tr_b16 a[168:169], v30 offset:24576
ds_read_b64_tr_b16 a[170:171], v30 offset:26624
v_mfma_f32_16x16x32_bf16 v[132:135], a[140:143], a[220:223], v[132:135]
s_mov_b32 s7, 0x20000
s_mov_b32 s74, 0
buffer_load_dwordx4 v20, s[20:23], s76 offen lds
v_mfma_f32_16x16x32_bf16 v[132:135], a[136:139], a[212:215], v[132:135]
s_add_u32 s8, s54, s74
s_addc_u32 s9, s55, 0
ds_read_b64_tr_b16 a[172:173], v30 offset:28672
ds_read_b64_tr_b16 a[174:175], v30 offset:30720
v_mfma_f32_16x16x32_bf16 v[132:135], a[132:135], a[204:207], v[132:135]
s_and_b32 s9, s9, 0xffff
s_mov_b32 s10, 1835008
buffer_load_dwordx4 v21, s[20:23], s76 offen offset:1024 lds
v_mfma_f32_16x16x32_bf16 v[132:135], a[128:131], a[196:199], v[132:135]
s_mov_b32 s11, 0x20000
s_lshl_b32 s67, s70, 2
ds_read_b64_tr_b16 a[176:177], v31 offset:16384
ds_read_b64_tr_b16 a[178:179], v31 offset:18432
v_mfma_f32_16x16x32_bf16 v[140:143], a[144:147], a[196:199], v[140:143]
s_lshr_b32 s66, s35, 1
s_lshl_b32 s66, s66, 5
ds_read_b64_tr_b16 a[180:181], v31 offset:20480
ds_read_b64_tr_b16 a[182:183], v31 offset:22528
v_mfma_f32_16x16x32_bf16 v[140:143], a[148:151], a[204:207], v[140:143]
s_add_u32 s66, s66, s70
s_lshl_b32 s66, s66, 10
buffer_load_dwordx4 v22, s[20:23], s76 offen offset:2048 lds
ds_read_b64_tr_b16 a[184:185], v31 offset:24576
ds_read_b64_tr_b16 a[186:187], v31 offset:26624
ds_read_b64_tr_b16 a[188:189], v31 offset:28672
ds_read_b64_tr_b16 a[190:191], v31 offset:30720
v_mfma_f32_16x16x32_bf16 v[140:143], a[152:155], a[212:215], v[140:143]
s_mov_b32 s52, 0x3f80
s_mov_b32 s53, 0x3f800000
s_waitcnt lgkmcnt(10)
buffer_load_dwordx4 v23, s[20:23], s76 offen offset:3072 lds
v_mfma_f32_16x16x32_bf16 v[140:143], a[156:159], a[220:223], v[140:143]
s_mov_b32 s49, 32768
s_lshl_b32 s72, s70, 3
s_add_u32 m0, s28, 32768
s_add_u32 s76, s33, 114944
buffer_load_dwordx4 v20, s[20:23], s76 offen lds
v_mfma_f32_16x16x32_bf16 v[136:139], a[156:159], a[216:219], v[136:139]
s_add_u32 s72, s72, s73
s_lshl_b32 s72, s72, 7
buffer_load_dwordx4 v21, s[20:23], s76 offen offset:1024 lds
v_mfma_f32_16x16x32_bf16 v[136:139], a[152:155], a[208:211], v[136:139]
s_lshl_b32 s69, s35, 28
s_add_u32 s72, s72, s69
buffer_load_dwordx4 v22, s[20:23], s76 offen offset:2048 lds
v_mfma_f32_16x16x32_bf16 v[136:139], a[148:151], a[200:203], v[136:139]
buffer_load_dwordx4 v23, s[20:23], s76 offen offset:3072 lds
v_mfma_f32_16x16x32_bf16 v[136:139], a[144:147], a[192:195], v[136:139]
s_waitcnt vmcnt(16) lgkmcnt(0)
s_barrier
ds_read_b64_tr_b16 a[64:65], v28 offset:32768
v_mfma_f32_16x16x32_bf16 v[128:131], a[160:163], a[224:227], v[128:131]
ds_read_b64_tr_b16 a[66:67], v28 offset:34816
v_mfma_f32_16x16x32_bf16 v[128:131], a[164:167], a[232:235], v[128:131]
s_add_u32 m0, s28, 114688
s_add_u32 s76, s33, 229632
ds_read_b64_tr_b16 a[68:69], v28 offset:36864
v_mfma_f32_16x16x32_bf16 v[128:131], a[168:171], a[240:243], v[128:131]
buffer_load_dwordx4 v20, s[20:23], s76 offen lds
v_mfma_f32_16x16x32_bf16 v[128:131], a[172:175], a[248:251], v[128:131]
ds_read_b64_tr_b16 a[70:71], v28 offset:38912
ds_read_b64_tr_b16 a[72:73], v28 offset:40960
v_mfma_f32_16x16x32_bf16 v[132:135], a[172:175], a[252:255], v[132:135]
ds_read_b64_tr_b16 a[74:75], v28 offset:43008
ds_read_b64_tr_b16 a[76:77], v28 offset:45056
v_mfma_f32_16x16x32_bf16 v[132:135], a[168:171], a[244:247], v[132:135]
ds_read_b64_tr_b16 a[78:79], v28 offset:47104
v_mfma_f32_16x16x32_bf16 v[132:135], a[164:167], a[236:239], v[132:135]
buffer_load_dwordx4 v21, s[20:23], s76 offen offset:1024 lds
v_mfma_f32_16x16x32_bf16 v[132:135], a[160:163], a[228:231], v[132:135]
ds_read_b64_tr_b16 a[80:81], v29 offset:32768
ds_read_b64_tr_b16 a[82:83], v29 offset:34816
v_mfma_f32_16x16x32_bf16 v[140:143], a[176:179], a[228:231], v[140:143]
ds_read_b64_tr_b16 a[84:85], v29 offset:36864
ds_read_b64_tr_b16 a[86:87], v29 offset:38912
v_mfma_f32_16x16x32_bf16 v[140:143], a[180:183], a[236:239], v[140:143]
ds_read_b64_tr_b16 a[88:89], v29 offset:40960
ds_read_b64_tr_b16 a[90:91], v29 offset:43008
v_mfma_f32_16x16x32_bf16 v[140:143], a[184:187], a[244:247], v[140:143]
buffer_load_dwordx4 v22, s[20:23], s76 offen offset:2048 lds
v_mfma_f32_16x16x32_bf16 v[140:143], a[188:191], a[252:255], v[140:143]
ds_read_b64_tr_b16 a[92:93], v29 offset:45056
ds_read_b64_tr_b16 a[94:95], v29 offset:47104
v_mfma_f32_16x16x32_bf16 v[136:139], a[188:191], a[248:251], v[136:139]
ds_read_b64_tr_b16 a[96:97], v30 offset:49152
ds_read_b64_tr_b16 a[98:99], v30 offset:51200
v_mfma_f32_16x16x32_bf16 v[136:139], a[184:187], a[240:243], v[136:139]
buffer_load_dwordx4 v23, s[20:23], s76 offen offset:3072 lds
v_mfma_f32_16x16x32_bf16 v[136:139], a[180:183], a[232:235], v[136:139]
ds_read_b64_tr_b16 a[100:101], v30 offset:53248
ds_read_b64_tr_b16 a[102:103], v30 offset:55296
v_mfma_f32_16x16x32_bf16 v[136:139], a[176:179], a[224:227], v[136:139]
s_add_u32 m0, s28, 49152
s_add_u32 s76, s33, 344320
s_waitcnt lgkmcnt(6)
ds_read_b64_tr_b16 a[104:105], v30 offset:57344
ds_read_b64_tr_b16 a[106:107], v30 offset:59392
v_mfma_f32_16x16x32_bf16 v[144:147], a[64:67], a[0:3], 0
buffer_load_dwordx4 v20, s[20:23], s76 offen lds
v_mfma_f32_16x16x32_bf16 v[144:147], a[68:71], a[8:11], v[144:147]
ds_read_b64_tr_b16 a[108:109], v30 offset:61440
ds_read_b64_tr_b16 a[110:111], v30 offset:63488
v_mfma_f32_16x16x32_bf16 v[144:147], a[72:75], a[16:19], v[144:147]
ds_read_b64_tr_b16 a[112:113], v31 offset:49152
ds_read_b64_tr_b16 a[114:115], v31 offset:51200
v_mfma_f32_16x16x32_bf16 v[144:147], a[76:79], a[24:27], v[144:147]
ds_read_b64_tr_b16 a[116:117], v31 offset:53248
v_cvt_pk_bf16_f32 v192, v128, v129
v_mfma_f32_16x16x32_bf16 v[148:151], a[76:79], a[28:31], 0
ds_read_b64_tr_b16 a[118:119], v31 offset:55296
v_cvt_pk_bf16_f32 v193, v130, v131
v_mfma_f32_16x16x32_bf16 v[148:151], a[72:75], a[20:23], v[148:151]
buffer_load_dwordx4 v21, s[20:23], s76 offen offset:1024 lds
v_mfma_f32_16x16x32_bf16 v[148:151], a[68:71], a[12:15], v[148:151]
ds_read_b64_tr_b16 a[120:121], v31 offset:57344
v_cvt_pk_bf16_f32 v194, v136, v137
v_mfma_f32_16x16x32_bf16 v[148:151], a[64:67], a[4:7], v[148:151]
ds_read_b64_tr_b16 a[122:123], v31 offset:59392
v_cvt_pk_bf16_f32 v195, v138, v139
v_mfma_f32_16x16x32_bf16 v[156:159], a[80:83], a[4:7], 0
ds_read_b64_tr_b16 a[124:125], v31 offset:61440
v_cvt_pk_bf16_f32 v196, v132, v133
v_mfma_f32_16x16x32_bf16 v[156:159], a[84:87], a[12:15], v[156:159]
buffer_load_dwordx4 v22, s[20:23], s76 offen offset:2048 lds
ds_read_b64_tr_b16 a[126:127], v31 offset:63488
v_mfma_f32_16x16x32_bf16 v[156:159], a[88:91], a[20:23], v[156:159]
s_waitcnt lgkmcnt(4)
v_cvt_pk_bf16_f32 v197, v134, v135
v_cvt_pk_bf16_f32 v198, v140, v141
v_mfma_f32_16x16x32_bf16 v[156:159], a[92:95], a[28:31], v[156:159]
buffer_load_dwordx4 v23, s[20:23], s76 offen offset:3072 lds
v_mfma_f32_16x16x32_bf16 v[152:155], a[92:95], a[24:27], 0
v_cvt_pk_bf16_f32 v199, v142, v143
v_mfma_f32_16x16x32_bf16 v[152:155], a[88:91], a[16:19], v[152:155]
v_mfma_f32_16x16x32_bf16 v[152:155], a[84:87], a[8:11], v[152:155]
v_mfma_f32_16x16x32_bf16 v[152:155], a[80:83], a[0:3], v[152:155]
s_waitcnt vmcnt(16) lgkmcnt(0)
s_barrier
ds_read_b64_tr_b16 a[128:129], v28 offset:49152
v_mfma_f32_16x16x32_bf16 v[144:147], a[96:99], a[32:35], v[144:147]
s_mov_b32 s32, 0
ds_read_b64_tr_b16 a[130:131], v28 offset:51200
v_mfma_f32_16x16x32_bf16 v[144:147], a[100:103], a[40:43], v[144:147]
buffer_store_dwordx4 v[192:195], v44, s[24:27], s32 offen sc1
v_mfma_f32_16x16x32_bf16 v[144:147], a[104:107], a[48:51], v[144:147]
s_add_u32 m0, s28, 131072
s_add_u32 s76, s33, 384
ds_read_b64_tr_b16 a[132:133], v28 offset:53248
ds_read_b64_tr_b16 a[134:135], v28 offset:55296
v_mfma_f32_16x16x32_bf16 v[144:147], a[108:111], a[56:59], v[144:147]
buffer_load_dwordx4 v20, s[20:23], s76 offen lds
v_mfma_f32_16x16x32_bf16 v[148:151], a[108:111], a[60:63], v[148:151]
ds_read_b64_tr_b16 a[136:137], v28 offset:57344
ds_read_b64_tr_b16 a[138:139], v28 offset:59392
v_mfma_f32_16x16x32_bf16 v[148:151], a[104:107], a[52:55], v[148:151]
ds_read_b64_tr_b16 a[140:141], v28 offset:61440
ds_read_b64_tr_b16 a[142:143], v28 offset:63488
v_mfma_f32_16x16x32_bf16 v[148:151], a[100:103], a[44:47], v[148:151]
buffer_store_dwordx4 v[196:199], v44, s[24:27], s32 offen offset:1024 sc1
v_mfma_f32_16x16x32_bf16 v[148:151], a[96:99], a[36:39], v[148:151]
buffer_load_dwordx4 v21, s[20:23], s76 offen offset:1024 lds
v_mfma_f32_16x16x32_bf16 v[156:159], a[112:115], a[36:39], v[156:159]
ds_read_b64_tr_b16 a[144:145], v29 offset:49152
ds_read_b64_tr_b16 a[146:147], v29 offset:51200
v_mfma_f32_16x16x32_bf16 v[156:159], a[116:119], a[44:47], v[156:159]
ds_read_b64_tr_b16 a[148:149], v29 offset:53248
ds_read_b64_tr_b16 a[150:151], v29 offset:55296
v_mfma_f32_16x16x32_bf16 v[156:159], a[120:123], a[52:55], v[156:159]
ds_read_b64_tr_b16 a[152:153], v29 offset:57344
ds_read_b64_tr_b16 a[154:155], v29 offset:59392
v_mfma_f32_16x16x32_bf16 v[156:159], a[124:127], a[60:63], v[156:159]
buffer_load_dwordx4 v22, s[20:23], s76 offen offset:2048 lds
v_mfma_f32_16x16x32_bf16 v[152:155], a[124:127], a[56:59], v[152:155]
ds_read_b64_tr_b16 a[156:157], v29 offset:61440
ds_read_b64_tr_b16 a[158:159], v29 offset:63488
v_mfma_f32_16x16x32_bf16 v[152:155], a[120:123], a[48:51], v[152:155]
ds_read_b64_tr_b16 a[160:161], v30 offset:32768
ds_read_b64_tr_b16 a[162:163], v30 offset:34816
v_mfma_f32_16x16x32_bf16 v[152:155], a[116:119], a[40:43], v[152:155]
buffer_load_dwordx4 v23, s[20:23], s76 offen offset:3072 lds
v_mfma_f32_16x16x32_bf16 v[152:155], a[112:115], a[32:35], v[152:155]
s_waitcnt lgkmcnt(6)
ds_read_b64_tr_b16 a[164:165], v30 offset:36864
ds_read_b64_tr_b16 a[166:167], v30 offset:38912
v_mfma_f32_16x16x32_bf16 v[144:147], a[128:131], a[192:195], v[144:147]
ds_read_b64_tr_b16 a[168:169], v30 offset:40960
v_mbcnt_lo_u32_b32 v0, -1, 0
v_mfma_f32_16x16x32_bf16 v[144:147], a[132:135], a[200:203], v[144:147]
s_add_u32 m0, s28, 81920
s_add_u32 s76, s33, 115072
ds_read_b64_tr_b16 a[170:171], v30 offset:43008
v_mbcnt_hi_u32_b32 v0, -1, v0
v_mfma_f32_16x16x32_bf16 v[144:147], a[136:139], a[208:211], v[144:147]
buffer_load_dwordx4 v20, s[20:23], s76 offen lds
v_mfma_f32_16x16x32_bf16 v[144:147], a[140:143], a[216:219], v[144:147]
ds_read_b64_tr_b16 a[172:173], v30 offset:45056
ds_read_b64_tr_b16 a[174:175], v30 offset:47104
v_mfma_f32_16x16x32_bf16 v[148:151], a[140:143], a[220:223], v[148:151]
ds_read_b64_tr_b16 a[176:177], v31 offset:32768
v_lshlrev_b32 v1, 4, v0
v_mfma_f32_16x16x32_bf16 v[148:151], a[136:139], a[212:215], v[148:151]
ds_read_b64_tr_b16 a[178:179], v31 offset:34816
ds_read_b64_tr_b16 a[180:181], v31 offset:36864
v_mfma_f32_16x16x32_bf16 v[148:151], a[132:135], a[204:207], v[148:151]
buffer_load_dwordx4 v21, s[20:23], s76 offen offset:1024 lds
v_mfma_f32_16x16x32_bf16 v[148:151], a[128:131], a[196:199], v[148:151]
ds_read_b64_tr_b16 a[182:183], v31 offset:38912
v_and_b32 v6, 7, v0
v_mfma_f32_16x16x32_bf16 v[156:159], a[144:147], a[196:199], v[156:159]
ds_read_b64_tr_b16 a[184:185], v31 offset:40960
ds_read_b64_tr_b16 a[186:187], v31 offset:43008
v_mfma_f32_16x16x32_bf16 v[156:159], a[148:151], a[204:207], v[156:159]
s_waitcnt lgkmcnt(6)
ds_read_b64_tr_b16 a[188:189], v31 offset:45056
v_lshlrev_b32 v5, 7, v6
ds_read_b64_tr_b16 a[190:191], v31 offset:47104
v_mfma_f32_16x16x32_bf16 v[156:159], a[152:155], a[212:215], v[156:159]
buffer_load_dwordx4 v22, s[20:23], s76 offen offset:2048 lds
v_mfma_f32_16x16x32_bf16 v[156:159], a[156:159], a[220:223], v[156:159]
buffer_load_dwordx4 v23, s[20:23], s76 offen offset:3072 lds
v_mfma_f32_16x16x32_bf16 v[152:155], a[156:159], a[216:219], v[152:155]
v_and_b32 v6, 15, v0
v_mul_u32_u24 v8, 1792, v6
v_mfma_f32_16x16x32_bf16 v[152:155], a[152:155], a[208:211], v[152:155]
v_lshrrev_b32 v6, 4, v0
v_mfma_f32_16x16x32_bf16 v[152:155], a[148:151], a[200:203], v[152:155]
v_mfma_f32_16x16x32_bf16 v[152:155], a[144:147], a[192:195], v[152:155]
s_waitcnt vmcnt(16) lgkmcnt(0)
s_barrier
ds_read_b64_tr_b16 a[64:65], v28 offset:0
v_mfma_f32_16x16x32_bf16 v[144:147], a[160:163], a[224:227], v[144:147]
ds_read_b64_tr_b16 a[66:67], v28 offset:2048
v_lshl_add_u32 v8, v6, 4, v8
v_mfma_f32_16x16x32_bf16 v[144:147], a[164:167], a[232:235], v[144:147]
ds_read_b64_tr_b16 a[68:69], v28 offset:4096
v_mfma_f32_16x16x32_bf16 v[144:147], a[168:171], a[240:243], v[144:147]
s_add_u32 m0, s28, 147456
s_add_u32 s76, s33, 229760
ds_read_b64_tr_b16 a[70:71], v28 offset:6144
v_lshlrev_b32 v12, 20, v0
v_mfma_f32_16x16x32_bf16 v[144:147], a[172:175], a[248:251], v[144:147]
buffer_load_dwordx4 v20, s[20:23], s76 offen lds
v_mfma_f32_16x16x32_bf16 v[148:151], a[172:175], a[252:255], v[148:151]
ds_read_b64_tr_b16 a[72:73], v28 offset:8192
ds_read_b64_tr_b16 a[74:75], v28 offset:10240
v_mfma_f32_16x16x32_bf16 v[148:151], a[168:171], a[244:247], v[148:151]
ds_read_b64_tr_b16 a[76:77], v28 offset:12288
v_add_u32 v12, s72, v12
v_mfma_f32_16x16x32_bf16 v[148:151], a[164:167], a[236:239], v[148:151]
ds_read_b64_tr_b16 a[78:79], v28 offset:14336
ds_read_b64_tr_b16 a[80:81], v29 offset:0
v_mfma_f32_16x16x32_bf16 v[148:151], a[160:163], a[228:231], v[148:151]
buffer_load_dwordx4 v21, s[20:23], s76 offen offset:1024 lds
v_mfma_f32_16x16x32_bf16 v[156:159], a[176:179], a[228:231], v[156:159]
ds_read_b64_tr_b16 a[82:83], v29 offset:2048
v_mov_b32 v4, 1
v_mfma_f32_16x16x32_bf16 v[156:159], a[180:183], a[236:239], v[156:159]
ds_read_b64_tr_b16 a[84:85], v29 offset:4096
ds_read_b64_tr_b16 a[86:87], v29 offset:6144
v_mfma_f32_16x16x32_bf16 v[156:159], a[184:187], a[244:247], v[156:159]
ds_read_b64_tr_b16 a[88:89], v29 offset:8192
ds_read_b64_tr_b16 a[90:91], v29 offset:10240
v_mfma_f32_16x16x32_bf16 v[156:159], a[188:191], a[252:255], v[156:159]
buffer_load_dwordx4 v22, s[20:23], s76 offen offset:2048 lds
v_mfma_f32_16x16x32_bf16 v[152:155], a[188:191], a[248:251], v[152:155]
ds_read_b64_tr_b16 a[92:93], v29 offset:12288
ds_read_b64_tr_b16 a[94:95], v29 offset:14336
v_mfma_f32_16x16x32_bf16 v[152:155], a[184:187], a[240:243], v[152:155]
ds_read_b64_tr_b16 a[96:97], v30 offset:0
ds_read_b64_tr_b16 a[98:99], v30 offset:2048
v_mfma_f32_16x16x32_bf16 v[152:155], a[180:183], a[232:235], v[152:155]
buffer_load_dwordx4 v23, s[20:23], s76 offen offset:3072 lds
v_mfma_f32_16x16x32_bf16 v[152:155], a[176:179], a[224:227], v[152:155]
s_waitcnt lgkmcnt(6)
ds_read_b64_tr_b16 a[100:101], v30 offset:4096
ds_read_b64_tr_b16 a[102:103], v30 offset:6144
v_mfma_f32_16x16x32_bf16 v[128:131], a[64:67], a[0:3], 0
s_add_u32 m0, s28, 65536
s_add_u32 s76, s33, 344448
ds_read_b64_tr_b16 a[104:105], v30 offset:8192
ds_read_b64_tr_b16 a[106:107], v30 offset:10240
v_mfma_f32_16x16x32_bf16 v[128:131], a[68:71], a[8:11], v[128:131]
buffer_load_dwordx4 v20, s[20:23], s76 offen lds
v_mfma_f32_16x16x32_bf16 v[128:131], a[72:75], a[16:19], v[128:131]
ds_read_b64_tr_b16 a[108:109], v30 offset:12288
ds_read_b64_tr_b16 a[110:111], v30 offset:14336
v_mfma_f32_16x16x32_bf16 v[128:131], a[76:79], a[24:27], v[128:131]
ds_read_b64_tr_b16 a[112:113], v31 offset:0
v_cvt_pk_bf16_f32 v200, v144, v145
v_mfma_f32_16x16x32_bf16 v[132:135], a[76:79], a[28:31], 0
ds_read_b64_tr_b16 a[114:115], v31 offset:2048
v_cvt_pk_bf16_f32 v201, v146, v147
v_mfma_f32_16x16x32_bf16 v[132:135], a[72:75], a[20:23], v[132:135]
ds_read_b64_tr_b16 a[116:117], v31 offset:4096
v_cvt_pk_bf16_f32 v202, v152, v153
v_mfma_f32_16x16x32_bf16 v[132:135], a[68:71], a[12:15], v[132:135]
buffer_load_dwordx4 v21, s[20:23], s76 offen offset:1024 lds
v_mfma_f32_16x16x32_bf16 v[132:135], a[64:67], a[4:7], v[132:135]
ds_read_b64_tr_b16 a[118:119], v31 offset:6144
ds_read_b64_tr_b16 a[120:121], v31 offset:8192
v_mfma_f32_16x16x32_bf16 v[140:143], a[80:83], a[4:7], 0
ds_read_b64_tr_b16 a[122:123], v31 offset:10240
v_cvt_pk_bf16_f32 v203, v154, v155
v_mfma_f32_16x16x32_bf16 v[140:143], a[84:87], a[12:15], v[140:143]
s_waitcnt lgkmcnt(5)
ds_read_b64_tr_b16 a[124:125], v31 offset:12288
v_cvt_pk_bf16_f32 v204, v148, v149
ds_read_b64_tr_b16 a[126:127], v31 offset:14336
v_mfma_f32_16x16x32_bf16 v[140:143], a[88:91], a[20:23], v[140:143]
buffer_load_dwordx4 v22, s[20:23], s76 offen offset:2048 lds
v_mfma_f32_16x16x32_bf16 v[140:143], a[92:95], a[28:31], v[140:143]
v_cvt_pk_bf16_f32 v205, v150, v151
v_cvt_pk_bf16_f32 v206, v156, v157
v_mfma_f32_16x16x32_bf16 v[136:139], a[92:95], a[24:27], 0
buffer_load_dwordx4 v23, s[20:23], s76 offen offset:3072 lds
v_mfma_f32_16x16x32_bf16 v[136:139], a[88:91], a[16:19], v[136:139]
v_cvt_pk_bf16_f32 v207, v158, v159
v_mfma_f32_16x16x32_bf16 v[136:139], a[84:87], a[8:11], v[136:139]
v_mfma_f32_16x16x32_bf16 v[136:139], a[80:83], a[0:3], v[136:139]
s_waitcnt vmcnt(16) lgkmcnt(0)
s_barrier
ds_read_b64_tr_b16 a[128:129], v28 offset:16384
v_mfma_f32_16x16x32_bf16 v[128:131], a[96:99], a[32:35], v[128:131]
s_mov_b32 s32, 2048
ds_read_b64_tr_b16 a[130:131], v28 offset:18432
v_mfma_f32_16x16x32_bf16 v[128:131], a[100:103], a[40:43], v[128:131]
buffer_store_dwordx4 v[200:203], v44, s[24:27], s32 offen sc1
v_mfma_f32_16x16x32_bf16 v[128:131], a[104:107], a[48:51], v[128:131]
s_add_u32 m0, s28, 98304
s_add_u32 s76, s33, 512
ds_read_b64_tr_b16 a[132:133], v28 offset:20480
ds_read_b64_tr_b16 a[134:135], v28 offset:22528
v_mfma_f32_16x16x32_bf16 v[128:131], a[108:111], a[56:59], v[128:131]
buffer_load_dwordx4 v20, s[20:23], s76 offen lds
v_mfma_f32_16x16x32_bf16 v[132:135], a[108:111], a[60:63], v[132:135]
ds_read_b64_tr_b16 a[136:137], v28 offset:24576
ds_read_b64_tr_b16 a[138:139], v28 offset:26624
v_mfma_f32_16x16x32_bf16 v[132:135], a[104:107], a[52:55], v[132:135]
ds_read_b64_tr_b16 a[140:141], v28 offset:28672
ds_read_b64_tr_b16 a[142:143], v28 offset:30720
v_mfma_f32_16x16x32_bf16 v[132:135], a[100:103], a[44:47], v[132:135]
buffer_store_dwordx4 v[204:207], v44, s[24:27], s32 offen offset:1024 sc1
v_mfma_f32_16x16x32_bf16 v[132:135], a[96:99], a[36:39], v[132:135]
buffer_load_dwordx4 v21, s[20:23], s76 offen offset:1024 lds
v_mfma_f32_16x16x32_bf16 v[140:143], a[112:115], a[36:39], v[140:143]
ds_read_b64_tr_b16 a[144:145], v29 offset:16384
ds_read_b64_tr_b16 a[146:147], v29 offset:18432
v_mfma_f32_16x16x32_bf16 v[140:143], a[116:119], a[44:47], v[140:143]
ds_read_b64_tr_b16 a[148:149], v29 offset:20480
ds_read_b64_tr_b16 a[150:151], v29 offset:22528
v_mfma_f32_16x16x32_bf16 v[140:143], a[120:123], a[52:55], v[140:143]
ds_read_b64_tr_b16 a[152:153], v29 offset:24576
ds_read_b64_tr_b16 a[154:155], v29 offset:26624
v_mfma_f32_16x16x32_bf16 v[140:143], a[124:127], a[60:63], v[140:143]
buffer_load_dwordx4 v22, s[20:23], s76 offen offset:2048 lds
v_mfma_f32_16x16x32_bf16 v[136:139], a[124:127], a[56:59], v[136:139]
ds_read_b64_tr_b16 a[156:157], v29 offset:28672
ds_read_b64_tr_b16 a[158:159], v29 offset:30720
v_mfma_f32_16x16x32_bf16 v[136:139], a[120:123], a[48:51], v[136:139]
ds_read_b64_tr_b16 a[160:161], v30 offset:16384
ds_read_b64_tr_b16 a[162:163], v30 offset:18432
v_mfma_f32_16x16x32_bf16 v[136:139], a[116:119], a[40:43], v[136:139]
buffer_load_dwordx4 v23, s[20:23], s76 offen offset:3072 lds
v_mfma_f32_16x16x32_bf16 v[136:139], a[112:115], a[32:35], v[136:139]
s_waitcnt lgkmcnt(6)
ds_read_b64_tr_b16 a[164:165], v30 offset:20480
ds_read_b64_tr_b16 a[166:167], v30 offset:22528
v_mfma_f32_16x16x32_bf16 v[128:131], a[128:131], a[192:195], v[128:131]
s_add_u32 m0, s28, 32768
s_add_u32 s76, s33, 115200
ds_read_b64_tr_b16 a[168:169], v30 offset:24576
ds_read_b64_tr_b16 a[170:171], v30 offset:26624
v_mfma_f32_16x16x32_bf16 v[128:131], a[132:135], a[200:203], v[128:131]
buffer_load_dwordx4 v20, s[20:23], s76 offen lds
v_mfma_f32_16x16x32_bf16 v[128:131], a[136:139], a[208:211], v[128:131]
ds_read_b64_tr_b16 a[172:173], v30 offset:28672
ds_read_b64_tr_b16 a[174:175], v30 offset:30720
v_mfma_f32_16x16x32_bf16 v[128:131], a[140:143], a[216:219], v[128:131]
ds_read_b64_tr_b16 a[176:177], v31 offset:16384
ds_read_b64_tr_b16 a[178:179], v31 offset:18432
v_mfma_f32_16x16x32_bf16 v[132:135], a[140:143], a[220:223], v[132:135]
ds_read_b64_tr_b16 a[180:181], v31 offset:20480
ds_read_b64_tr_b16 a[182:183], v31 offset:22528
v_mfma_f32_16x16x32_bf16 v[132:135], a[136:139], a[212:215], v[132:135]
buffer_load_dwordx4 v21, s[20:23], s76 offen offset:1024 lds
v_mfma_f32_16x16x32_bf16 v[132:135], a[132:135], a[204:207], v[132:135]
ds_read_b64_tr_b16 a[184:185], v31 offset:24576
ds_read_b64_tr_b16 a[186:187], v31 offset:26624
v_mfma_f32_16x16x32_bf16 v[132:135], a[128:131], a[196:199], v[132:135]
ds_read_b64_tr_b16 a[188:189], v31 offset:28672
ds_read_b64_tr_b16 a[190:191], v31 offset:30720
v_mfma_f32_16x16x32_bf16 v[140:143], a[144:147], a[196:199], v[140:143]
buffer_load_dwordx4 v22, s[20:23], s76 offen offset:2048 lds
v_mfma_f32_16x16x32_bf16 v[140:143], a[148:151], a[204:207], v[140:143]
s_waitcnt lgkmcnt(6)
buffer_load_dwordx4 v23, s[20:23], s76 offen offset:3072 lds
v_mfma_f32_16x16x32_bf16 v[140:143], a[152:155], a[212:215], v[140:143]
v_mfma_f32_16x16x32_bf16 v[140:143], a[156:159], a[220:223], v[140:143]
v_mfma_f32_16x16x32_bf16 v[136:139], a[156:159], a[216:219], v[136:139]
v_mfma_f32_16x16x32_bf16 v[136:139], a[152:155], a[208:211], v[136:139]
v_mfma_f32_16x16x32_bf16 v[136:139], a[148:151], a[200:203], v[136:139]
v_mfma_f32_16x16x32_bf16 v[136:139], a[144:147], a[192:195], v[136:139]
s_waitcnt vmcnt(16) lgkmcnt(0)
s_barrier
ds_read_b64_tr_b16 a[64:65], v28 offset:32768
v_mfma_f32_16x16x32_bf16 v[128:131], a[160:163], a[224:227], v[128:131]
ds_read_b64_tr_b16 a[66:67], v28 offset:34816
v_mfma_f32_16x16x32_bf16 v[128:131], a[164:167], a[232:235], v[128:131]
s_add_u32 m0, s28, 114688
s_add_u32 s76, s33, 229888
ds_read_b64_tr_b16 a[68:69], v28 offset:36864
v_mfma_f32_16x16x32_bf16 v[128:131], a[168:171], a[240:243], v[128:131]
buffer_load_dwordx4 v20, s[20:23], s76 offen lds
v_mfma_f32_16x16x32_bf16 v[128:131], a[172:175], a[248:251], v[128:131]
ds_read_b64_tr_b16 a[70:71], v28 offset:38912
ds_read_b64_tr_b16 a[72:73], v28 offset:40960
v_mfma_f32_16x16x32_bf16 v[132:135], a[172:175], a[252:255], v[132:135]
ds_read_b64_tr_b16 a[74:75], v28 offset:43008
ds_read_b64_tr_b16 a[76:77], v28 offset:45056
v_mfma_f32_16x16x32_bf16 v[132:135], a[168:171], a[244:247], v[132:135]
ds_read_b64_tr_b16 a[78:79], v28 offset:47104
v_mfma_f32_16x16x32_bf16 v[132:135], a[164:167], a[236:239], v[132:135]
buffer_load_dwordx4 v21, s[20:23], s76 offen offset:1024 lds
v_mfma_f32_16x16x32_bf16 v[132:135], a[160:163], a[228:231], v[132:135]
ds_read_b64_tr_b16 a[80:81], v29 offset:32768
ds_read_b64_tr_b16 a[82:83], v29 offset:34816
v_mfma_f32_16x16x32_bf16 v[140:143], a[176:179], a[228:231], v[140:143]
ds_read_b64_tr_b16 a[84:85], v29 offset:36864
ds_read_b64_tr_b16 a[86:87], v29 offset:38912
v_mfma_f32_16x16x32_bf16 v[140:143], a[180:183], a[236:239], v[140:143]
ds_read_b64_tr_b16 a[88:89], v29 offset:40960
ds_read_b64_tr_b16 a[90:91], v29 offset:43008
v_mfma_f32_16x16x32_bf16 v[140:143], a[184:187], a[244:247], v[140:143]
buffer_load_dwordx4 v22, s[20:23], s76 offen offset:2048 lds
v_mfma_f32_16x16x32_bf16 v[140:143], a[188:191], a[252:255], v[140:143]
ds_read_b64_tr_b16 a[92:93], v29 offset:45056
ds_read_b64_tr_b16 a[94:95], v29 offset:47104
v_mfma_f32_16x16x32_bf16 v[136:139], a[188:191], a[248:251], v[136:139]
ds_read_b64_tr_b16 a[96:97], v30 offset:49152
ds_read_b64_tr_b16 a[98:99], v30 offset:51200
v_mfma_f32_16x16x32_bf16 v[136:139], a[184:187], a[240:243], v[136:139]
buffer_load_dwordx4 v23, s[20:23], s76 offen offset:3072 lds
v_mfma_f32_16x16x32_bf16 v[136:139], a[180:183], a[232:235], v[136:139]
ds_read_b64_tr_b16 a[100:101], v30 offset:53248
ds_read_b64_tr_b16 a[102:103], v30 offset:55296
v_mfma_f32_16x16x32_bf16 v[136:139], a[176:179], a[224:227], v[136:139]
s_add_u32 m0, s28, 49152
s_add_u32 s76, s33, 344576
s_waitcnt lgkmcnt(6)
ds_read_b64_tr_b16 a[104:105], v30 offset:57344
ds_read_b64_tr_b16 a[106:107], v30 offset:59392
v_mfma_f32_16x16x32_bf16 v[144:147], a[64:67], a[0:3], 0
buffer_load_dwordx4 v20, s[20:23], s76 offen lds
v_mfma_f32_16x16x32_bf16 v[144:147], a[68:71], a[8:11], v[144:147]
ds_read_b64_tr_b16 a[108:109], v30 offset:61440
ds_read_b64_tr_b16 a[110:111], v30 offset:63488
v_mfma_f32_16x16x32_bf16 v[144:147], a[72:75], a[16:19], v[144:147]
ds_read_b64_tr_b16 a[112:113], v31 offset:49152
ds_read_b64_tr_b16 a[114:115], v31 offset:51200
v_mfma_f32_16x16x32_bf16 v[144:147], a[76:79], a[24:27], v[144:147]
ds_read_b64_tr_b16 a[116:117], v31 offset:53248
v_cvt_pk_bf16_f32 v192, v128, v129
v_mfma_f32_16x16x32_bf16 v[148:151], a[76:79], a[28:31], 0
ds_read_b64_tr_b16 a[118:119], v31 offset:55296
v_cvt_pk_bf16_f32 v193, v130, v131
v_mfma_f32_16x16x32_bf16 v[148:151], a[72:75], a[20:23], v[148:151]
buffer_load_dwordx4 v21, s[20:23], s76 offen offset:1024 lds
v_mfma_f32_16x16x32_bf16 v[148:151], a[68:71], a[12:15], v[148:151]
ds_read_b64_tr_b16 a[120:121], v31 offset:57344
v_cvt_pk_bf16_f32 v194, v136, v137
v_mfma_f32_16x16x32_bf16 v[148:151], a[64:67], a[4:7], v[148:151]
ds_read_b64_tr_b16 a[122:123], v31 offset:59392
v_cvt_pk_bf16_f32 v195, v138, v139
v_mfma_f32_16x16x32_bf16 v[156:159], a[80:83], a[4:7], 0
ds_read_b64_tr_b16 a[124:125], v31 offset:61440
v_cvt_pk_bf16_f32 v196, v132, v133
v_mfma_f32_16x16x32_bf16 v[156:159], a[84:87], a[12:15], v[156:159]
buffer_load_dwordx4 v22, s[20:23], s76 offen offset:2048 lds
ds_read_b64_tr_b16 a[126:127], v31 offset:63488
v_mfma_f32_16x16x32_bf16 v[156:159], a[88:91], a[20:23], v[156:159]
s_waitcnt lgkmcnt(4)
v_cvt_pk_bf16_f32 v197, v134, v135
v_cvt_pk_bf16_f32 v198, v140, v141
v_mfma_f32_16x16x32_bf16 v[156:159], a[92:95], a[28:31], v[156:159]
buffer_load_dwordx4 v23, s[20:23], s76 offen offset:3072 lds
v_mfma_f32_16x16x32_bf16 v[152:155], a[92:95], a[24:27], 0
v_cvt_pk_bf16_f32 v199, v142, v143
v_mfma_f32_16x16x32_bf16 v[152:155], a[88:91], a[16:19], v[152:155]
v_mfma_f32_16x16x32_bf16 v[152:155], a[84:87], a[8:11], v[152:155]
v_mfma_f32_16x16x32_bf16 v[152:155], a[80:83], a[0:3], v[152:155]
s_waitcnt vmcnt(16) lgkmcnt(0)
s_barrier
ds_read_b64_tr_b16 a[128:129], v28 offset:49152
v_mfma_f32_16x16x32_bf16 v[144:147], a[96:99], a[32:35], v[144:147]
s_mov_b32 s32, 4096
ds_read_b64_tr_b16 a[130:131], v28 offset:51200
v_mfma_f32_16x16x32_bf16 v[144:147], a[100:103], a[40:43], v[144:147]
buffer_store_dwordx4 v[192:195], v44, s[24:27], s32 offen sc1
v_mfma_f32_16x16x32_bf16 v[144:147], a[104:107], a[48:51], v[144:147]
s_add_u32 m0, s28, 131072
s_add_u32 s76, s33, 640
ds_read_b64_tr_b16 a[132:133], v28 offset:53248
ds_read_b64_tr_b16 a[134:135], v28 offset:55296
v_mfma_f32_16x16x32_bf16 v[144:147], a[108:111], a[56:59], v[144:147]
buffer_load_dwordx4 v20, s[20:23], s76 offen lds
v_mfma_f32_16x16x32_bf16 v[148:151], a[108:111], a[60:63], v[148:151]
ds_read_b64_tr_b16 a[136:137], v28 offset:57344
ds_read_b64_tr_b16 a[138:139], v28 offset:59392
v_mfma_f32_16x16x32_bf16 v[148:151], a[104:107], a[52:55], v[148:151]
ds_read_b64_tr_b16 a[140:141], v28 offset:61440
ds_read_b64_tr_b16 a[142:143], v28 offset:63488
v_mfma_f32_16x16x32_bf16 v[148:151], a[100:103], a[44:47], v[148:151]
buffer_store_dwordx4 v[196:199], v44, s[24:27], s32 offen offset:1024 sc1
v_mfma_f32_16x16x32_bf16 v[148:151], a[96:99], a[36:39], v[148:151]
buffer_load_dwordx4 v21, s[20:23], s76 offen offset:1024 lds
v_mfma_f32_16x16x32_bf16 v[156:159], a[112:115], a[36:39], v[156:159]
ds_read_b64_tr_b16 a[144:145], v29 offset:49152
ds_read_b64_tr_b16 a[146:147], v29 offset:51200
v_mfma_f32_16x16x32_bf16 v[156:159], a[116:119], a[44:47], v[156:159]
ds_read_b64_tr_b16 a[148:149], v29 offset:53248
ds_read_b64_tr_b16 a[150:151], v29 offset:55296
v_mfma_f32_16x16x32_bf16 v[156:159], a[120:123], a[52:55], v[156:159]
ds_read_b64_tr_b16 a[152:153], v29 offset:57344
ds_read_b64_tr_b16 a[154:155], v29 offset:59392
v_mfma_f32_16x16x32_bf16 v[156:159], a[124:127], a[60:63], v[156:159]
buffer_load_dwordx4 v22, s[20:23], s76 offen offset:2048 lds
v_mfma_f32_16x16x32_bf16 v[152:155], a[124:127], a[56:59], v[152:155]
ds_read_b64_tr_b16 a[156:157], v29 offset:61440
ds_read_b64_tr_b16 a[158:159], v29 offset:63488
v_mfma_f32_16x16x32_bf16 v[152:155], a[120:123], a[48:51], v[152:155]
ds_read_b64_tr_b16 a[160:161], v30 offset:32768
ds_read_b64_tr_b16 a[162:163], v30 offset:34816
v_mfma_f32_16x16x32_bf16 v[152:155], a[116:119], a[40:43], v[152:155]
buffer_load_dwordx4 v23, s[20:23], s76 offen offset:3072 lds
v_mfma_f32_16x16x32_bf16 v[152:155], a[112:115], a[32:35], v[152:155]
s_waitcnt lgkmcnt(6)
ds_read_b64_tr_b16 a[164:165], v30 offset:36864
ds_read_b64_tr_b16 a[166:167], v30 offset:38912
v_mfma_f32_16x16x32_bf16 v[144:147], a[128:131], a[192:195], v[144:147]
s_add_u32 m0, s28, 81920
s_add_u32 s76, s33, 115328
ds_read_b64_tr_b16 a[168:169], v30 offset:40960
ds_read_b64_tr_b16 a[170:171], v30 offset:43008
v_mfma_f32_16x16x32_bf16 v[144:147], a[132:135], a[200:203], v[144:147]
buffer_load_dwordx4 v20, s[20:23], s76 offen lds
v_mfma_f32_16x16x32_bf16 v[144:147], a[136:139], a[208:211], v[144:147]
ds_read_b64_tr_b16 a[172:173], v30 offset:45056
ds_read_b64_tr_b16 a[174:175], v30 offset:47104
v_mfma_f32_16x16x32_bf16 v[144:147], a[140:143], a[216:219], v[144:147]
ds_read_b64_tr_b16 a[176:177], v31 offset:32768
ds_read_b64_tr_b16 a[178:179], v31 offset:34816
v_mfma_f32_16x16x32_bf16 v[148:151], a[140:143], a[220:223], v[148:151]
ds_read_b64_tr_b16 a[180:181], v31 offset:36864
ds_read_b64_tr_b16 a[182:183], v31 offset:38912
v_mfma_f32_16x16x32_bf16 v[148:151], a[136:139], a[212:215], v[148:151]
buffer_load_dwordx4 v21, s[20:23], s76 offen offset:1024 lds
v_mfma_f32_16x16x32_bf16 v[148:151], a[132:135], a[204:207], v[148:151]
ds_read_b64_tr_b16 a[184:185], v31 offset:40960
ds_read_b64_tr_b16 a[186:187], v31 offset:43008
v_mfma_f32_16x16x32_bf16 v[148:151], a[128:131], a[196:199], v[148:151]
ds_read_b64_tr_b16 a[188:189], v31 offset:45056
ds_read_b64_tr_b16 a[190:191], v31 offset:47104
v_mfma_f32_16x16x32_bf16 v[156:159], a[144:147], a[196:199], v[156:159]
buffer_load_dwordx4 v22, s[20:23], s76 offen offset:2048 lds
v_mfma_f32_16x16x32_bf16 v[156:159], a[148:151], a[204:207], v[156:159]
s_waitcnt lgkmcnt(6)
buffer_load_dwordx4 v23, s[20:23], s76 offen offset:3072 lds
v_mfma_f32_16x16x32_bf16 v[156:159], a[152:155], a[212:215], v[156:159]
v_mfma_f32_16x16x32_bf16 v[156:159], a[156:159], a[220:223], v[156:159]
v_mfma_f32_16x16x32_bf16 v[152:155], a[156:159], a[216:219], v[152:155]
v_mfma_f32_16x16x32_bf16 v[152:155], a[152:155], a[208:211], v[152:155]
v_mfma_f32_16x16x32_bf16 v[152:155], a[148:151], a[200:203], v[152:155]
v_mfma_f32_16x16x32_bf16 v[152:155], a[144:147], a[192:195], v[152:155]
s_waitcnt vmcnt(16) lgkmcnt(0)
s_barrier
ds_read_b64_tr_b16 a[64:65], v28 offset:0
v_mfma_f32_16x16x32_bf16 v[144:147], a[160:163], a[224:227], v[144:147]
ds_read_b64_tr_b16 a[66:67], v28 offset:2048
v_mfma_f32_16x16x32_bf16 v[144:147], a[164:167], a[232:235], v[144:147]
s_add_u32 m0, s28, 147456
s_add_u32 s76, s33, 230016
ds_read_b64_tr_b16 a[68:69], v28 offset:4096
v_mfma_f32_16x16x32_bf16 v[144:147], a[168:171], a[240:243], v[144:147]
buffer_load_dwordx4 v20, s[20:23], s76 offen lds
v_mfma_f32_16x16x32_bf16 v[144:147], a[172:175], a[248:251], v[144:147]
ds_read_b64_tr_b16 a[70:71], v28 offset:6144
ds_read_b64_tr_b16 a[72:73], v28 offset:8192
v_mfma_f32_16x16x32_bf16 v[148:151], a[172:175], a[252:255], v[148:151]
ds_read_b64_tr_b16 a[74:75], v28 offset:10240
ds_read_b64_tr_b16 a[76:77], v28 offset:12288
v_mfma_f32_16x16x32_bf16 v[148:151], a[168:171], a[244:247], v[148:151]
ds_read_b64_tr_b16 a[78:79], v28 offset:14336
v_mfma_f32_16x16x32_bf16 v[148:151], a[164:167], a[236:239], v[148:151]
buffer_load_dwordx4 v21, s[20:23], s76 offen offset:1024 lds
v_mfma_f32_16x16x32_bf16 v[148:151], a[160:163], a[228:231], v[148:151]
ds_read_b64_tr_b16 a[80:81], v29 offset:0
ds_read_b64_tr_b16 a[82:83], v29 offset:2048
v_mfma_f32_16x16x32_bf16 v[156:159], a[176:179], a[228:231], v[156:159]
ds_read_b64_tr_b16 a[84:85], v29 offset:4096
ds_read_b64_tr_b16 a[86:87], v29 offset:6144
v_mfma_f32_16x16x32_bf16 v[156:159], a[180:183], a[236:239], v[156:159]
ds_read_b64_tr_b16 a[88:89], v29 offset:8192
ds_read_b64_tr_b16 a[90:91], v29 offset:10240
v_mfma_f32_16x16x32_bf16 v[156:159], a[184:187], a[244:247], v[156:159]
buffer_load_dwordx4 v22, s[20:23], s76 offen offset:2048 lds
v_mfma_f32_16x16x32_bf16 v[156:159], a[188:191], a[252:255], v[156:159]
ds_read_b64_tr_b16 a[92:93], v29 offset:12288
ds_read_b64_tr_b16 a[94:95], v29 offset:14336
v_mfma_f32_16x16x32_bf16 v[152:155], a[188:191], a[248:251], v[152:155]
ds_read_b64_tr_b16 a[96:97], v30 offset:0
ds_read_b64_tr_b16 a[98:99], v30 offset:2048
v_mfma_f32_16x16x32_bf16 v[152:155], a[184:187], a[240:243], v[152:155]
buffer_load_dwordx4 v23, s[20:23], s76 offen offset:3072 lds
v_mfma_f32_16x16x32_bf16 v[152:155], a[180:183], a[232:235], v[152:155]
ds_read_b64_tr_b16 a[100:101], v30 offset:4096
ds_read_b64_tr_b16 a[102:103], v30 offset:6144
v_mfma_f32_16x16x32_bf16 v[152:155], a[176:179], a[224:227], v[152:155]
s_add_u32 m0, s28, 65536
s_add_u32 s76, s33, 344704
s_waitcnt lgkmcnt(6)
ds_read_b64_tr_b16 a[104:105], v30 offset:8192
ds_read_b64_tr_b16 a[106:107], v30 offset:10240
v_mfma_f32_16x16x32_bf16 v[128:131], a[64:67], a[0:3], 0
buffer_load_dwordx4 v20, s[20:23], s76 offen lds
v_mfma_f32_16x16x32_bf16 v[128:131], a[68:71], a[8:11], v[128:131]
ds_read_b64_tr_b16 a[108:109], v30 offset:12288
ds_read_b64_tr_b16 a[110:111], v30 offset:14336
v_mfma_f32_16x16x32_bf16 v[128:131], a[72:75], a[16:19], v[128:131]
ds_read_b64_tr_b16 a[112:113], v31 offset:0
ds_read_b64_tr_b16 a[114:115], v31 offset:2048
v_mfma_f32_16x16x32_bf16 v[128:131], a[76:79], a[24:27], v[128:131]
ds_read_b64_tr_b16 a[116:117], v31 offset:4096
v_cvt_pk_bf16_f32 v200, v144, v145
v_mfma_f32_16x16x32_bf16 v[132:135], a[76:79], a[28:31], 0
ds_read_b64_tr_b16 a[118:119], v31 offset:6144
v_cvt_pk_bf16_f32 v201, v146, v147
v_mfma_f32_16x16x32_bf16 v[132:135], a[72:75], a[20:23], v[132:135]
buffer_load_dwordx4 v21, s[20:23], s76 offen offset:1024 lds
v_mfma_f32_16x16x32_bf16 v[132:135], a[68:71], a[12:15], v[132:135]
ds_read_b64_tr_b16 a[120:121], v31 offset:8192
v_cvt_pk_bf16_f32 v202, v152, v153
v_mfma_f32_16x16x32_bf16 v[132:135], a[64:67], a[4:7], v[132:135]
ds_read_b64_tr_b16 a[122:123], v31 offset:10240
v_cvt_pk_bf16_f32 v203, v154, v155
v_mfma_f32_16x16x32_bf16 v[140:143], a[80:83], a[4:7], 0
ds_read_b64_tr_b16 a[124:125], v31 offset:12288
v_cvt_pk_bf16_f32 v204, v148, v149
v_mfma_f32_16x16x32_bf16 v[140:143], a[84:87], a[12:15], v[140:143]
buffer_load_dwordx4 v22, s[20:23], s76 offen offset:2048 lds
ds_read_b64_tr_b16 a[126:127], v31 offset:14336
v_mfma_f32_16x16x32_bf16 v[140:143], a[88:91], a[20:23], v[140:143]
s_waitcnt lgkmcnt(4)
v_cvt_pk_bf16_f32 v205, v150, v151
v_cvt_pk_bf16_f32 v206, v156, v157
v_mfma_f32_16x16x32_bf16 v[140:143], a[92:95], a[28:31], v[140:143]
buffer_load_dwordx4 v23, s[20:23], s76 offen offset:3072 lds
v_mfma_f32_16x16x32_bf16 v[136:139], a[92:95], a[24:27], 0
v_cvt_pk_bf16_f32 v207, v158, v159
v_mfma_f32_16x16x32_bf16 v[136:139], a[88:91], a[16:19], v[136:139]
v_mfma_f32_16x16x32_bf16 v[136:139], a[84:87], a[8:11], v[136:139]
v_mfma_f32_16x16x32_bf16 v[136:139], a[80:83], a[0:3], v[136:139]
s_waitcnt vmcnt(16) lgkmcnt(0)
s_barrier
ds_read_b64_tr_b16 a[128:129], v28 offset:16384
v_mfma_f32_16x16x32_bf16 v[128:131], a[96:99], a[32:35], v[128:131]
s_mov_b32 s32, 6144
ds_read_b64_tr_b16 a[130:131], v28 offset:18432
v_mfma_f32_16x16x32_bf16 v[128:131], a[100:103], a[40:43], v[128:131]
buffer_store_dwordx4 v[200:203], v44, s[24:27], s32 offen sc1
v_mfma_f32_16x16x32_bf16 v[128:131], a[104:107], a[48:51], v[128:131]
s_add_u32 m0, s28, 98304
s_add_u32 s76, s33, 768
ds_read_b64_tr_b16 a[132:133], v28 offset:20480
ds_read_b64_tr_b16 a[134:135], v28 offset:22528
v_mfma_f32_16x16x32_bf16 v[128:131], a[108:111], a[56:59], v[128:131]
buffer_load_dwordx4 v20, s[20:23], s76 offen lds
v_mfma_f32_16x16x32_bf16 v[132:135], a[108:111], a[60:63], v[132:135]
ds_read_b64_tr_b16 a[136:137], v28 offset:24576
ds_read_b64_tr_b16 a[138:139], v28 offset:26624
v_mfma_f32_16x16x32_bf16 v[132:135], a[104:107], a[52:55], v[132:135]
ds_read_b64_tr_b16 a[140:141], v28 offset:28672
ds_read_b64_tr_b16 a[142:143], v28 offset:30720
v_mfma_f32_16x16x32_bf16 v[132:135], a[100:103], a[44:47], v[132:135]
buffer_store_dwordx4 v[204:207], v44, s[24:27], s32 offen offset:1024 sc1
v_mfma_f32_16x16x32_bf16 v[132:135], a[96:99], a[36:39], v[132:135]
buffer_load_dwordx4 v21, s[20:23], s76 offen offset:1024 lds
v_mfma_f32_16x16x32_bf16 v[140:143], a[112:115], a[36:39], v[140:143]
ds_read_b64_tr_b16 a[144:145], v29 offset:16384
ds_read_b64_tr_b16 a[146:147], v29 offset:18432
v_mfma_f32_16x16x32_bf16 v[140:143], a[116:119], a[44:47], v[140:143]
ds_read_b64_tr_b16 a[148:149], v29 offset:20480
ds_read_b64_tr_b16 a[150:151], v29 offset:22528
v_mfma_f32_16x16x32_bf16 v[140:143], a[120:123], a[52:55], v[140:143]
ds_read_b64_tr_b16 a[152:153], v29 offset:24576
ds_read_b64_tr_b16 a[154:155], v29 offset:26624
v_mfma_f32_16x16x32_bf16 v[140:143], a[124:127], a[60:63], v[140:143]
buffer_load_dwordx4 v22, s[20:23], s76 offen offset:2048 lds
v_mfma_f32_16x16x32_bf16 v[136:139], a[124:127], a[56:59], v[136:139]
ds_read_b64_tr_b16 a[156:157], v29 offset:28672
ds_read_b64_tr_b16 a[158:159], v29 offset:30720
v_mfma_f32_16x16x32_bf16 v[136:139], a[120:123], a[48:51], v[136:139]
ds_read_b64_tr_b16 a[160:161], v30 offset:16384
ds_read_b64_tr_b16 a[162:163], v30 offset:18432
v_mfma_f32_16x16x32_bf16 v[136:139], a[116:119], a[40:43], v[136:139]
buffer_load_dwordx4 v23, s[20:23], s76 offen offset:3072 lds
v_mfma_f32_16x16x32_bf16 v[136:139], a[112:115], a[32:35], v[136:139]
s_waitcnt lgkmcnt(6)
ds_read_b64_tr_b16 a[164:165], v30 offset:20480
ds_read_b64_tr_b16 a[166:167], v30 offset:22528
v_mfma_f32_16x16x32_bf16 v[128:131], a[128:131], a[192:195], v[128:131]
s_add_u32 m0, s28, 32768
s_add_u32 s76, s33, 115456
ds_read_b64_tr_b16 a[168:169], v30 offset:24576
ds_read_b64_tr_b16 a[170:171], v30 offset:26624
v_mfma_f32_16x16x32_bf16 v[128:131], a[132:135], a[200:203], v[128:131]
buffer_load_dwordx4 v20, s[20:23], s76 offen lds
v_mfma_f32_16x16x32_bf16 v[128:131], a[136:139], a[208:211], v[128:131]
ds_read_b64_tr_b16 a[172:173], v30 offset:28672
ds_read_b64_tr_b16 a[174:175], v30 offset:30720
v_mfma_f32_16x16x32_bf16 v[128:131], a[140:143], a[216:219], v[128:131]
ds_read_b64_tr_b16 a[176:177], v31 offset:16384
ds_read_b64_tr_b16 a[178:179], v31 offset:18432
v_mfma_f32_16x16x32_bf16 v[132:135], a[140:143], a[220:223], v[132:135]
ds_read_b64_tr_b16 a[180:181], v31 offset:20480
ds_read_b64_tr_b16 a[182:183], v31 offset:22528
v_mfma_f32_16x16x32_bf16 v[132:135], a[136:139], a[212:215], v[132:135]
buffer_load_dwordx4 v21, s[20:23], s76 offen offset:1024 lds
v_mfma_f32_16x16x32_bf16 v[132:135], a[132:135], a[204:207], v[132:135]
ds_read_b64_tr_b16 a[184:185], v31 offset:24576
ds_read_b64_tr_b16 a[186:187], v31 offset:26624
v_mfma_f32_16x16x32_bf16 v[132:135], a[128:131], a[196:199], v[132:135]
ds_read_b64_tr_b16 a[188:189], v31 offset:28672
ds_read_b64_tr_b16 a[190:191], v31 offset:30720
v_mfma_f32_16x16x32_bf16 v[140:143], a[144:147], a[196:199], v[140:143]
buffer_load_dwordx4 v22, s[20:23], s76 offen offset:2048 lds
v_mfma_f32_16x16x32_bf16 v[140:143], a[148:151], a[204:207], v[140:143]
s_waitcnt lgkmcnt(6)
buffer_load_dwordx4 v23, s[20:23], s76 offen offset:3072 lds
v_mfma_f32_16x16x32_bf16 v[140:143], a[152:155], a[212:215], v[140:143]
v_mfma_f32_16x16x32_bf16 v[140:143], a[156:159], a[220:223], v[140:143]
v_mfma_f32_16x16x32_bf16 v[136:139], a[156:159], a[216:219], v[136:139]
v_mfma_f32_16x16x32_bf16 v[136:139], a[152:155], a[208:211], v[136:139]
v_mfma_f32_16x16x32_bf16 v[136:139], a[148:151], a[200:203], v[136:139]
v_mfma_f32_16x16x32_bf16 v[136:139], a[144:147], a[192:195], v[136:139]
s_waitcnt vmcnt(16) lgkmcnt(0)
s_barrier
ds_read_b64_tr_b16 a[64:65], v28 offset:32768
v_mfma_f32_16x16x32_bf16 v[128:131], a[160:163], a[224:227], v[128:131]
ds_read_b64_tr_b16 a[66:67], v28 offset:34816
v_mfma_f32_16x16x32_bf16 v[128:131], a[164:167], a[232:235], v[128:131]
s_add_u32 m0, s28, 114688
s_add_u32 s76, s33, 230144
ds_read_b64_tr_b16 a[68:69], v28 offset:36864
v_mfma_f32_16x16x32_bf16 v[128:131], a[168:171], a[240:243], v[128:131]
buffer_load_dwordx4 v20, s[20:23], s76 offen lds
v_mfma_f32_16x16x32_bf16 v[128:131], a[172:175], a[248:251], v[128:131]
ds_read_b64_tr_b16 a[70:71], v28 offset:38912
ds_read_b64_tr_b16 a[72:73], v28 offset:40960
v_mfma_f32_16x16x32_bf16 v[132:135], a[172:175], a[252:255], v[132:135]
ds_read_b64_tr_b16 a[74:75], v28 offset:43008
v_mfma_f32_16x16x32_bf16 v[132:135], a[168:171], a[244:247], v[132:135]
ds_read_b64_tr_b16 a[76:77], v28 offset:45056
v_mfma_f32_16x16x32_bf16 v[132:135], a[164:167], a[236:239], v[132:135]
buffer_load_dwordx4 v21, s[20:23], s76 offen offset:1024 lds
v_mfma_f32_16x16x32_bf16 v[132:135], a[160:163], a[228:231], v[132:135]
ds_read_b64_tr_b16 a[78:79], v28 offset:47104
ds_read_b64_tr_b16 a[80:81], v29 offset:32768
v_mfma_f32_16x16x32_bf16 v[140:143], a[176:179], a[228:231], v[140:143]
ds_read_b64_tr_b16 a[82:83], v29 offset:34816
v_mfma_f32_16x16x32_bf16 v[140:143], a[180:183], a[236:239], v[140:143]
buffer_load_dwordx4 v22, s[20:23], s76 offen offset:2048 lds
v_mfma_f32_16x16x32_bf16 v[140:143], a[184:187], a[244:247], v[140:143]
ds_read_b64_tr_b16 a[84:85], v29 offset:36864
ds_read_b64_tr_b16 a[86:87], v29 offset:38912
v_mfma_f32_16x16x32_bf16 v[140:143], a[188:191], a[252:255], v[140:143]
ds_read_b64_tr_b16 a[88:89], v29 offset:40960
ds_read_b64_tr_b16 a[90:91], v29 offset:43008
v_mfma_f32_16x16x32_bf16 v[136:139], a[188:191], a[248:251], v[136:139]
ds_read_b64_tr_b16 a[92:93], v29 offset:45056
v_mfma_f32_16x16x32_bf16 v[136:139], a[184:187], a[240:243], v[136:139]
buffer_load_dwordx4 v23, s[20:23], s76 offen offset:3072 lds
v_mfma_f32_16x16x32_bf16 v[136:139], a[180:183], a[232:235], v[136:139]
ds_read_b64_tr_b16 a[94:95], v29 offset:47104
ds_read_b64_tr_b16 a[96:97], v30 offset:49152
v_mfma_f32_16x16x32_bf16 v[136:139], a[176:179], a[224:227], v[136:139]
s_add_u32 m0, s28, 49152
s_add_u32 s76, s33, 344832
s_waitcnt lgkmcnt(7)
ds_read_b64_tr_b16 a[98:99], v30 offset:51200
v_mfma_f32_16x16x32_bf16 v[144:147], a[64:67], a[0:3], 0
buffer_load_dwordx4 v20, s[20:23], s76 offen lds
v_mfma_f32_16x16x32_bf16 v[144:147], a[68:71], a[8:11], v[144:147]
ds_read_b64_tr_b16 a[100:101], v30 offset:53248
ds_read_b64_tr_b16 a[102:103], v30 offset:55296
v_mfma_f32_16x16x32_bf16 v[144:147], a[72:75], a[16:19], v[144:147]
ds_read_b64_tr_b16 a[104:105], v30 offset:57344
v_mfma_f32_16x16x32_bf16 v[144:147], a[76:79], a[24:27], v[144:147]
ds_read_b64_tr_b16 a[106:107], v30 offset:59392
v_cvt_pk_bf16_f32 v192, v128, v129
v_mfma_f32_16x16x32_bf16 v[148:151], a[76:79], a[28:31], 0
ds_read_b64_tr_b16 a[108:109], v30 offset:61440
v_cvt_pk_bf16_f32 v193, v130, v131
v_mfma_f32_16x16x32_bf16 v[148:151], a[72:75], a[20:23], v[148:151]
buffer_load_dwordx4 v21, s[20:23], s76 offen offset:1024 lds
v_mfma_f32_16x16x32_bf16 v[148:151], a[68:71], a[12:15], v[148:151]
ds_read_b64_tr_b16 a[110:111], v30 offset:63488
v_cvt_pk_bf16_f32 v194, v136, v137
v_mfma_f32_16x16x32_bf16 v[148:151], a[64:67], a[4:7], v[148:151]
ds_read_b64_tr_b16 a[112:113], v31 offset:49152
v_cvt_pk_bf16_f32 v195, v138, v139
v_mfma_f32_16x16x32_bf16 v[156:159], a[80:83], a[4:7], 0
s_waitcnt lgkmcnt(4)
ds_read_b64_tr_b16 a[114:115], v31 offset:51200
v_cvt_pk_bf16_f32 v196, v132, v133
v_mfma_f32_16x16x32_bf16 v[156:159], a[84:87], a[12:15], v[156:159]
buffer_load_dwordx4 v22, s[20:23], s76 offen offset:2048 lds
v_mfma_f32_16x16x32_bf16 v[156:159], a[88:91], a[20:23], v[156:159]
ds_read_b64_tr_b16 a[116:117], v31 offset:53248
v_cvt_pk_bf16_f32 v197, v134, v135
v_mfma_f32_16x16x32_bf16 v[156:159], a[92:95], a[28:31], v[156:159]
ds_read_b64_tr_b16 a[118:119], v31 offset:55296
v_cvt_pk_bf16_f32 v198, v140, v141
v_mfma_f32_16x16x32_bf16 v[152:155], a[92:95], a[24:27], 0
ds_read_b64_tr_b16 a[120:121], v31 offset:57344
ds_read_b64_tr_b16 a[122:123], v31 offset:59392
v_mfma_f32_16x16x32_bf16 v[152:155], a[88:91], a[16:19], v[152:155]
ds_read_b64_tr_b16 a[124:125], v31 offset:61440
v_cvt_pk_bf16_f32 v199, v142, v143
v_mfma_f32_16x16x32_bf16 v[152:155], a[84:87], a[8:11], v[152:155]
buffer_load_dwordx4 v23, s[20:23], s76 offen offset:3072 lds
ds_read_b64_tr_b16 a[126:127], v31 offset:63488
v_mfma_f32_16x16x32_bf16 v[152:155], a[80:83], a[0:3], v[152:155]
s_waitcnt vmcnt(16)
s_barrier
ds_read_b64_tr_b16 a[128:129], v28 offset:49152
v_mfma_f32_16x16x32_bf16 v[144:147], a[96:99], a[32:35], v[144:147]
ds_read_b64_tr_b16 a[130:131], v28 offset:51200
v_mfma_f32_16x16x32_bf16 v[144:147], a[100:103], a[40:43], v[144:147]
s_waitcnt lgkmcnt(6)
ds_read_b64_tr_b16 a[132:133], v28 offset:53248
v_mfma_f32_16x16x32_bf16 v[144:147], a[104:107], a[48:51], v[144:147]
ds_read_b64_tr_b16 a[134:135], v28 offset:55296
v_mfma_f32_16x16x32_bf16 v[144:147], a[108:111], a[56:59], v[144:147]
ds_read_b64_tr_b16 a[136:137], v28 offset:57344
v_mfma_f32_16x16x32_bf16 v[148:151], a[108:111], a[60:63], v[148:151]
ds_read_b64_tr_b16 a[138:139], v28 offset:59392
v_mfma_f32_16x16x32_bf16 v[148:151], a[104:107], a[52:55], v[148:151]
ds_read_b64_tr_b16 a[140:141], v28 offset:61440
v_mfma_f32_16x16x32_bf16 v[148:151], a[100:103], a[44:47], v[148:151]
ds_read_b64_tr_b16 a[142:143], v28 offset:63488
v_mfma_f32_16x16x32_bf16 v[148:151], a[96:99], a[36:39], v[148:151]
ds_read_b64_tr_b16 a[144:145], v29 offset:49152
v_mfma_f32_16x16x32_bf16 v[156:159], a[112:115], a[36:39], v[156:159]
ds_read_b64_tr_b16 a[146:147], v29 offset:51200
v_mfma_f32_16x16x32_bf16 v[156:159], a[116:119], a[44:47], v[156:159]
s_waitcnt lgkmcnt(5)
ds_read_b64_tr_b16 a[148:149], v29 offset:53248
ds_read_b64_tr_b16 a[150:151], v29 offset:55296
v_mfma_f32_16x16x32_bf16 v[156:159], a[120:123], a[52:55], v[156:159]
ds_read_b64_tr_b16 a[152:153], v29 offset:57344
v_mfma_f32_16x16x32_bf16 v[156:159], a[124:127], a[60:63], v[156:159]
ds_read_b64_tr_b16 a[154:155], v29 offset:59392
v_mfma_f32_16x16x32_bf16 v[152:155], a[124:127], a[56:59], v[152:155]
ds_read_b64_tr_b16 a[156:157], v29 offset:61440
v_mfma_f32_16x16x32_bf16 v[152:155], a[120:123], a[48:51], v[152:155]
ds_read_b64_tr_b16 a[158:159], v29 offset:63488
v_mfma_f32_16x16x32_bf16 v[152:155], a[116:119], a[40:43], v[152:155]
ds_read_b64_tr_b16 a[160:161], v30 offset:32768
v_mfma_f32_16x16x32_bf16 v[152:155], a[112:115], a[32:35], v[152:155]
ds_read_b64_tr_b16 a[162:163], v30 offset:34816
v_mfma_f32_16x16x32_bf16 v[144:147], a[128:131], a[192:195], v[144:147]
ds_read_b64_tr_b16 a[164:165], v30 offset:36864
v_mfma_f32_16x16x32_bf16 v[144:147], a[132:135], a[200:203], v[144:147]
s_waitcnt lgkmcnt(5)
ds_read_b64_tr_b16 a[166:167], v30 offset:38912
v_mfma_f32_16x16x32_bf16 v[144:147], a[136:139], a[208:211], v[144:147]
ds_read_b64_tr_b16 a[168:169], v30 offset:40960
v_mfma_f32_16x16x32_bf16 v[144:147], a[140:143], a[216:219], v[144:147]
ds_read_b64_tr_b16 a[170:171], v30 offset:43008
ds_read_b64_tr_b16 a[172:173], v30 offset:45056
v_mfma_f32_16x16x32_bf16 v[148:151], a[140:143], a[220:223], v[148:151]
ds_read_b64_tr_b16 a[174:175], v30 offset:47104
v_mfma_f32_16x16x32_bf16 v[148:151], a[136:139], a[212:215], v[148:151]
ds_read_b64_tr_b16 a[176:177], v31 offset:32768
v_mfma_f32_16x16x32_bf16 v[148:151], a[132:135], a[204:207], v[148:151]
ds_read_b64_tr_b16 a[178:179], v31 offset:34816
v_mfma_f32_16x16x32_bf16 v[148:151], a[128:131], a[196:199], v[148:151]
ds_read_b64_tr_b16 a[180:181], v31 offset:36864
v_mfma_f32_16x16x32_bf16 v[156:159], a[144:147], a[196:199], v[156:159]
ds_read_b64_tr_b16 a[182:183], v31 offset:38912
v_mfma_f32_16x16x32_bf16 v[156:159], a[148:151], a[204:207], v[156:159]
ds_read_b64_tr_b16 a[184:185], v31 offset:40960
v_mfma_f32_16x16x32_bf16 v[156:159], a[152:155], a[212:215], v[156:159]
s_waitcnt lgkmcnt(5)
ds_read_b64_tr_b16 a[186:187], v31 offset:43008
v_mfma_f32_16x16x32_bf16 v[156:159], a[156:159], a[220:223], v[156:159]
ds_read_b64_tr_b16 a[188:189], v31 offset:45056
v_mfma_f32_16x16x32_bf16 v[152:155], a[156:159], a[216:219], v[152:155]
ds_read_b64_tr_b16 a[190:191], v31 offset:47104
v_mfma_f32_16x16x32_bf16 v[152:155], a[152:155], a[208:211], v[152:155]
v_mfma_f32_16x16x32_bf16 v[152:155], a[148:151], a[200:203], v[152:155]
v_mfma_f32_16x16x32_bf16 v[152:155], a[144:147], a[192:195], v[152:155]
s_waitcnt vmcnt(0)
s_barrier
ds_read_b64_tr_b16 a[64:65], v28 offset:0
v_mfma_f32_16x16x32_bf16 v[144:147], a[160:163], a[224:227], v[144:147]
buffer_store_dword v61, v12, s[60:63], 0 offen sc1
v_mfma_f32_16x16x32_bf16 v[144:147], a[164:167], a[232:235], v[144:147]
s_mov_b32 s32, 8192
ds_read_b64_tr_b16 a[66:67], v28 offset:2048
ds_read_b64_tr_b16 a[68:69], v28 offset:4096
v_mfma_f32_16x16x32_bf16 v[144:147], a[168:171], a[240:243], v[144:147]
buffer_store_dwordx4 v[192:195], v44, s[24:27], s32 offen sc1
v_mfma_f32_16x16x32_bf16 v[144:147], a[172:175], a[248:251], v[144:147]
ds_read_b64_tr_b16 a[70:71], v28 offset:6144
ds_read_b64_tr_b16 a[72:73], v28 offset:8192
v_mfma_f32_16x16x32_bf16 v[148:151], a[172:175], a[252:255], v[148:151]
ds_read_b64_tr_b16 a[74:75], v28 offset:10240
v_mfma_f32_16x16x32_bf16 v[148:151], a[168:171], a[244:247], v[148:151]
ds_read_b64_tr_b16 a[76:77], v28 offset:12288
v_mfma_f32_16x16x32_bf16 v[148:151], a[164:167], a[236:239], v[148:151]
buffer_store_dwordx4 v[196:199], v44, s[24:27], s32 offen offset:1024 sc1
v_mfma_f32_16x16x32_bf16 v[148:151], a[160:163], a[228:231], v[148:151]
s_waitcnt lgkmcnt(4)
ds_read_b64_tr_b16 a[78:79], v28 offset:14336
ds_read_b64_tr_b16 a[80:81], v29 offset:0
v_mfma_f32_16x16x32_bf16 v[156:159], a[176:179], a[228:231], v[156:159]
ds_read_b64_tr_b16 a[82:83], v29 offset:2048
v_mfma_f32_16x16x32_bf16 v[156:159], a[180:183], a[236:239], v[156:159]
ds_read_b64_tr_b16 a[84:85], v29 offset:4096
ds_read_b64_tr_b16 a[86:87], v29 offset:6144
v_mfma_f32_16x16x32_bf16 v[156:159], a[184:187], a[244:247], v[156:159]
ds_read_b64_tr_b16 a[88:89], v29 offset:8192
v_mfma_f32_16x16x32_bf16 v[156:159], a[188:191], a[252:255], v[156:159]
ds_read_b64_tr_b16 a[90:91], v29 offset:10240
v_mfma_f32_16x16x32_bf16 v[152:155], a[188:191], a[248:251], v[152:155]
ds_read_b64_tr_b16 a[92:93], v29 offset:12288
v_mfma_f32_16x16x32_bf16 v[152:155], a[184:187], a[240:243], v[152:155]
ds_read_b64_tr_b16 a[94:95], v29 offset:14336
v_mfma_f32_16x16x32_bf16 v[152:155], a[180:183], a[232:235], v[152:155]
ds_read_b64_tr_b16 a[96:97], v30 offset:0
v_mfma_f32_16x16x32_bf16 v[152:155], a[176:179], a[224:227], v[152:155]
ds_read_b64_tr_b16 a[98:99], v30 offset:2048
v_mfma_f32_16x16x32_bf16 v[128:131], a[64:67], a[0:3], 0
s_waitcnt lgkmcnt(5)
ds_read_b64_tr_b16 a[100:101], v30 offset:4096
v_mfma_f32_16x16x32_bf16 v[128:131], a[68:71], a[8:11], v[128:131]
ds_read_b64_tr_b16 a[102:103], v30 offset:6144
v_mfma_f32_16x16x32_bf16 v[128:131], a[72:75], a[16:19], v[128:131]
ds_read_b64_tr_b16 a[104:105], v30 offset:8192
v_mfma_f32_16x16x32_bf16 v[128:131], a[76:79], a[24:27], v[128:131]
ds_read_b64_tr_b16 a[106:107], v30 offset:10240
v_cvt_pk_bf16_f32 v200, v144, v145
v_mfma_f32_16x16x32_bf16 v[132:135], a[76:79], a[28:31], 0
ds_read_b64_tr_b16 a[108:109], v30 offset:12288
v_cvt_pk_bf16_f32 v201, v146, v147
v_mfma_f32_16x16x32_bf16 v[132:135], a[72:75], a[20:23], v[132:135]
ds_read_b64_tr_b16 a[110:111], v30 offset:14336
v_cvt_pk_bf16_f32 v202, v152, v153
v_mfma_f32_16x16x32_bf16 v[132:135], a[68:71], a[12:15], v[132:135]
ds_read_b64_tr_b16 a[112:113], v31 offset:0
v_cvt_pk_bf16_f32 v203, v154, v155
v_mfma_f32_16x16x32_bf16 v[132:135], a[64:67], a[4:7], v[132:135]
ds_read_b64_tr_b16 a[114:115], v31 offset:2048
v_cvt_pk_bf16_f32 v204, v148, v149
v_mfma_f32_16x16x32_bf16 v[140:143], a[80:83], a[4:7], 0
ds_read_b64_tr_b16 a[116:117], v31 offset:4096
v_cvt_pk_bf16_f32 v205, v150, v151
v_mfma_f32_16x16x32_bf16 v[140:143], a[84:87], a[12:15], v[140:143]
s_waitcnt lgkmcnt(5)
ds_read_b64_tr_b16 a[118:119], v31 offset:6144
v_cvt_pk_bf16_f32 v206, v156, v157
v_mfma_f32_16x16x32_bf16 v[140:143], a[88:91], a[20:23], v[140:143]
ds_read_b64_tr_b16 a[120:121], v31 offset:8192
ds_read_b64_tr_b16 a[122:123], v31 offset:10240
v_mfma_f32_16x16x32_bf16 v[140:143], a[92:95], a[28:31], v[140:143]
ds_read_b64_tr_b16 a[124:125], v31 offset:12288
v_cvt_pk_bf16_f32 v207, v158, v159
v_mfma_f32_16x16x32_bf16 v[136:139], a[92:95], a[24:27], 0
ds_read_b64_tr_b16 a[126:127], v31 offset:14336
v_mfma_f32_16x16x32_bf16 v[136:139], a[88:91], a[16:19], v[136:139]
v_mfma_f32_16x16x32_bf16 v[136:139], a[84:87], a[8:11], v[136:139]
v_mfma_f32_16x16x32_bf16 v[136:139], a[80:83], a[0:3], v[136:139]
ds_read_b64_tr_b16 a[128:129], v28 offset:16384
v_mfma_f32_16x16x32_bf16 v[128:131], a[96:99], a[32:35], v[128:131]
s_mov_b32 s32, 10240
ds_read_b64_tr_b16 a[130:131], v28 offset:18432
v_mfma_f32_16x16x32_bf16 v[128:131], a[100:103], a[40:43], v[128:131]
buffer_store_dwordx4 v[200:203], v44, s[24:27], s32 offen sc1
v_mfma_f32_16x16x32_bf16 v[128:131], a[104:107], a[48:51], v[128:131]
s_waitcnt lgkmcnt(2)
ds_read_b64_tr_b16 a[132:133], v28 offset:20480
v_mfma_f32_16x16x32_bf16 v[128:131], a[108:111], a[56:59], v[128:131]
ds_read_b64_tr_b16 a[134:135], v28 offset:22528
v_mfma_f32_16x16x32_bf16 v[132:135], a[108:111], a[60:63], v[132:135]
ds_read_b64_tr_b16 a[136:137], v28 offset:24576
v_mfma_f32_16x16x32_bf16 v[132:135], a[104:107], a[52:55], v[132:135]
buffer_store_dwordx4 v[204:207], v44, s[24:27], s32 offen offset:1024 sc1
v_mfma_f32_16x16x32_bf16 v[132:135], a[100:103], a[44:47], v[132:135]
ds_read_b64_tr_b16 a[138:139], v28 offset:26624
ds_read_b64_tr_b16 a[140:141], v28 offset:28672
v_mfma_f32_16x16x32_bf16 v[132:135], a[96:99], a[36:39], v[132:135]
ds_read_b64_tr_b16 a[142:143], v28 offset:30720
v_mfma_f32_16x16x32_bf16 v[140:143], a[112:115], a[36:39], v[140:143]
ds_read_b64_tr_b16 a[144:145], v29 offset:16384
v_mfma_f32_16x16x32_bf16 v[140:143], a[116:119], a[44:47], v[140:143]
ds_read_b64_tr_b16 a[146:147], v29 offset:18432
v_mfma_f32_16x16x32_bf16 v[140:143], a[120:123], a[52:55], v[140:143]
ds_read_b64_tr_b16 a[148:149], v29 offset:20480
v_mfma_f32_16x16x32_bf16 v[140:143], a[124:127], a[60:63], v[140:143]
ds_read_b64_tr_b16 a[150:151], v29 offset:22528
v_mfma_f32_16x16x32_bf16 v[136:139], a[124:127], a[56:59], v[136:139]
ds_read_b64_tr_b16 a[152:153], v29 offset:24576
v_mfma_f32_16x16x32_bf16 v[136:139], a[120:123], a[48:51], v[136:139]
ds_read_b64_tr_b16 a[154:155], v29 offset:26624
v_mfma_f32_16x16x32_bf16 v[136:139], a[116:119], a[40:43], v[136:139]
ds_read_b64_tr_b16 a[156:157], v29 offset:28672
v_mfma_f32_16x16x32_bf16 v[136:139], a[112:115], a[32:35], v[136:139]
s_waitcnt lgkmcnt(5)
ds_read_b64_tr_b16 a[158:159], v29 offset:30720
v_mfma_f32_16x16x32_bf16 v[128:131], a[128:131], a[192:195], v[128:131]
ds_read_b64_tr_b16 a[160:161], v30 offset:16384
v_mfma_f32_16x16x32_bf16 v[128:131], a[132:135], a[200:203], v[128:131]
ds_read_b64_tr_b16 a[162:163], v30 offset:18432
v_mfma_f32_16x16x32_bf16 v[128:131], a[136:139], a[208:211], v[128:131]
ds_read_b64_tr_b16 a[164:165], v30 offset:20480
v_mfma_f32_16x16x32_bf16 v[128:131], a[140:143], a[216:219], v[128:131]
ds_read_b64_tr_b16 a[166:167], v30 offset:22528
v_mfma_f32_16x16x32_bf16 v[132:135], a[140:143], a[220:223], v[132:135]
ds_read_b64_tr_b16 a[168:169], v30 offset:24576
v_mfma_f32_16x16x32_bf16 v[132:135], a[136:139], a[212:215], v[132:135]
ds_read_b64_tr_b16 a[170:171], v30 offset:26624
v_mfma_f32_16x16x32_bf16 v[132:135], a[132:135], a[204:207], v[132:135]
ds_read_b64_tr_b16 a[172:173], v30 offset:28672
v_mfma_f32_16x16x32_bf16 v[132:135], a[128:131], a[196:199], v[132:135]
ds_read_b64_tr_b16 a[174:175], v30 offset:30720
v_mfma_f32_16x16x32_bf16 v[140:143], a[144:147], a[196:199], v[140:143]
s_waitcnt lgkmcnt(5)
ds_read_b64_tr_b16 a[176:177], v31 offset:16384
v_mfma_f32_16x16x32_bf16 v[140:143], a[148:151], a[204:207], v[140:143]
ds_read_b64_tr_b16 a[178:179], v31 offset:18432
v_mfma_f32_16x16x32_bf16 v[140:143], a[152:155], a[212:215], v[140:143]
ds_read_b64_tr_b16 a[180:181], v31 offset:20480
v_mfma_f32_16x16x32_bf16 v[140:143], a[156:159], a[220:223], v[140:143]
ds_read_b64_tr_b16 a[182:183], v31 offset:22528
v_mfma_f32_16x16x32_bf16 v[136:139], a[156:159], a[216:219], v[136:139]
ds_read_b64_tr_b16 a[184:185], v31 offset:24576
v_mfma_f32_16x16x32_bf16 v[136:139], a[152:155], a[208:211], v[136:139]
ds_read_b64_tr_b16 a[186:187], v31 offset:26624
v_mfma_f32_16x16x32_bf16 v[136:139], a[148:151], a[200:203], v[136:139]
ds_read_b64_tr_b16 a[188:189], v31 offset:28672
v_mfma_f32_16x16x32_bf16 v[136:139], a[144:147], a[192:195], v[136:139]
ds_read_b64_tr_b16 a[190:191], v31 offset:30720
v_mfma_f32_16x16x32_bf16 v[128:131], a[160:163], a[224:227], v[128:131]
s_waitcnt lgkmcnt(5)
v_mfma_f32_16x16x32_bf16 v[128:131], a[164:167], a[232:235], v[128:131]
v_mfma_f32_16x16x32_bf16 v[128:131], a[168:171], a[240:243], v[128:131]
v_mfma_f32_16x16x32_bf16 v[128:131], a[172:175], a[248:251], v[128:131]
v_mfma_f32_16x16x32_bf16 v[132:135], a[172:175], a[252:255], v[132:135]
v_mfma_f32_16x16x32_bf16 v[132:135], a[168:171], a[244:247], v[132:135]
v_mfma_f32_16x16x32_bf16 v[132:135], a[164:167], a[236:239], v[132:135]
v_mfma_f32_16x16x32_bf16 v[132:135], a[160:163], a[228:231], v[132:135]
v_mfma_f32_16x16x32_bf16 v[140:143], a[176:179], a[228:231], v[140:143]
s_waitcnt lgkmcnt(2)
v_mfma_f32_16x16x32_bf16 v[140:143], a[180:183], a[236:239], v[140:143]
v_mfma_f32_16x16x32_bf16 v[140:143], a[184:187], a[244:247], v[140:143]
s_waitcnt lgkmcnt(0)
v_mfma_f32_16x16x32_bf16 v[140:143], a[188:191], a[252:255], v[140:143]
v_mfma_f32_16x16x32_bf16 v[136:139], a[188:191], a[248:251], v[136:139]
v_mfma_f32_16x16x32_bf16 v[136:139], a[184:187], a[240:243], v[136:139]
v_mfma_f32_16x16x32_bf16 v[136:139], a[180:183], a[232:235], v[136:139]
v_mfma_f32_16x16x32_bf16 v[136:139], a[176:179], a[224:227], v[136:139]
v_cvt_pk_bf16_f32 v192, v128, v129
v_cvt_pk_bf16_f32 v193, v130, v131
s_nop 5
v_cvt_pk_bf16_f32 v194, v136, v137
v_cvt_pk_bf16_f32 v195, v138, v139
s_mov_b32 s32, 12288
buffer_store_dwordx4 v[192:195], v44, s[24:27], s32 offen sc1
v_cvt_pk_bf16_f32 v196, v132, v133
v_cvt_pk_bf16_f32 v197, v134, v135
v_cvt_pk_bf16_f32 v198, v140, v141
v_cvt_pk_bf16_f32 v199, v142, v143
buffer_store_dwordx4 v[196:199], v44, s[24:27], s32 offen offset:1024 sc1
buffer_load_dword v6, v5, s[60:63], s66 offen sc1
s_mov_b32 s69, 4000
s_waitcnt vmcnt(0)
s_barrier
buffer_store_dword v61, v12, s[60:63], s49 offen sc1
s_branch L_chk
L_poll:
buffer_load_dword v6, v5, s[60:63], s66 offen sc1
s_waitcnt vmcnt(0)
L_chk:
v_cmp_eq_u32 vcc, v6, v61
v_cmp_ne_u32 s[74:75], 0, v61
s_and_b64 vcc, vcc, s[74:75]
s_cmp_eq_u64 vcc, exec
s_cbranch_scc1 L_go
s_sub_u32 s69, s69, 1
s_cmp_lg_u32 s69, 0
s_cbranch_scc1 L_poll
s_add_u32 s74, s73, 8
s_lshl_b32 s74, 1, s74
v_mov_b32 v9, s74
s_mov_b64 exec, 1
s_nop 1
buffer_atomic_or v9, off, s[56:59], s67 sc0 sc1
s_waitcnt vmcnt(0)
s_mov_b64 exec, -1
s_nop 3
v_readfirstlane_b32 s74, v9
s_and_b32 s74, s74, 0xff
s_cmp_lg_u32 s74, 8
s_cbranch_scc1 L_fin
L_go:
s_mov_b32 s50, s73
s_mov_b32 s51, s35
s_call_b64 s[40:41], L_red
L_fin:
s_cmp_lg_u32 s35, 1
s_cbranch_scc1 L_done
s_mov_b64 exec, 1
s_nop 1
buffer_atomic_add v4, off, s[56:59], s67 sc0 sc1
s_waitcnt vmcnt(0)
s_mov_b64 exec, -1
s_nop 3
v_readfirstlane_b32 s48, v4
s_and_b32 s74, s48, 0xff
s_cmp_lg_u32 s74, 7
s_cbranch_scc1 L_done
s_bfe_u32 s48, s48, 0x80008
L_redo:
s_cmp_eq_u32 s48, 0
s_cbranch_scc1 L_done
s_ff1_i32_b32 s50, s48
s_bitset0_b32 s48, s50
s_mov_b32 s51, 0
L_redo1:
s_call_b64 s[40:41], L_red
s_add_u32 s51, s51, 1
s_cmp_lt_u32 s51, 4
s_cbranch_scc1 L_redo1
s_branch L_redo
L_done:
L_exit:
s_endpgm
L_red:
s_lshr_b32 s74, s50, 1
s_mul_i32 s44, s74, 14336
s_and_b32 s75, s50, 1
s_lshl_b32 s75, s75, 10
s_add_u32 s44, s44, s75
s_lshl_b32 s75, s51, 12
s_add_u32 s44, s44, s75
s_cmp_eq_u32 s51, 3
s_cselect_b32 s46, 0x40000000, 2048
s_cselect_b32 s47, 0x40000000, 128
v_add_u32 v10, s46, v1
v_add_u32 v11, s47, v8
s_mov_b32 s45, s44
buffer_load_dwordx4 v[128:131], v1, s[4:7], s45 offen sc1
s_add_u32 s45, s45, 57344
buffer_load_dwordx4 v[132:135], v1, s[4:7], s45 offen sc1
s_add_u32 s45, s45, 57344
buffer_load_dwordx4 v[136:139], v1, s[4:7], s45 offen sc1
s_add_u32 s45, s45, 57344
buffer_load_dwordx4 v[140:143], v1, s[4:7], s45 offen sc1
s_add_u32 s45, s45, 57344
buffer_load_dwordx4 v[144:147], v1, s[4:7], s45 offen sc1
s_add_u32 s45, s45, 57344
buffer_load_dwordx4 v[148:151], v1, s[4:7], s45 offen sc1
s_add_u32 s45, s45, 57344
buffer_load_dwordx4 v[152:155], v1, s[4:7], s45 offen sc1
s_add_u32 s45, s45, 57344
buffer_load_dwordx4 v[156:159], v1, s[4:7], s45 offen sc1
s_mov_b32 s45, s44
buffer_load_dwordx4 v[64:67], v10, s[4:7], s45 offen sc1
s_add_u32 s45, s45, 57344
buffer_load_dwordx4 v[68:71], v10, s[4:7], s45 offen sc1
s_add_u32 s45, s45, 57344
buffer_load_dwordx4 v[72:75], v10, s[4:7], s45 offen sc1
s_add_u32 s45, s45, 57344
buffer_load_dwordx4 v[76:79], v10, s[4:7], s45 offen sc1
s_add_u32 s45, s45, 57344
buffer_load_dwordx4 v[80:83], v10, s[4:7], s45 offen sc1
s_add_u32 s45, s45, 57344
buffer_load_dwordx4 v[84:87], v10, s[4:7], s45 offen sc1
s_add_u32 s45, s45, 57344
buffer_load_dwordx4 v[88:91], v10, s[4:7], s45 offen sc1
s_add_u32 s45, s45, 57344
buffer_load_dwordx4 v[92:95], v10, s[4:7], s45 offen sc1
s_and_b32 s45, s70, 15
s_lshl_b32 s45, s45, 2
s_and_b32 s75, s50, 3
s_add_u32 s45, s45, s75
s_mul_i32 s45, s45, 28672
s_mul_i32 s75, s68, 896
s_add_u32 s45, s45, s75
s_lshl_b32 s75, s51, 8
s_add_u32 s45, s45, s75
s_lshr_b32 s75, s50, 2
s_lshl_b32 s75, s75, 6
s_add_u32 s45, s45, s75
v_mov_b32 v16, 0
v_mov_b32 v17, 0
v_mov_b32 v18, 0
v_mov_b32 v19, 0
v_mov_b32 v20, 0
v_mov_b32 v21, 0
v_mov_b32 v22, 0
v_mov_b32 v23, 0
s_waitcnt vmcnt(15)
v_dot2c_f32_bf16 v16, s52, v128
v_dot2c_f32_bf16 v17, s53, v128
v_dot2c_f32_bf16 v18, s52, v129
v_dot2c_f32_bf16 v19, s53, v129
v_dot2c_f32_bf16 v20, s52, v130
v_dot2c_f32_bf16 v21, s53, v130
v_dot2c_f32_bf16 v22, s52, v131
v_dot2c_f32_bf16 v23, s53, v131
s_waitcnt vmcnt(14)
v_dot2c_f32_bf16 v16, s52, v132
v_dot2c_f32_bf16 v17, s53, v132
v_dot2c_f32_bf16 v18, s52, v133
v_dot2c_f32_bf16 v19, s53, v133
v_dot2c_f32_bf16 v20, s52, v134
v_dot2c_f32_bf16 v21, s53, v134
v_dot2c_f32_bf16 v22, s52, v135
v_dot2c_f32_bf16 v23, s53, v135
s_waitcnt vmcnt(13)
v_dot2c_f32_bf16 v16, s52, v136
v_dot2c_f32_bf16 v17, s53, v136
v_dot2c_f32_bf16 v18, s52, v137
v_dot2c_f32_bf16 v19, s53, v137
v_dot2c_f32_bf16 v20, s52, v138
v_dot2c_f32_bf16 v21, s53, v138
v_dot2c_f32_bf16 v22, s52, v139
v_dot2c_f32_bf16 v23, s53, v139
s_waitcnt vmcnt(12)
v_dot2c_f32_bf16 v16, s52, v140
v_dot2c_f32_bf16 v17, s53, v140
v_dot2c_f32_bf16 v18, s52, v141
v_dot2c_f32_bf16 v19, s53, v141
v_dot2c_f32_bf16 v20, s52, v142
v_dot2c_f32_bf16 v21, s53, v142
v_dot2c_f32_bf16 v22, s52, v143
v_dot2c_f32_bf16 v23, s53, v143
s_waitcnt vmcnt(11)
v_dot2c_f32_bf16 v16, s52, v144
v_dot2c_f32_bf16 v17, s53, v144
v_dot2c_f32_bf16 v18, s52, v145
v_dot2c_f32_bf16 v19, s53, v145
v_dot2c_f32_bf16 v20, s52, v146
v_dot2c_f32_bf16 v21, s53, v146
v_dot2c_f32_bf16 v22, s52, v147
v_dot2c_f32_bf16 v23, s53, v147
s_waitcnt vmcnt(10)
v_dot2c_f32_bf16 v16, s52, v148
v_dot2c_f32_bf16 v17, s53, v148
v_dot2c_f32_bf16 v18, s52, v149
v_dot2c_f32_bf16 v19, s53, v149
v_dot2c_f32_bf16 v20, s52, v150
v_dot2c_f32_bf16 v21, s53, v150
v_dot2c_f32_bf16 v22, s52, v151
v_dot2c_f32_bf16 v23, s53, v151
s_waitcnt vmcnt(9)
v_dot2c_f32_bf16 v16, s52, v152
v_dot2c_f32_bf16 v17, s53, v152
v_dot2c_f32_bf16 v18, s52, v153
v_dot2c_f32_bf16 v19, s53, v153
v_dot2c_f32_bf16 v20, s52, v154
v_dot2c_f32_bf16 v21, s53, v154
v_dot2c_f32_bf16 v22, s52, v155
v_dot2c_f32_bf16 v23, s53, v155
s_waitcnt vmcnt(8)
v_dot2c_f32_bf16 v16, s52, v156
v_dot2c_f32_bf16 v17, s53, v156
v_dot2c_f32_bf16 v18, s52, v157
v_dot2c_f32_bf16 v19, s53, v157
v_dot2c_f32_bf16 v20, s52, v158
v_dot2c_f32_bf16 v21, s53, v158
v_dot2c_f32_bf16 v22, s52, v159
v_dot2c_f32_bf16 v23, s53, v159
s_nop 2
v_cvt_pk_bf16_f32 v24, v16, v17
v_cvt_pk_bf16_f32 v25, v18, v19
v_cvt_pk_bf16_f32 v26, v20, v21
v_cvt_pk_bf16_f32 v27, v22, v23
s_nop 1
v_permlane32_swap_b32 v24, v26
v_permlane32_swap_b32 v25, v27
s_nop 1
v_permlane16_swap_b32 v24, v26
v_permlane16_swap_b32 v25, v27
buffer_store_dwordx4 v[24:27], v8, s[8:11], s45 offen
v_mov_b32 v32, 0
v_mov_b32 v33, 0
v_mov_b32 v34, 0
v_mov_b32 v35, 0
v_mov_b32 v36, 0
v_mov_b32 v37, 0
v_mov_b32 v38, 0
v_mov_b32 v39, 0
s_waitcnt vmcnt(7)
v_dot2c_f32_bf16 v32, s52, v64
v_dot2c_f32_bf16 v33, s53, v64
v_dot2c_f32_bf16 v34, s52, v65
v_dot2c_f32_bf16 v35, s53, v65
v_dot2c_f32_bf16 v36, s52, v66
v_dot2c_f32_bf16 v37, s53, v66
v_dot2c_f32_bf16 v38, s52, v67
v_dot2c_f32_bf16 v39, s53, v67
s_waitcnt vmcnt(6)
v_dot2c_f32_bf16 v32, s52, v68
v_dot2c_f32_bf16 v33, s53, v68
v_dot2c_f32_bf16 v34, s52, v69
v_dot2c_f32_bf16 v35, s53, v69
v_dot2c_f32_bf16 v36, s52, v70
v_dot2c_f32_bf16 v37, s53, v70
v_dot2c_f32_bf16 v38, s52, v71
v_dot2c_f32_bf16 v39, s53, v71
s_waitcnt vmcnt(5)
v_dot2c_f32_bf16 v32, s52, v72
v_dot2c_f32_bf16 v33, s53, v72
v_dot2c_f32_bf16 v34, s52, v73
v_dot2c_f32_bf16 v35, s53, v73
v_dot2c_f32_bf16 v36, s52, v74
v_dot2c_f32_bf16 v37, s53, v74
v_dot2c_f32_bf16 v38, s52, v75
v_dot2c_f32_bf16 v39, s53, v75
s_waitcnt vmcnt(4)
v_dot2c_f32_bf16 v32, s52, v76
v_dot2c_f32_bf16 v33, s53, v76
v_dot2c_f32_bf16 v34, s52, v77
v_dot2c_f32_bf16 v35, s53, v77
v_dot2c_f32_bf16 v36, s52, v78
v_dot2c_f32_bf16 v37, s53, v78
v_dot2c_f32_bf16 v38, s52, v79
v_dot2c_f32_bf16 v39, s53, v79
s_waitcnt vmcnt(3)
v_dot2c_f32_bf16 v32, s52, v80
v_dot2c_f32_bf16 v33, s53, v80
v_dot2c_f32_bf16 v34, s52, v81
v_dot2c_f32_bf16 v35, s53, v81
v_dot2c_f32_bf16 v36, s52, v82
v_dot2c_f32_bf16 v37, s53, v82
v_dot2c_f32_bf16 v38, s52, v83
v_dot2c_f32_bf16 v39, s53, v83
s_waitcnt vmcnt(2)
v_dot2c_f32_bf16 v32, s52, v84
v_dot2c_f32_bf16 v33, s53, v84
v_dot2c_f32_bf16 v34, s52, v85
v_dot2c_f32_bf16 v35, s53, v85
v_dot2c_f32_bf16 v36, s52, v86
v_dot2c_f32_bf16 v37, s53, v86
v_dot2c_f32_bf16 v38, s52, v87
v_dot2c_f32_bf16 v39, s53, v87
s_waitcnt vmcnt(1)
v_dot2c_f32_bf16 v32, s52, v88
v_dot2c_f32_bf16 v33, s53, v88
v_dot2c_f32_bf16 v34, s52, v89
v_dot2c_f32_bf16 v35, s53, v89
v_dot2c_f32_bf16 v36, s52, v90
v_dot2c_f32_bf16 v37, s53, v90
v_dot2c_f32_bf16 v38, s52, v91
v_dot2c_f32_bf16 v39, s53, v91
s_waitcnt vmcnt(0)
v_dot2c_f32_bf16 v32, s52, v92
v_dot2c_f32_bf16 v33, s53, v92
v_dot2c_f32_bf16 v34, s52, v93
v_dot2c_f32_bf16 v35, s53, v93
v_dot2c_f32_bf16 v36, s52, v94
v_dot2c_f32_bf16 v37, s53, v94
v_dot2c_f32_bf16 v38, s52, v95
v_dot2c_f32_bf16 v39, s53, v95
s_nop 2
v_cvt_pk_bf16_f32 v40, v32, v33
v_cvt_pk_bf16_f32 v41, v34, v35
v_cvt_pk_bf16_f32 v42, v36, v37
v_cvt_pk_bf16_f32 v43, v38, v39
s_nop 1
v_permlane32_swap_b32 v40, v42
v_permlane32_swap_b32 v41, v43
s_nop 1
v_permlane16_swap_b32 v40, v42
v_permlane16_swap_b32 v41, v43
buffer_store_dwordx4 v[40:43], v11, s[8:11], s45 offen
s_setpc_b64 s[40:41]
L_code_end:
.set CODE_BYTES, L_code_end - concat_heads__gqa_block_cached__gqa_block_cached__near_ridge_kernel - 1024
L_t_a0:
s_call_b64 s[40:41], L_rare_1_1
s_branch L_t_a0_back
L_t_a1:
s_call_b64 s[40:41], L_rare_0_1
s_branch L_t_a1_back
L_t_a2:
s_call_b64 s[40:41], L_rare_1_1
s_branch L_t_a2_back
L_t_a3:
s_call_b64 s[40:41], L_rare_0_1
s_branch L_t_a3_back
L_t_a4:
s_call_b64 s[40:41], L_rare_1_1
s_branch L_t_a4_back
L_t_a5:
s_call_b64 s[40:41], L_rare_0_1
s_branch L_t_a5_back
L_t_a58:
s_call_b64 s[40:41], L_rare_1_1
s_branch L_t_a58_back
L_t_a59:
s_call_b64 s[40:41], L_rare_0_1
s_branch L_t_a59_back
L_t_a60:
s_call_b64 s[40:41], L_rare_1_1
s_branch L_t_a60_back
L_t_a61:
s_call_b64 s[40:41], L_rare_0_1
s_branch L_t_a61_back
L_t_a62:
s_call_b64 s[40:41], L_rare_1_0
s_branch L_t_a62_back
L_rare_0_1:
s_nop 9
v_max3_f32 v45, v96, v97, v98
v_max3_f32 v45, v45, v99, v104
v_max3_f32 v45, v45, v105, v106
v_max_f32 v45, v45, v107
v_mov_b32 v46, v45
s_nop 1
v_permlane32_swap_b32 v45, v46
v_max_f32 v45, v45, v46
v_mov_b32 v46, v45
s_nop 1
v_permlane16_swap_b32 v45, v46
v_max_f32 v45, v45, v46
v_max_f32 v45, 0, v45
v_sub_f32 v46, 0, v45
v_exp_f32 v46, v46
v_sub_f32 v88, v88, v45
v_sub_f32 v89, v89, v45
v_sub_f32 v90, v90, v45
v_sub_f32 v91, v91, v45
v_sub_f32 v96, v96, v45
v_sub_f32 v97, v97, v45
v_sub_f32 v98, v98, v45
v_sub_f32 v99, v99, v45
v_sub_f32 v104, v104, v45
v_sub_f32 v105, v105, v45
v_sub_f32 v106, v106, v45
v_sub_f32 v107, v107, v45
v_sub_f32 v112, v112, v45
v_sub_f32 v113, v113, v45
v_sub_f32 v114, v114, v45
v_sub_f32 v115, v115, v45
v_sub_f32 v120, v120, v45
v_sub_f32 v121, v121, v45
v_sub_f32 v122, v122, v45
v_sub_f32 v123, v123, v45
v_mul_f32 v38, v38, v46
v_mul_f32 v128, v128, v46
v_mul_f32 v129, v129, v46
v_mul_f32 v130, v130, v46
v_mul_f32 v131, v131, v46
v_mul_f32 v136, v136, v46
v_mul_f32 v137, v137, v46
v_mul_f32 v138, v138, v46
v_mul_f32 v139, v139, v46
v_mul_f32 v144, v144, v46
v_mul_f32 v145, v145, v46
v_mul_f32 v146, v146, v46
v_mul_f32 v147, v147, v46
v_mul_f32 v152, v152, v46
v_mul_f32 v153, v153, v46
v_mul_f32 v154, v154, v46
v_mul_f32 v155, v155, v46
v_mul_f32 v160, v160, v46
v_mul_f32 v161, v161, v46
v_mul_f32 v162, v162, v46
v_mul_f32 v163, v163, v46
v_mul_f32 v168, v168, v46
v_mul_f32 v169, v169, v46
v_mul_f32 v170, v170, v46
v_mul_f32 v171, v171, v46
v_mul_f32 v176, v176, v46
v_mul_f32 v177, v177, v46
v_mul_f32 v178, v178, v46
v_mul_f32 v179, v179, v46
v_mul_f32 v184, v184, v46
v_mul_f32 v185, v185, v46
v_mul_f32 v186, v186, v46
v_mul_f32 v187, v187, v46
v_mul_f32 v192, v192, v46
v_mul_f32 v193, v193, v46
v_mul_f32 v194, v194, v46
v_mul_f32 v195, v195, v46
v_mul_f32 v200, v200, v46
v_mul_f32 v201, v201, v46
v_mul_f32 v202, v202, v46
v_mul_f32 v203, v203, v46
v_mul_f32 v208, v208, v46
v_mul_f32 v209, v209, v46
v_mul_f32 v210, v210, v46
v_mul_f32 v211, v211, v46
v_mul_f32 v216, v216, v46
v_mul_f32 v217, v217, v46
v_mul_f32 v218, v218, v46
v_mul_f32 v219, v219, v46
v_mul_f32 v224, v224, v46
v_mul_f32 v225, v225, v46
v_mul_f32 v226, v226, v46
v_mul_f32 v227, v227, v46
v_mul_f32 v232, v232, v46
v_mul_f32 v233, v233, v46
v_mul_f32 v234, v234, v46
v_mul_f32 v235, v235, v46
v_mul_f32 v240, v240, v46
v_mul_f32 v241, v241, v46
v_mul_f32 v242, v242, v46
v_mul_f32 v243, v243, v46
v_mul_f32 v248, v248, v46
v_mul_f32 v249, v249, v46
v_mul_f32 v250, v250, v46
v_mul_f32 v251, v251, v46
v_max3_f32 v45, v100, v101, v102
v_max3_f32 v45, v45, v103, v108
v_max3_f32 v45, v45, v109, v110
v_max_f32 v45, v45, v111
v_mov_b32 v46, v45
s_nop 1
v_permlane32_swap_b32 v45, v46
v_max_f32 v45, v45, v46
v_mov_b32 v46, v45
s_nop 1
v_permlane16_swap_b32 v45, v46
v_max_f32 v45, v45, v46
v_max_f32 v45, 0, v45
v_sub_f32 v46, 0, v45
v_exp_f32 v46, v46
v_sub_f32 v92, v92, v45
v_sub_f32 v93, v93, v45
v_sub_f32 v94, v94, v45
v_sub_f32 v95, v95, v45
v_sub_f32 v100, v100, v45
v_sub_f32 v101, v101, v45
v_sub_f32 v102, v102, v45
v_sub_f32 v103, v103, v45
v_sub_f32 v108, v108, v45
v_sub_f32 v109, v109, v45
v_sub_f32 v110, v110, v45
v_sub_f32 v111, v111, v45
v_sub_f32 v116, v116, v45
v_sub_f32 v117, v117, v45
v_sub_f32 v118, v118, v45
v_sub_f32 v119, v119, v45
v_sub_f32 v124, v124, v45
v_sub_f32 v125, v125, v45
v_sub_f32 v126, v126, v45
v_sub_f32 v127, v127, v45
v_mul_f32 v39, v39, v46
v_mul_f32 v132, v132, v46
v_mul_f32 v133, v133, v46
v_mul_f32 v134, v134, v46
v_mul_f32 v135, v135, v46
v_mul_f32 v140, v140, v46
v_mul_f32 v141, v141, v46
v_mul_f32 v142, v142, v46
v_mul_f32 v143, v143, v46
v_mul_f32 v148, v148, v46
v_mul_f32 v149, v149, v46
v_mul_f32 v150, v150, v46
v_mul_f32 v151, v151, v46
v_mul_f32 v156, v156, v46
v_mul_f32 v157, v157, v46
v_mul_f32 v158, v158, v46
v_mul_f32 v159, v159, v46
v_mul_f32 v164, v164, v46
v_mul_f32 v165, v165, v46
v_mul_f32 v166, v166, v46
v_mul_f32 v167, v167, v46
v_mul_f32 v172, v172, v46
v_mul_f32 v173, v173, v46
v_mul_f32 v174, v174, v46
v_mul_f32 v175, v175, v46
v_mul_f32 v180, v180, v46
v_mul_f32 v181, v181, v46
v_mul_f32 v182, v182, v46
v_mul_f32 v183, v183, v46
v_mul_f32 v188, v188, v46
v_mul_f32 v189, v189, v46
v_mul_f32 v190, v190, v46
v_mul_f32 v191, v191, v46
v_mul_f32 v196, v196, v46
v_mul_f32 v197, v197, v46
v_mul_f32 v198, v198, v46
v_mul_f32 v199, v199, v46
v_mul_f32 v204, v204, v46
v_mul_f32 v205, v205, v46
v_mul_f32 v206, v206, v46
v_mul_f32 v207, v207, v46
v_mul_f32 v212, v212, v46
v_mul_f32 v213, v213, v46
v_mul_f32 v214, v214, v46
v_mul_f32 v215, v215, v46
v_mul_f32 v220, v220, v46
v_mul_f32 v221, v221, v46
v_mul_f32 v222, v222, v46
v_mul_f32 v223, v223, v46
v_mul_f32 v228, v228, v46
v_mul_f32 v229, v229, v46
v_mul_f32 v230, v230, v46
v_mul_f32 v231, v231, v46
v_mul_f32 v236, v236, v46
v_mul_f32 v237, v237, v46
v_mul_f32 v238, v238, v46
v_mul_f32 v239, v239, v46
v_mul_f32 v244, v244, v46
v_mul_f32 v245, v245, v46
v_mul_f32 v246, v246, v46
v_mul_f32 v247, v247, v46
v_mul_f32 v252, v252, v46
v_mul_f32 v253, v253, v46
v_mul_f32 v254, v254, v46
v_mul_f32 v255, v255, v46
v_exp_f32 v48, v96
v_exp_f32 v49, v97
v_exp_f32 v50, v98
v_add_f32 v40, v48, v49
v_exp_f32 v51, v99
v_cvt_pk_bf16_f32 v72, v48, v49
v_exp_f32 v52, v104
v_add_f32 v40, v40, v50
v_exp_f32 v53, v105
v_add_f32 v40, v40, v51
v_cvt_pk_bf16_f32 v73, v50, v51
v_exp_f32 v54, v106
v_add_f32 v40, v40, v52
v_exp_f32 v55, v107
v_add_f32 v40, v40, v53
v_cvt_pk_bf16_f32 v74, v52, v53
v_exp_f32 v48, v100
v_add_f32 v40, v40, v54
v_exp_f32 v49, v101
v_add_f32 v40, v40, v55
v_cvt_pk_bf16_f32 v75, v54, v55
v_exp_f32 v50, v102
v_add_f32 v41, v48, v49
v_exp_f32 v51, v103
v_cvt_pk_bf16_f32 v76, v48, v49
v_exp_f32 v52, v108
v_add_f32 v41, v41, v50
v_exp_f32 v53, v109
v_add_f32 v41, v41, v51
v_cvt_pk_bf16_f32 v77, v50, v51
v_exp_f32 v54, v110
v_add_f32 v41, v41, v52
v_exp_f32 v55, v111
v_add_f32 v41, v41, v53
v_cvt_pk_bf16_f32 v78, v52, v53
v_add_f32 v41, v41, v54
v_add_f32 v41, v41, v55
v_cvt_pk_bf16_f32 v79, v54, v55
s_nop 1
s_setpc_b64 s[40:41]
L_rare_1_0:
s_nop 9
v_max3_f32 v45, v112, v113, v114
v_max3_f32 v45, v45, v115, v120
v_max3_f32 v45, v45, v121, v122
v_max_f32 v45, v45, v123
v_mov_b32 v46, v45
s_nop 1
v_permlane32_swap_b32 v45, v46
v_max_f32 v45, v45, v46
v_mov_b32 v46, v45
s_nop 1
v_permlane16_swap_b32 v45, v46
v_max_f32 v45, v45, v46
v_max_f32 v45, 0, v45
v_sub_f32 v46, 0, v45
v_exp_f32 v46, v46
v_sub_f32 v88, v88, v45
v_sub_f32 v89, v89, v45
v_sub_f32 v90, v90, v45
v_sub_f32 v91, v91, v45
v_sub_f32 v112, v112, v45
v_sub_f32 v113, v113, v45
v_sub_f32 v114, v114, v45
v_sub_f32 v115, v115, v45
v_sub_f32 v120, v120, v45
v_sub_f32 v121, v121, v45
v_sub_f32 v122, v122, v45
v_sub_f32 v123, v123, v45
v_mul_f32 v38, v38, v46
v_mul_f32 v128, v128, v46
v_mul_f32 v129, v129, v46
v_mul_f32 v130, v130, v46
v_mul_f32 v131, v131, v46
v_mul_f32 v136, v136, v46
v_mul_f32 v137, v137, v46
v_mul_f32 v138, v138, v46
v_mul_f32 v139, v139, v46
v_mul_f32 v144, v144, v46
v_mul_f32 v145, v145, v46
v_mul_f32 v146, v146, v46
v_mul_f32 v147, v147, v46
v_mul_f32 v152, v152, v46
v_mul_f32 v153, v153, v46
v_mul_f32 v154, v154, v46
v_mul_f32 v155, v155, v46
v_mul_f32 v160, v160, v46
v_mul_f32 v161, v161, v46
v_mul_f32 v162, v162, v46
v_mul_f32 v163, v163, v46
v_mul_f32 v168, v168, v46
v_mul_f32 v169, v169, v46
v_mul_f32 v170, v170, v46
v_mul_f32 v171, v171, v46
v_mul_f32 v176, v176, v46
v_mul_f32 v177, v177, v46
v_mul_f32 v178, v178, v46
v_mul_f32 v179, v179, v46
v_mul_f32 v184, v184, v46
v_mul_f32 v185, v185, v46
v_mul_f32 v186, v186, v46
v_mul_f32 v187, v187, v46
v_mul_f32 v192, v192, v46
v_mul_f32 v193, v193, v46
v_mul_f32 v194, v194, v46
v_mul_f32 v195, v195, v46
v_mul_f32 v200, v200, v46
v_mul_f32 v201, v201, v46
v_mul_f32 v202, v202, v46
v_mul_f32 v203, v203, v46
v_mul_f32 v208, v208, v46
v_mul_f32 v209, v209, v46
v_mul_f32 v210, v210, v46
v_mul_f32 v211, v211, v46
v_mul_f32 v216, v216, v46
v_mul_f32 v217, v217, v46
v_mul_f32 v218, v218, v46
v_mul_f32 v219, v219, v46
v_mul_f32 v224, v224, v46
v_mul_f32 v225, v225, v46
v_mul_f32 v226, v226, v46
v_mul_f32 v227, v227, v46
v_mul_f32 v232, v232, v46
v_mul_f32 v233, v233, v46
v_mul_f32 v234, v234, v46
v_mul_f32 v235, v235, v46
v_mul_f32 v240, v240, v46
v_mul_f32 v241, v241, v46
v_mul_f32 v242, v242, v46
v_mul_f32 v243, v243, v46
v_mul_f32 v248, v248, v46
v_mul_f32 v249, v249, v46
v_mul_f32 v250, v250, v46
v_mul_f32 v251, v251, v46
v_max3_f32 v45, v116, v117, v118
v_max3_f32 v45, v45, v119, v124
v_max3_f32 v45, v45, v125, v126
v_max_f32 v45, v45, v127
v_mov_b32 v46, v45
s_nop 1
v_permlane32_swap_b32 v45, v46
v_max_f32 v45, v45, v46
v_mov_b32 v46, v45
s_nop 1
v_permlane16_swap_b32 v45, v46
v_max_f32 v45, v45, v46
v_max_f32 v45, 0, v45
v_sub_f32 v46, 0, v45
v_exp_f32 v46, v46
v_sub_f32 v92, v92, v45
v_sub_f32 v93, v93, v45
v_sub_f32 v94, v94, v45
v_sub_f32 v95, v95, v45
v_sub_f32 v116, v116, v45
v_sub_f32 v117, v117, v45
v_sub_f32 v118, v118, v45
v_sub_f32 v119, v119, v45
v_sub_f32 v124, v124, v45
v_sub_f32 v125, v125, v45
v_sub_f32 v126, v126, v45
v_sub_f32 v127, v127, v45
v_mul_f32 v39, v39, v46
v_mul_f32 v132, v132, v46
v_mul_f32 v133, v133, v46
v_mul_f32 v134, v134, v46
v_mul_f32 v135, v135, v46
v_mul_f32 v140, v140, v46
v_mul_f32 v141, v141, v46
v_mul_f32 v142, v142, v46
v_mul_f32 v143, v143, v46
v_mul_f32 v148, v148, v46
v_mul_f32 v149, v149, v46
v_mul_f32 v150, v150, v46
v_mul_f32 v151, v151, v46
v_mul_f32 v156, v156, v46
v_mul_f32 v157, v157, v46
v_mul_f32 v158, v158, v46
v_mul_f32 v159, v159, v46
v_mul_f32 v164, v164, v46
v_mul_f32 v165, v165, v46
v_mul_f32 v166, v166, v46
v_mul_f32 v167, v167, v46
v_mul_f32 v172, v172, v46
v_mul_f32 v173, v173, v46
v_mul_f32 v174, v174, v46
v_mul_f32 v175, v175, v46
v_mul_f32 v180, v180, v46
v_mul_f32 v181, v181, v46
v_mul_f32 v182, v182, v46
v_mul_f32 v183, v183, v46
v_mul_f32 v188, v188, v46
v_mul_f32 v189, v189, v46
v_mul_f32 v190, v190, v46
v_mul_f32 v191, v191, v46
v_mul_f32 v196, v196, v46
v_mul_f32 v197, v197, v46
v_mul_f32 v198, v198, v46
v_mul_f32 v199, v199, v46
v_mul_f32 v204, v204, v46
v_mul_f32 v205, v205, v46
v_mul_f32 v206, v206, v46
v_mul_f32 v207, v207, v46
v_mul_f32 v212, v212, v46
v_mul_f32 v213, v213, v46
v_mul_f32 v214, v214, v46
v_mul_f32 v215, v215, v46
v_mul_f32 v220, v220, v46
v_mul_f32 v221, v221, v46
v_mul_f32 v222, v222, v46
v_mul_f32 v223, v223, v46
v_mul_f32 v228, v228, v46
v_mul_f32 v229, v229, v46
v_mul_f32 v230, v230, v46
v_mul_f32 v231, v231, v46
v_mul_f32 v236, v236, v46
v_mul_f32 v237, v237, v46
v_mul_f32 v238, v238, v46
v_mul_f32 v239, v239, v46
v_mul_f32 v244, v244, v46
v_mul_f32 v245, v245, v46
v_mul_f32 v246, v246, v46
v_mul_f32 v247, v247, v46
v_mul_f32 v252, v252, v46
v_mul_f32 v253, v253, v46
v_mul_f32 v254, v254, v46
v_mul_f32 v255, v255, v46
v_exp_f32 v48, v112
v_exp_f32 v49, v113
v_exp_f32 v50, v114
v_add_f32 v40, v48, v49
v_exp_f32 v51, v115
v_cvt_pk_bf16_f32 v80, v48, v49
v_exp_f32 v52, v120
v_add_f32 v40, v40, v50
v_exp_f32 v53, v121
v_add_f32 v40, v40, v51
v_cvt_pk_bf16_f32 v81, v50, v51
v_exp_f32 v54, v122
v_add_f32 v40, v40, v52
v_exp_f32 v55, v123
v_add_f32 v40, v40, v53
v_cvt_pk_bf16_f32 v82, v52, v53
v_exp_f32 v48, v116
v_add_f32 v40, v40, v54
v_exp_f32 v49, v117
v_add_f32 v40, v40, v55
v_cvt_pk_bf16_f32 v83, v54, v55
v_exp_f32 v50, v118
v_add_f32 v41, v48, v49
v_exp_f32 v51, v119
v_cvt_pk_bf16_f32 v84, v48, v49
v_exp_f32 v52, v124
v_add_f32 v41, v41, v50
v_exp_f32 v53, v125
v_add_f32 v41, v41, v51
v_cvt_pk_bf16_f32 v85, v50, v51
v_exp_f32 v54, v126
v_add_f32 v41, v41, v52
v_exp_f32 v55, v127
v_add_f32 v41, v41, v53
v_cvt_pk_bf16_f32 v86, v52, v53
v_add_f32 v41, v41, v54
v_add_f32 v41, v41, v55
v_cvt_pk_bf16_f32 v87, v54, v55
s_nop 1
s_setpc_b64 s[40:41]
L_rare_1_1:
s_nop 9
v_max3_f32 v45, v112, v113, v114
v_max3_f32 v45, v45, v115, v120
v_max3_f32 v45, v45, v121, v122
v_max_f32 v45, v45, v123
v_mov_b32 v46, v45
s_nop 1
v_permlane32_swap_b32 v45, v46
v_max_f32 v45, v45, v46
v_mov_b32 v46, v45
s_nop 1
v_permlane16_swap_b32 v45, v46
v_max_f32 v45, v45, v46
v_max_f32 v45, 0, v45
v_sub_f32 v46, 0, v45
v_exp_f32 v46, v46
v_sub_f32 v88, v88, v45
v_sub_f32 v89, v89, v45
v_sub_f32 v90, v90, v45
v_sub_f32 v91, v91, v45
v_sub_f32 v112, v112, v45
v_sub_f32 v113, v113, v45
v_sub_f32 v114, v114, v45
v_sub_f32 v115, v115, v45
v_sub_f32 v120, v120, v45
v_sub_f32 v121, v121, v45
v_sub_f32 v122, v122, v45
v_sub_f32 v123, v123, v45
v_sub_f32 v96, v96, v45
v_sub_f32 v97, v97, v45
v_sub_f32 v98, v98, v45
v_sub_f32 v99, v99, v45
v_sub_f32 v104, v104, v45
v_sub_f32 v105, v105, v45
v_sub_f32 v106, v106, v45
v_sub_f32 v107, v107, v45
v_mul_f32 v38, v38, v46
v_mul_f32 v128, v128, v46
v_mul_f32 v129, v129, v46
v_mul_f32 v130, v130, v46
v_mul_f32 v131, v131, v46
v_mul_f32 v136, v136, v46
v_mul_f32 v137, v137, v46
v_mul_f32 v138, v138, v46
v_mul_f32 v139, v139, v46
v_mul_f32 v144, v144, v46
v_mul_f32 v145, v145, v46
v_mul_f32 v146, v146, v46
v_mul_f32 v147, v147, v46
v_mul_f32 v152, v152, v46
v_mul_f32 v153, v153, v46
v_mul_f32 v154, v154, v46
v_mul_f32 v155, v155, v46
v_mul_f32 v160, v160, v46
v_mul_f32 v161, v161, v46
v_mul_f32 v162, v162, v46
v_mul_f32 v163, v163, v46
v_mul_f32 v168, v168, v46
v_mul_f32 v169, v169, v46
v_mul_f32 v170, v170, v46
v_mul_f32 v171, v171, v46
v_mul_f32 v176, v176, v46
v_mul_f32 v177, v177, v46
v_mul_f32 v178, v178, v46
v_mul_f32 v179, v179, v46
v_mul_f32 v184, v184, v46
v_mul_f32 v185, v185, v46
v_mul_f32 v186, v186, v46
v_mul_f32 v187, v187, v46
v_mul_f32 v192, v192, v46
v_mul_f32 v193, v193, v46
v_mul_f32 v194, v194, v46
v_mul_f32 v195, v195, v46
v_mul_f32 v200, v200, v46
v_mul_f32 v201, v201, v46
v_mul_f32 v202, v202, v46
v_mul_f32 v203, v203, v46
v_mul_f32 v208, v208, v46
v_mul_f32 v209, v209, v46
v_mul_f32 v210, v210, v46
v_mul_f32 v211, v211, v46
v_mul_f32 v216, v216, v46
v_mul_f32 v217, v217, v46
v_mul_f32 v218, v218, v46
v_mul_f32 v219, v219, v46
v_mul_f32 v224, v224, v46
v_mul_f32 v225, v225, v46
v_mul_f32 v226, v226, v46
v_mul_f32 v227, v227, v46
v_mul_f32 v232, v232, v46
v_mul_f32 v233, v233, v46
v_mul_f32 v234, v234, v46
v_mul_f32 v235, v235, v46
v_mul_f32 v240, v240, v46
v_mul_f32 v241, v241, v46
v_mul_f32 v242, v242, v46
v_mul_f32 v243, v243, v46
v_mul_f32 v248, v248, v46
v_mul_f32 v249, v249, v46
v_mul_f32 v250, v250, v46
v_mul_f32 v251, v251, v46
v_max3_f32 v45, v116, v117, v118
v_max3_f32 v45, v45, v119, v124
v_max3_f32 v45, v45, v125, v126
v_max_f32 v45, v45, v127
v_mov_b32 v46, v45
s_nop 1
v_permlane32_swap_b32 v45, v46
v_max_f32 v45, v45, v46
v_mov_b32 v46, v45
s_nop 1
v_permlane16_swap_b32 v45, v46
v_max_f32 v45, v45, v46
v_max_f32 v45, 0, v45
v_sub_f32 v46, 0, v45
v_exp_f32 v46, v46
v_sub_f32 v92, v92, v45
v_sub_f32 v93, v93, v45
v_sub_f32 v94, v94, v45
v_sub_f32 v95, v95, v45
v_sub_f32 v116, v116, v45
v_sub_f32 v117, v117, v45
v_sub_f32 v118, v118, v45
v_sub_f32 v119, v119, v45
v_sub_f32 v124, v124, v45
v_sub_f32 v125, v125, v45
v_sub_f32 v126, v126, v45
v_sub_f32 v127, v127, v45
v_sub_f32 v100, v100, v45
v_sub_f32 v101, v101, v45
v_sub_f32 v102, v102, v45
v_sub_f32 v103, v103, v45
v_sub_f32 v108, v108, v45
v_sub_f32 v109, v109, v45
v_sub_f32 v110, v110, v45
v_sub_f32 v111, v111, v45
v_mul_f32 v39, v39, v46
v_mul_f32 v132, v132, v46
v_mul_f32 v133, v133, v46
v_mul_f32 v134, v134, v46
v_mul_f32 v135, v135, v46
v_mul_f32 v140, v140, v46
v_mul_f32 v141, v141, v46
v_mul_f32 v142, v142, v46
v_mul_f32 v143, v143, v46
v_mul_f32 v148, v148, v46
v_mul_f32 v149, v149, v46
v_mul_f32 v150, v150, v46
v_mul_f32 v151, v151, v46
v_mul_f32 v156, v156, v46
v_mul_f32 v157, v157, v46
v_mul_f32 v158, v158, v46
v_mul_f32 v159, v159, v46
v_mul_f32 v164, v164, v46
v_mul_f32 v165, v165, v46
v_mul_f32 v166, v166, v46
v_mul_f32 v167, v167, v46
v_mul_f32 v172, v172, v46
v_mul_f32 v173, v173, v46
v_mul_f32 v174, v174, v46
v_mul_f32 v175, v175, v46
v_mul_f32 v180, v180, v46
v_mul_f32 v181, v181, v46
v_mul_f32 v182, v182, v46
v_mul_f32 v183, v183, v46
v_mul_f32 v188, v188, v46
v_mul_f32 v189, v189, v46
v_mul_f32 v190, v190, v46
v_mul_f32 v191, v191, v46
v_mul_f32 v196, v196, v46
v_mul_f32 v197, v197, v46
v_mul_f32 v198, v198, v46
v_mul_f32 v199, v199, v46
v_mul_f32 v204, v204, v46
v_mul_f32 v205, v205, v46
v_mul_f32 v206, v206, v46
v_mul_f32 v207, v207, v46
v_mul_f32 v212, v212, v46
v_mul_f32 v213, v213, v46
v_mul_f32 v214, v214, v46
v_mul_f32 v215, v215, v46
v_mul_f32 v220, v220, v46
v_mul_f32 v221, v221, v46
v_mul_f32 v222, v222, v46
v_mul_f32 v223, v223, v46
v_mul_f32 v228, v228, v46
v_mul_f32 v229, v229, v46
v_mul_f32 v230, v230, v46
v_mul_f32 v231, v231, v46
v_mul_f32 v236, v236, v46
v_mul_f32 v237, v237, v46
v_mul_f32 v238, v238, v46
v_mul_f32 v239, v239, v46
v_mul_f32 v244, v244, v46
v_mul_f32 v245, v245, v46
v_mul_f32 v246, v246, v46
v_mul_f32 v247, v247, v46
v_mul_f32 v252, v252, v46
v_mul_f32 v253, v253, v46
v_mul_f32 v254, v254, v46
v_mul_f32 v255, v255, v46
v_exp_f32 v48, v112
v_exp_f32 v49, v113
v_exp_f32 v50, v114
v_add_f32 v40, v48, v49
v_exp_f32 v51, v115
v_cvt_pk_bf16_f32 v80, v48, v49
v_exp_f32 v52, v120
v_add_f32 v40, v40, v50
v_exp_f32 v53, v121
v_add_f32 v40, v40, v51
v_cvt_pk_bf16_f32 v81, v50, v51
v_exp_f32 v54, v122
v_add_f32 v40, v40, v52
v_exp_f32 v55, v123
v_add_f32 v40, v40, v53
v_cvt_pk_bf16_f32 v82, v52, v53
v_exp_f32 v48, v116
v_add_f32 v40, v40, v54
v_exp_f32 v49, v117
v_add_f32 v40, v40, v55
v_cvt_pk_bf16_f32 v83, v54, v55
v_exp_f32 v50, v118
v_add_f32 v41, v48, v49
v_exp_f32 v51, v119
v_cvt_pk_bf16_f32 v84, v48, v49
v_exp_f32 v52, v124
v_add_f32 v41, v41, v50
v_exp_f32 v53, v125
v_add_f32 v41, v41, v51
v_cvt_pk_bf16_f32 v85, v50, v51
v_exp_f32 v54, v126
v_add_f32 v41, v41, v52
v_exp_f32 v55, v127
v_add_f32 v41, v41, v53
v_cvt_pk_bf16_f32 v86, v52, v53
v_add_f32 v41, v41, v54
v_add_f32 v41, v41, v55
v_cvt_pk_bf16_f32 v87, v54, v55
s_nop 1
s_setpc_b64 s[40:41]
.section .rodata,"a"
.p2align 6
.amdhsa_kernel concat_heads__gqa_block_cached__gqa_block_cached__near_ridge_kernel
  .amdhsa_next_free_vgpr 512
  .amdhsa_next_free_sgpr 102
  .amdhsa_accum_offset 256
  .amdhsa_group_segment_fixed_size 0
  .amdhsa_kernarg_size 104
  .amdhsa_user_sgpr_count 2
  .amdhsa_user_sgpr_kernarg_segment_ptr 1
  .amdhsa_system_sgpr_workgroup_id_x 1
.end_amdhsa_kernel
```
